```python
import torch

def _softmax(x, axis=-1):
    return torch.softmax(x, dim=axis)

def _gelu(x):
    return torch.nn.functional.gelu(x, approximate='tanh')

def _silu(x):
    return torch.nn.functional.silu(x)

def _sigmoid(x):
    return torch.sigmoid(x)

def _layernorm(x, axis=-1, eps=1e-05):
    m = x.mean(dim=axis, keepdim=True)
    v = x.var(dim=axis, keepdim=True, unbiased=False)
    return (x - m) / torch.sqrt(v + eps)

def _scatter_add(tgt, idx, src, axis=0):
    return tgt.clone().index_add_(axis, idx, src)

def _segment_sum(src, seg, n):
    out = torch.zeros((n,) + src.shape[1:], dtype=src.dtype)
    return out.index_add_(0, seg, src)

def _pad(x, pw):
    flat = tuple((v for pair in reversed(pw) for v in pair))
    return torch.nn.functional.pad(x, flat)
kernel_name = 'adaLN_cond__linear_kernel_hedgehog__glu_gated_geglu__prompt'

def setup_inputs():

    _w = lambda a: (lambda t: t.to(torch.bfloat16) if t.is_floating_point() else t)(torch.as_tensor(a))

    def _A_setup():
        B, S, D, H = (1, 2048, 576, 32)
        Dh = D // H
        return {'x': _w((lambda *s: torch.randn(*s, dtype=torch.bfloat16) * 0.05)(B, S, D)), 'wqkv': _w((lambda *s: torch.randn(*s, dtype=torch.bfloat16) * 0.4)(D, 3 * D)), 'w_phi': _w((lambda *s: torch.randn(*s, dtype=torch.bfloat16) * 0.4)(H, Dh, Dh) * Dh ** (-0.5)), 'wo': _w((lambda *s: torch.randn(*s, dtype=torch.bfloat16) * 0.05)(D, D))}
    _A_in = _A_setup()

    def _B_setup():
        B, S, Dm, Df = (1, 2048, 576, 4608)
        return {'x': _w((lambda *s: torch.randn(*s, dtype=torch.bfloat16) * 0.05)(B, S, Dm)), 'w_gate': _w((lambda *s: torch.randn(*s, dtype=torch.bfloat16) * 1.6)(Dm, Df) * Dm ** (-0.5)), 'w_up': _w((lambda *s: torch.randn(*s, dtype=torch.bfloat16) * 1.6)(Dm, Df) * Dm ** (-0.5)), 'w_down': _w((lambda *s: torch.randn(*s, dtype=torch.bfloat16) * 1.6)(Df, Dm) * Df ** (-0.5))}
    _B_in = _B_setup()
    return {'A_x': _A_in['x'], 'A_wqkv': _A_in['wqkv'], 'A_w_phi': _A_in['w_phi'], 'A_wo': _A_in['wo'], 'B_x': _B_in['x'], 'B_w_gate': _B_in['w_gate'], 'B_w_up': _B_in['w_up'], 'B_w_down': _B_in['w_down'], 'c': _w((lambda *s: torch.randn(*s, dtype=torch.bfloat16) * 0.1)(1, 576) * 8.0), 'w_mod': _w((lambda *s: torch.randn(*s, dtype=torch.bfloat16) * 0.1)(576, 6 * 576) * 576 ** (-0.5) * 8.0)}

def reference(A_x, A_wqkv, A_w_phi, A_wo, B_x, B_w_gate, B_w_up, B_w_down, c, w_mod):

    def _A_ref(x, wqkv, w_phi, wo):
        B, S, D = x.shape
        H = 32
        Dh = D // H
        qkv = (lambda x, *d: x.permute(*d))((x @ wqkv).reshape(B, S, 3, H, Dh), 2, 0, 3, 1, 4)
        q, k, v = (qkv[0], qkv[1], qkv[2])
        pq = torch.einsum('bhsd,hdf->bhsf', q, w_phi)
        pk = torch.einsum('bhsd,hdf->bhsf', k, w_phi)
        phi_q = torch.concatenate([_softmax(pq, axis=-1), _softmax(-pq, axis=-1)], axis=-1)
        phi_k = torch.concatenate([_softmax(pk, axis=-1), _softmax(-pk, axis=-1)], axis=-1)
        kv = torch.einsum('bhsf,bhsd->bhfd', phi_k, v)
        z = torch.einsum('bhsf->bhf', phi_k)
        num = torch.einsum('bhqf,bhfd->bhqd', phi_q, kv)
        den = torch.einsum('bhqf,bhf->bhq', phi_q, z)[..., None] + 1e-06
        o = num / den
        return (lambda x, *d: x.permute(*d))(o, 0, 2, 1, 3).reshape(B, S, D) @ wo

    def _B_ref(x, w_gate, w_up, w_down):
        g = torch.einsum('bsd,df->bsf', x, w_gate)
        u = torch.einsum('bsd,df->bsf', x, w_up)
        h = _gelu(g) * u
        return torch.einsum('bsf,fd->bsd', h, w_down)
    x = A_x
    mod = (_silu(c) @ w_mod).reshape(c.shape[0], 6, 1, -1)
    sa, ca, ga, sb, cb, gb = (mod[:, 0].clone(), mod[:, 1].clone(), mod[:, 2].clone(), mod[:, 3].clone(), mod[:, 4].clone(), mod[:, 5].clone())
    h = _layernorm(x, axis=-1) * (1 + ca) + sa
    x = x + ga * _A_ref(h, A_wqkv, A_w_phi, A_wo)
    h = _layernorm(x, axis=-1) * (1 + cb) + sb
    x = x + gb * _B_ref(h, B_w_gate, B_w_up, B_w_down)
    return x
```

```asm
; @launch kernel=k0_mod_kernel grid=(373,1,1) block=(1024,1,1) lds=12288
; @launch kernel=ln1_kernel grid=(256,1,1) block=(64,1,1) lds=0
; @launch kernel=k1_qkv_kernel grid=(256,1,1) block=(512,1,1) lds=141312
; @launch kernel=k2_attn_kernel grid=(144,1,1) block=(512,1,1) lds=135168
; @launch kernel=ln2_kernel grid=(256,1,1) block=(64,1,1) lds=0
; @launch kernel=k3_gateup_kernel grid=(256,1,1) block=(512,1,1) lds=124416
; @launch kernel=k4_down_kernel grid=(256,1,1) block=(512,1,1) lds=147456
; @launch kernel=k5_reduce_kernel grid=(192,1,1) block=(256,1,1) lds=0
.amdgcn_target "amdgcn-amd-amdhsa--gfx950"
.text
.globl k0_mod_kernel
.p2align 8
.type k0_mod_kernel,@function
k0_mod_kernel:
    s_load_dwordx2 s[4:5], s[0:1], 64
    s_load_dwordx2 s[6:7], s[0:1], 72
    s_load_dwordx2 s[8:9], s[0:1], 96
    s_load_dwordx2 s[32:33], s[0:1], 8
    s_load_dwordx2 s[34:35], s[0:1], 24
    s_waitcnt lgkmcnt(0)
    s_mov_b32 s12, s4
    s_and_b32 s13, s5, 0xffff
    s_mov_b32 s14, 1152
    s_mov_b32 s15, 0x00020000
    s_mov_b32 s16, s6
    s_and_b32 s17, s7, 0xffff
    s_mov_b32 s18, 3981312
    s_mov_b32 s19, 0x00020000
    s_mov_b32 s20, s8
    s_and_b32 s21, s9, 0xffff
    s_mov_b32 s22, 268435456
    s_mov_b32 s23, 0x00020000
    s_cmp_ge_u32 s2, 373
    s_cbranch_scc1 end_k0_mod_kernel_1
    s_cmp_ge_u32 s2, 332
    s_cbranch_scc1 prepo_k0_mod_kernel_4
    s_cmp_ge_u32 s2, 116
    s_cbranch_scc1 prepq_k0_mod_kernel_3
    s_cmp_ge_u32 s2, 108
    s_cbranch_scc1 zero_k0_mod_kernel_2
    v_lshlrev_b32 v1, 1, v0
    buffer_load_ushort v2, v1, s[12:15], 0 offen
    v_lshrrev_b32 v6, 4, v0
    v_and_b32 v5, 15, v0
    s_lshl_b32 s24, s2, 6
    v_lshlrev_b32 v7, 2, v5
    v_add_u32 v7, s24, v7
    v_mul_u32_u24 v8, 62208, v6
    v_add_u32 v7, v7, v8
    s_mov_b32 s26, 0
    buffer_load_dword v16, v7, s[16:19], s26 offen
    s_mov_b32 s26, 6912
    buffer_load_dword v17, v7, s[16:19], s26 offen
    s_mov_b32 s26, 13824
    buffer_load_dword v18, v7, s[16:19], s26 offen
    s_mov_b32 s26, 20736
    buffer_load_dword v19, v7, s[16:19], s26 offen
    s_mov_b32 s26, 27648
    buffer_load_dword v20, v7, s[16:19], s26 offen
    s_mov_b32 s26, 34560
    buffer_load_dword v21, v7, s[16:19], s26 offen
    s_mov_b32 s26, 41472
    buffer_load_dword v22, v7, s[16:19], s26 offen
    s_mov_b32 s26, 48384
    buffer_load_dword v23, v7, s[16:19], s26 offen
    s_mov_b32 s26, 55296
    buffer_load_dword v24, v7, s[16:19], s26 offen
    s_waitcnt vmcnt(9)
    v_lshlrev_b32 v2, 16, v2
    v_mul_f32 v3, 0xbfb8aa3b, v2
    v_exp_f32 v3, v3
    s_nop 0
    v_add_f32 v3, 1.0, v3
    v_rcp_f32 v3, v3
    s_nop 0
    v_mul_f32 v3, v2, v3
    v_cvt_pk_bf16_f32 v4, v3, v3
    v_lshlrev_b32 v3, 16, v4
    v_lshlrev_b32 v1, 2, v0
    ds_write_b32 v1, v3
    s_waitcnt lgkmcnt(0)
    s_barrier
    v_mul_u32_u24 v9, 36, v6
    ds_read_b32 v32, v9 offset:0
    ds_read_b32 v33, v9 offset:4
    ds_read_b32 v34, v9 offset:8
    ds_read_b32 v35, v9 offset:12
    ds_read_b32 v36, v9 offset:16
    ds_read_b32 v37, v9 offset:20
    ds_read_b32 v38, v9 offset:24
    ds_read_b32 v39, v9 offset:28
    ds_read_b32 v40, v9 offset:32
    v_mov_b32 v10, 0
    v_mov_b32 v11, 0
    s_waitcnt vmcnt(0) lgkmcnt(0)
    v_lshlrev_b32 v12, 16, v16
    v_and_b32 v13, 0xffff0000, v16
    v_fmac_f32 v10, v12, v32
    v_fmac_f32 v11, v13, v32
    v_lshlrev_b32 v12, 16, v17
    v_and_b32 v13, 0xffff0000, v17
    v_fmac_f32 v10, v12, v33
    v_fmac_f32 v11, v13, v33
    v_lshlrev_b32 v12, 16, v18
    v_and_b32 v13, 0xffff0000, v18
    v_fmac_f32 v10, v12, v34
    v_fmac_f32 v11, v13, v34
    v_lshlrev_b32 v12, 16, v19
    v_and_b32 v13, 0xffff0000, v19
    v_fmac_f32 v10, v12, v35
    v_fmac_f32 v11, v13, v35
    v_lshlrev_b32 v12, 16, v20
    v_and_b32 v13, 0xffff0000, v20
    v_fmac_f32 v10, v12, v36
    v_fmac_f32 v11, v13, v36
    v_lshlrev_b32 v12, 16, v21
    v_and_b32 v13, 0xffff0000, v21
    v_fmac_f32 v10, v12, v37
    v_fmac_f32 v11, v13, v37
    v_lshlrev_b32 v12, 16, v22
    v_and_b32 v13, 0xffff0000, v22
    v_fmac_f32 v10, v12, v38
    v_fmac_f32 v11, v13, v38
    v_lshlrev_b32 v12, 16, v23
    v_and_b32 v13, 0xffff0000, v23
    v_fmac_f32 v10, v12, v39
    v_fmac_f32 v11, v13, v39
    v_lshlrev_b32 v12, 16, v24
    v_and_b32 v13, 0xffff0000, v24
    v_fmac_f32 v10, v12, v40
    v_fmac_f32 v11, v13, v40
    v_lshlrev_b32 v12, 7, v6
    v_lshlrev_b32 v13, 3, v5
    v_add_u32 v12, v12, v13
    ds_write_b64 v12, v[10:11] offset:4096
    s_waitcnt lgkmcnt(0)
    s_barrier
    v_cmp_gt_u32 vcc, 32, v0
    s_nop 0
    s_and_saveexec_b64 s[28:29], vcc
    s_cbranch_execz skip_k0_mod_kernel_5
    v_lshlrev_b32 v12, 2, v0
    ds_read_b32 v16, v12 offset:4096
    ds_read_b32 v17, v12 offset:4224
    ds_read_b32 v18, v12 offset:4352
    ds_read_b32 v19, v12 offset:4480
    ds_read_b32 v20, v12 offset:4608
    ds_read_b32 v21, v12 offset:4736
    ds_read_b32 v22, v12 offset:4864
    ds_read_b32 v23, v12 offset:4992
    ds_read_b32 v24, v12 offset:5120
    ds_read_b32 v25, v12 offset:5248
    ds_read_b32 v26, v12 offset:5376
    ds_read_b32 v27, v12 offset:5504
    ds_read_b32 v28, v12 offset:5632
    ds_read_b32 v29, v12 offset:5760
    ds_read_b32 v30, v12 offset:5888
    ds_read_b32 v31, v12 offset:6016
    ds_read_b32 v32, v12 offset:6144
    ds_read_b32 v33, v12 offset:6272
    ds_read_b32 v34, v12 offset:6400
    ds_read_b32 v35, v12 offset:6528
    ds_read_b32 v36, v12 offset:6656
    ds_read_b32 v37, v12 offset:6784
    ds_read_b32 v38, v12 offset:6912
    ds_read_b32 v39, v12 offset:7040
    ds_read_b32 v40, v12 offset:7168
    ds_read_b32 v41, v12 offset:7296
    ds_read_b32 v42, v12 offset:7424
    ds_read_b32 v43, v12 offset:7552
    ds_read_b32 v44, v12 offset:7680
    ds_read_b32 v45, v12 offset:7808
    ds_read_b32 v46, v12 offset:7936
    ds_read_b32 v47, v12 offset:8064
    ds_read_b32 v48, v12 offset:8192
    ds_read_b32 v49, v12 offset:8320
    ds_read_b32 v50, v12 offset:8448
    ds_read_b32 v51, v12 offset:8576
    ds_read_b32 v52, v12 offset:8704
    ds_read_b32 v53, v12 offset:8832
    ds_read_b32 v54, v12 offset:8960
    ds_read_b32 v55, v12 offset:9088
    ds_read_b32 v56, v12 offset:9216
    ds_read_b32 v57, v12 offset:9344
    ds_read_b32 v58, v12 offset:9472
    ds_read_b32 v59, v12 offset:9600
    ds_read_b32 v60, v12 offset:9728
    ds_read_b32 v61, v12 offset:9856
    ds_read_b32 v62, v12 offset:9984
    ds_read_b32 v63, v12 offset:10112
    ds_read_b32 v64, v12 offset:10240
    ds_read_b32 v65, v12 offset:10368
    ds_read_b32 v66, v12 offset:10496
    ds_read_b32 v67, v12 offset:10624
    ds_read_b32 v68, v12 offset:10752
    ds_read_b32 v69, v12 offset:10880
    ds_read_b32 v70, v12 offset:11008
    ds_read_b32 v71, v12 offset:11136
    ds_read_b32 v72, v12 offset:11264
    ds_read_b32 v73, v12 offset:11392
    ds_read_b32 v74, v12 offset:11520
    ds_read_b32 v75, v12 offset:11648
    ds_read_b32 v76, v12 offset:11776
    ds_read_b32 v77, v12 offset:11904
    ds_read_b32 v78, v12 offset:12032
    ds_read_b32 v79, v12 offset:12160
    s_waitcnt lgkmcnt(0)
    v_add_f32 v16, v16, v17
    v_add_f32 v18, v18, v19
    v_add_f32 v20, v20, v21
    v_add_f32 v22, v22, v23
    v_add_f32 v24, v24, v25
    v_add_f32 v26, v26, v27
    v_add_f32 v28, v28, v29
    v_add_f32 v30, v30, v31
    v_add_f32 v32, v32, v33
    v_add_f32 v34, v34, v35
    v_add_f32 v36, v36, v37
    v_add_f32 v38, v38, v39
    v_add_f32 v40, v40, v41
    v_add_f32 v42, v42, v43
    v_add_f32 v44, v44, v45
    v_add_f32 v46, v46, v47
    v_add_f32 v48, v48, v49
    v_add_f32 v50, v50, v51
    v_add_f32 v52, v52, v53
    v_add_f32 v54, v54, v55
    v_add_f32 v56, v56, v57
    v_add_f32 v58, v58, v59
    v_add_f32 v60, v60, v61
    v_add_f32 v62, v62, v63
    v_add_f32 v64, v64, v65
    v_add_f32 v66, v66, v67
    v_add_f32 v68, v68, v69
    v_add_f32 v70, v70, v71
    v_add_f32 v72, v72, v73
    v_add_f32 v74, v74, v75
    v_add_f32 v76, v76, v77
    v_add_f32 v78, v78, v79
    v_add_f32 v16, v16, v18
    v_add_f32 v20, v20, v22
    v_add_f32 v24, v24, v26
    v_add_f32 v28, v28, v30
    v_add_f32 v32, v32, v34
    v_add_f32 v36, v36, v38
    v_add_f32 v40, v40, v42
    v_add_f32 v44, v44, v46
    v_add_f32 v48, v48, v50
    v_add_f32 v52, v52, v54
    v_add_f32 v56, v56, v58
    v_add_f32 v60, v60, v62
    v_add_f32 v64, v64, v66
    v_add_f32 v68, v68, v70
    v_add_f32 v72, v72, v74
    v_add_f32 v76, v76, v78
    v_add_f32 v16, v16, v20
    v_add_f32 v16, v16, v24
    v_add_f32 v16, v16, v28
    v_add_f32 v16, v16, v32
    v_add_f32 v16, v16, v36
    v_add_f32 v16, v16, v40
    v_add_f32 v16, v16, v44
    v_add_f32 v16, v16, v48
    v_add_f32 v16, v16, v52
    v_add_f32 v16, v16, v56
    v_add_f32 v16, v16, v60
    v_add_f32 v16, v16, v64
    v_add_f32 v16, v16, v68
    v_add_f32 v16, v16, v72
    v_add_f32 v16, v16, v76
    v_cvt_pk_bf16_f32 v17, v16, v16
    v_lshlrev_b32 v16, 16, v17
    s_lshl_b32 s24, s2, 5
    v_add_u32 v13, s24, v0
    v_add_f32 v18, 1.0, v16
    v_cvt_pk_bf16_f32 v17, v18, v18
    v_lshlrev_b32 v18, 16, v17
    v_subrev_u32 v19, 576, v13
    v_cmp_gt_u32 vcc, 576, v19
    s_nop 0
    s_mov_b64 s[30:31], vcc
    v_subrev_u32 v19, 0x900, v13
    v_cmp_gt_u32 vcc, 576, v19
    s_nop 0
    s_or_b64 vcc, vcc, s[30:31]
    v_cndmask_b32 v16, v16, v18, vcc
    v_lshlrev_b32 v14, 1, v13
    v_lshlrev_b32 v13, 2, v13
    buffer_store_dword v16, v13, s[20:23], 0 offen
    s_mov_b32 s24, 196608
    buffer_store_short_d16_hi v16, v14, s[20:23], s24 offen
skip_k0_mod_kernel_5:
    s_branch end_k0_mod_kernel_1
zero_k0_mod_kernel_2:
    s_sub_u32 s24, s2, 108
    s_lshl_b32 s24, s24, 14
    s_add_u32 s24, s24, 16384
    v_lshlrev_b32 v1, 4, v0
    v_mov_b32 v4, 0
    v_mov_b32 v5, 0
    v_mov_b32 v6, 0
    v_mov_b32 v7, 0
    buffer_store_dwordx4 v[4:7], v1, s[20:23], s24 offen
    s_branch end_k0_mod_kernel_1
prepq_k0_mod_kernel_3:
    s_mov_b32 s12, s32
    s_and_b32 s13, s33, 0xffff
    s_mov_b32 s14, 1990656
    s_mov_b32 s15, 0x00020000
    s_sub_u32 s24, s2, 116
    s_lshl_b32 s24, s24, 10
    v_add_u32 v1, s24, v0
    v_lshrrev_b32 v2, 8, v1
    v_mul_u32_u24 v2, 2428, v2
    v_lshrrev_b32 v2, 16, v2
    v_mul_u32_u24 v3, 6912, v2
    v_sub_u32 v3, v1, v3
    v_mul_u32_u24 v4, 5462, v3
    v_lshrrev_b32 v4, 16, v4
    v_mul_u32_u24 v5, 12, v4
    v_sub_u32 v5, v3, v5
    v_lshrrev_b32 v6, 2, v5
    v_and_b32 v5, 3, v5
    v_mul_u32_u24 v4, 3456, v4
    v_mul_u32_u24 v6, 1152, v6
    v_add_u32 v4, v4, v6
    v_lshlrev_b32 v5, 4, v5
    v_add_u32 v4, v4, v5
    v_mul_u32_u24 v2, 36, v2
    v_add_u32 v4, v4, v2
    buffer_load_dwordx4 v[8:11], v4, s[12:15], 0 offen
    v_lshlrev_b32 v1, 4, v1
    s_mov_b32 s25, 70254592
    s_waitcnt vmcnt(0)
    buffer_store_dwordx4 v[8:11], v1, s[20:23], s25 offen
    s_branch end_k0_mod_kernel_1
prepo_k0_mod_kernel_4:
    s_mov_b32 s12, s34
    s_and_b32 s13, s35, 0xffff
    s_mov_b32 s14, 663552
    s_mov_b32 s15, 0x00020000
    s_sub_u32 s24, s2, 332
    s_lshl_b32 s24, s24, 10
    v_add_u32 v1, s24, v0
    v_lshrrev_b32 v2, 8, v1
    v_mul_u32_u24 v2, 7282, v2
    v_lshrrev_b32 v2, 16, v2
    v_mul_u32_u24 v3, 2304, v2
    v_sub_u32 v3, v1, v3
    v_lshrrev_b32 v4, 2, v3
    v_and_b32 v5, 3, v3
    v_mul_u32_u24 v4, 1152, v4
    v_lshlrev_b32 v5, 4, v5
    v_add_u32 v4, v4, v5
    v_lshlrev_b32 v2, 6, v2
    v_add_u32 v4, v4, v2
    v_cmp_gt_u32 vcc, 41472, v1
    s_nop 0
    s_and_saveexec_b64 s[28:29], vcc
    s_cbranch_execz end_k0_mod_kernel_1
    buffer_load_dwordx4 v[8:11], v4, s[12:15], 0 offen
    v_lshlrev_b32 v1, 4, v1
    s_mov_b32 s25, 73793536
    s_waitcnt vmcnt(0)
    buffer_store_dwordx4 v[8:11], v1, s[20:23], s25 offen
end_k0_mod_kernel_1:
    s_endpgm
.globl ln1_kernel
.p2align 8
.type ln1_kernel,@function
ln1_kernel:
    s_load_dwordx2 s[4:5], s[0:1], 0
    s_load_dwordx2 s[8:9], s[0:1], 96
    s_waitcnt lgkmcnt(0)
    s_mov_b32 s12, s4
    s_and_b32 s13, s5, 0xffff
    s_mov_b32 s14, 2359296
    s_mov_b32 s15, 0x00020000
    s_mov_b32 s20, s8
    s_and_b32 s21, s9, 0xffff
    s_mov_b32 s22, 268435456
    s_mov_b32 s23, 0x00020000
    s_cmp_ge_u32 s2, 256
    s_cbranch_scc1 end_ln1_kernel_1
    v_lshrrev_b32 v1, 3, v0
    v_and_b32 v2, 7, v0
    s_lshl_b32 s24, s2, 3
    v_add_u32 v1, s24, v1
    v_mul_u32_u24 v3, 1152, v1
    v_lshlrev_b32 v4, 4, v2
    v_add_u32 v3, v3, v4
    s_mov_b32 s26, 197760
    s_mov_b32 s27, 196608
    buffer_load_dwordx4 v[8:11], v3, s[12:15], 0 offen offset:0
    buffer_load_dwordx4 v[12:15], v3, s[12:15], 0 offen offset:128
    buffer_load_dwordx4 v[16:19], v3, s[12:15], 0 offen offset:256
    buffer_load_dwordx4 v[20:23], v3, s[12:15], 0 offen offset:384
    buffer_load_dwordx4 v[24:27], v3, s[12:15], 0 offen offset:512
    buffer_load_dwordx4 v[28:31], v3, s[12:15], 0 offen offset:640
    buffer_load_dwordx4 v[32:35], v3, s[12:15], 0 offen offset:768
    buffer_load_dwordx4 v[36:39], v3, s[12:15], 0 offen offset:896
    buffer_load_dwordx4 v[40:43], v3, s[12:15], 0 offen offset:1024
    buffer_load_dwordx4 v[44:47], v4, s[20:23], s26 offen offset:0
    buffer_load_dwordx4 v[80:83], v4, s[20:23], s27 offen offset:0
    buffer_load_dwordx4 v[48:51], v4, s[20:23], s26 offen offset:128
    buffer_load_dwordx4 v[84:87], v4, s[20:23], s27 offen offset:128
    buffer_load_dwordx4 v[52:55], v4, s[20:23], s26 offen offset:256
    buffer_load_dwordx4 v[88:91], v4, s[20:23], s27 offen offset:256
    buffer_load_dwordx4 v[56:59], v4, s[20:23], s26 offen offset:384
    buffer_load_dwordx4 v[92:95], v4, s[20:23], s27 offen offset:384
    buffer_load_dwordx4 v[60:63], v4, s[20:23], s26 offen offset:512
    buffer_load_dwordx4 v[96:99], v4, s[20:23], s27 offen offset:512
    buffer_load_dwordx4 v[64:67], v4, s[20:23], s26 offen offset:640
    buffer_load_dwordx4 v[100:103], v4, s[20:23], s27 offen offset:640
    buffer_load_dwordx4 v[68:71], v4, s[20:23], s26 offen offset:768
    buffer_load_dwordx4 v[104:107], v4, s[20:23], s27 offen offset:768
    buffer_load_dwordx4 v[72:75], v4, s[20:23], s26 offen offset:896
    buffer_load_dwordx4 v[108:111], v4, s[20:23], s27 offen offset:896
    buffer_load_dwordx4 v[76:79], v4, s[20:23], s26 offen offset:1024
    buffer_load_dwordx4 v[112:115], v4, s[20:23], s27 offen offset:1024
    v_lshrrev_b32 v120, 5, v1
    v_mul_u32_u24 v120, 36864, v120
    v_lshrrev_b32 v121, 1, v2
    v_lshlrev_b32 v121, 10, v121
    v_add_u32 v120, v120, v121
    v_and_b32 v121, 1, v2
    v_lshlrev_b32 v121, 9, v121
    v_add_u32 v120, v120, v121
    v_and_b32 v121, 31, v1
    v_lshlrev_b32 v121, 4, v121
    v_add_u32 v120, v120, v121
    v_add_u32 v120, 262144, v120
    s_waitcnt vmcnt(18)
    v_lshlrev_b32 v128, 16, v8
    v_and_b32 v129, 0xffff0000, v8
    v_lshlrev_b32 v130, 16, v9
    v_and_b32 v131, 0xffff0000, v9
    v_lshlrev_b32 v132, 16, v10
    v_and_b32 v133, 0xffff0000, v10
    v_lshlrev_b32 v134, 16, v11
    v_and_b32 v135, 0xffff0000, v11
    v_lshlrev_b32 v136, 16, v12
    v_and_b32 v137, 0xffff0000, v12
    v_lshlrev_b32 v138, 16, v13
    v_and_b32 v139, 0xffff0000, v13
    v_lshlrev_b32 v140, 16, v14
    v_and_b32 v141, 0xffff0000, v14
    v_lshlrev_b32 v142, 16, v15
    v_and_b32 v143, 0xffff0000, v15
    v_lshlrev_b32 v144, 16, v16
    v_and_b32 v145, 0xffff0000, v16
    v_lshlrev_b32 v146, 16, v17
    v_and_b32 v147, 0xffff0000, v17
    v_lshlrev_b32 v148, 16, v18
    v_and_b32 v149, 0xffff0000, v18
    v_lshlrev_b32 v150, 16, v19
    v_and_b32 v151, 0xffff0000, v19
    v_lshlrev_b32 v152, 16, v20
    v_and_b32 v153, 0xffff0000, v20
    v_lshlrev_b32 v154, 16, v21
    v_and_b32 v155, 0xffff0000, v21
    v_lshlrev_b32 v156, 16, v22
    v_and_b32 v157, 0xffff0000, v22
    v_lshlrev_b32 v158, 16, v23
    v_and_b32 v159, 0xffff0000, v23
    v_lshlrev_b32 v160, 16, v24
    v_and_b32 v161, 0xffff0000, v24
    v_lshlrev_b32 v162, 16, v25
    v_and_b32 v163, 0xffff0000, v25
    v_lshlrev_b32 v164, 16, v26
    v_and_b32 v165, 0xffff0000, v26
    v_lshlrev_b32 v166, 16, v27
    v_and_b32 v167, 0xffff0000, v27
    v_lshlrev_b32 v168, 16, v28
    v_and_b32 v169, 0xffff0000, v28
    v_lshlrev_b32 v170, 16, v29
    v_and_b32 v171, 0xffff0000, v29
    v_lshlrev_b32 v172, 16, v30
    v_and_b32 v173, 0xffff0000, v30
    v_lshlrev_b32 v174, 16, v31
    v_and_b32 v175, 0xffff0000, v31
    v_lshlrev_b32 v176, 16, v32
    v_and_b32 v177, 0xffff0000, v32
    v_lshlrev_b32 v178, 16, v33
    v_and_b32 v179, 0xffff0000, v33
    v_lshlrev_b32 v180, 16, v34
    v_and_b32 v181, 0xffff0000, v34
    v_lshlrev_b32 v182, 16, v35
    v_and_b32 v183, 0xffff0000, v35
    v_lshlrev_b32 v184, 16, v36
    v_and_b32 v185, 0xffff0000, v36
    v_lshlrev_b32 v186, 16, v37
    v_and_b32 v187, 0xffff0000, v37
    v_lshlrev_b32 v188, 16, v38
    v_and_b32 v189, 0xffff0000, v38
    v_lshlrev_b32 v190, 16, v39
    v_and_b32 v191, 0xffff0000, v39
    v_lshlrev_b32 v192, 16, v40
    v_and_b32 v193, 0xffff0000, v40
    v_lshlrev_b32 v194, 16, v41
    v_and_b32 v195, 0xffff0000, v41
    v_lshlrev_b32 v196, 16, v42
    v_and_b32 v197, 0xffff0000, v42
    v_lshlrev_b32 v198, 16, v43
    v_and_b32 v199, 0xffff0000, v43
    v_pk_add_f32 v[122:123], v[128:129], v[130:131]
    v_pk_add_f32 v[122:123], v[122:123], v[132:133]
    v_pk_add_f32 v[122:123], v[122:123], v[134:135]
    v_pk_add_f32 v[122:123], v[122:123], v[136:137]
    v_pk_add_f32 v[122:123], v[122:123], v[138:139]
    v_pk_add_f32 v[122:123], v[122:123], v[140:141]
    v_pk_add_f32 v[122:123], v[122:123], v[142:143]
    v_pk_add_f32 v[122:123], v[122:123], v[144:145]
    v_pk_add_f32 v[122:123], v[122:123], v[146:147]
    v_pk_add_f32 v[122:123], v[122:123], v[148:149]
    v_pk_add_f32 v[122:123], v[122:123], v[150:151]
    v_pk_add_f32 v[122:123], v[122:123], v[152:153]
    v_pk_add_f32 v[122:123], v[122:123], v[154:155]
    v_pk_add_f32 v[122:123], v[122:123], v[156:157]
    v_pk_add_f32 v[122:123], v[122:123], v[158:159]
    v_pk_add_f32 v[122:123], v[122:123], v[160:161]
    v_pk_add_f32 v[122:123], v[122:123], v[162:163]
    v_pk_add_f32 v[122:123], v[122:123], v[164:165]
    v_pk_add_f32 v[122:123], v[122:123], v[166:167]
    v_pk_add_f32 v[122:123], v[122:123], v[168:169]
    v_pk_add_f32 v[122:123], v[122:123], v[170:171]
    v_pk_add_f32 v[122:123], v[122:123], v[172:173]
    v_pk_add_f32 v[122:123], v[122:123], v[174:175]
    v_pk_add_f32 v[122:123], v[122:123], v[176:177]
    v_pk_add_f32 v[122:123], v[122:123], v[178:179]
    v_pk_add_f32 v[122:123], v[122:123], v[180:181]
    v_pk_add_f32 v[122:123], v[122:123], v[182:183]
    v_pk_add_f32 v[122:123], v[122:123], v[184:185]
    v_pk_add_f32 v[122:123], v[122:123], v[186:187]
    v_pk_add_f32 v[122:123], v[122:123], v[188:189]
    v_pk_add_f32 v[122:123], v[122:123], v[190:191]
    v_pk_add_f32 v[122:123], v[122:123], v[192:193]
    v_pk_add_f32 v[122:123], v[122:123], v[194:195]
    v_pk_add_f32 v[122:123], v[122:123], v[196:197]
    v_pk_add_f32 v[122:123], v[122:123], v[198:199]
    v_add_f32 v5, v122, v123
    s_nop 1
    v_add_f32_dpp v5, v5, v5 quad_perm:[1,0,3,2] row_mask:0xf bank_mask:0xf
    s_nop 1
    v_add_f32_dpp v5, v5, v5 quad_perm:[2,3,0,1] row_mask:0xf bank_mask:0xf
    s_nop 1
    v_add_f32_dpp v5, v5, v5 row_half_mirror row_mask:0xf bank_mask:0xf
    v_mul_f32 v5, 0x3ae38e39, v5
    v_mov_b32 v6, 0
    v_mov_b32 v124, 0
    v_sub_f32 v7, v128, v5
    v_sub_f32 v125, v129, v5
    v_fmac_f32 v6, v7, v7
    v_fmac_f32 v124, v125, v125
    v_sub_f32 v7, v130, v5
    v_sub_f32 v125, v131, v5
    v_fmac_f32 v6, v7, v7
    v_fmac_f32 v124, v125, v125
    v_sub_f32 v7, v132, v5
    v_sub_f32 v125, v133, v5
    v_fmac_f32 v6, v7, v7
    v_fmac_f32 v124, v125, v125
    v_sub_f32 v7, v134, v5
    v_sub_f32 v125, v135, v5
    v_fmac_f32 v6, v7, v7
    v_fmac_f32 v124, v125, v125
    v_sub_f32 v7, v136, v5
    v_sub_f32 v125, v137, v5
    v_fmac_f32 v6, v7, v7
    v_fmac_f32 v124, v125, v125
    v_sub_f32 v7, v138, v5
    v_sub_f32 v125, v139, v5
    v_fmac_f32 v6, v7, v7
    v_fmac_f32 v124, v125, v125
    v_sub_f32 v7, v140, v5
    v_sub_f32 v125, v141, v5
    v_fmac_f32 v6, v7, v7
    v_fmac_f32 v124, v125, v125
    v_sub_f32 v7, v142, v5
    v_sub_f32 v125, v143, v5
    v_fmac_f32 v6, v7, v7
    v_fmac_f32 v124, v125, v125
    v_sub_f32 v7, v144, v5
    v_sub_f32 v125, v145, v5
    v_fmac_f32 v6, v7, v7
    v_fmac_f32 v124, v125, v125
    v_sub_f32 v7, v146, v5
    v_sub_f32 v125, v147, v5
    v_fmac_f32 v6, v7, v7
    v_fmac_f32 v124, v125, v125
    v_sub_f32 v7, v148, v5
    v_sub_f32 v125, v149, v5
    v_fmac_f32 v6, v7, v7
    v_fmac_f32 v124, v125, v125
    v_sub_f32 v7, v150, v5
    v_sub_f32 v125, v151, v5
    v_fmac_f32 v6, v7, v7
    v_fmac_f32 v124, v125, v125
    v_sub_f32 v7, v152, v5
    v_sub_f32 v125, v153, v5
    v_fmac_f32 v6, v7, v7
    v_fmac_f32 v124, v125, v125
    v_sub_f32 v7, v154, v5
    v_sub_f32 v125, v155, v5
    v_fmac_f32 v6, v7, v7
    v_fmac_f32 v124, v125, v125
    v_sub_f32 v7, v156, v5
    v_sub_f32 v125, v157, v5
    v_fmac_f32 v6, v7, v7
    v_fmac_f32 v124, v125, v125
    v_sub_f32 v7, v158, v5
    v_sub_f32 v125, v159, v5
    v_fmac_f32 v6, v7, v7
    v_fmac_f32 v124, v125, v125
    v_sub_f32 v7, v160, v5
    v_sub_f32 v125, v161, v5
    v_fmac_f32 v6, v7, v7
    v_fmac_f32 v124, v125, v125
    v_sub_f32 v7, v162, v5
    v_sub_f32 v125, v163, v5
    v_fmac_f32 v6, v7, v7
    v_fmac_f32 v124, v125, v125
    v_sub_f32 v7, v164, v5
    v_sub_f32 v125, v165, v5
    v_fmac_f32 v6, v7, v7
    v_fmac_f32 v124, v125, v125
    v_sub_f32 v7, v166, v5
    v_sub_f32 v125, v167, v5
    v_fmac_f32 v6, v7, v7
    v_fmac_f32 v124, v125, v125
    v_sub_f32 v7, v168, v5
    v_sub_f32 v125, v169, v5
    v_fmac_f32 v6, v7, v7
    v_fmac_f32 v124, v125, v125
    v_sub_f32 v7, v170, v5
    v_sub_f32 v125, v171, v5
    v_fmac_f32 v6, v7, v7
    v_fmac_f32 v124, v125, v125
    v_sub_f32 v7, v172, v5
    v_sub_f32 v125, v173, v5
    v_fmac_f32 v6, v7, v7
    v_fmac_f32 v124, v125, v125
    v_sub_f32 v7, v174, v5
    v_sub_f32 v125, v175, v5
    v_fmac_f32 v6, v7, v7
    v_fmac_f32 v124, v125, v125
    v_sub_f32 v7, v176, v5
    v_sub_f32 v125, v177, v5
    v_fmac_f32 v6, v7, v7
    v_fmac_f32 v124, v125, v125
    v_sub_f32 v7, v178, v5
    v_sub_f32 v125, v179, v5
    v_fmac_f32 v6, v7, v7
    v_fmac_f32 v124, v125, v125
    v_sub_f32 v7, v180, v5
    v_sub_f32 v125, v181, v5
    v_fmac_f32 v6, v7, v7
    v_fmac_f32 v124, v125, v125
    v_sub_f32 v7, v182, v5
    v_sub_f32 v125, v183, v5
    v_fmac_f32 v6, v7, v7
    v_fmac_f32 v124, v125, v125
    v_sub_f32 v7, v184, v5
    v_sub_f32 v125, v185, v5
    v_fmac_f32 v6, v7, v7
    v_fmac_f32 v124, v125, v125
    v_sub_f32 v7, v186, v5
    v_sub_f32 v125, v187, v5
    v_fmac_f32 v6, v7, v7
    v_fmac_f32 v124, v125, v125
    v_sub_f32 v7, v188, v5
    v_sub_f32 v125, v189, v5
    v_fmac_f32 v6, v7, v7
    v_fmac_f32 v124, v125, v125
    v_sub_f32 v7, v190, v5
    v_sub_f32 v125, v191, v5
    v_fmac_f32 v6, v7, v7
    v_fmac_f32 v124, v125, v125
    v_sub_f32 v7, v192, v5
    v_sub_f32 v125, v193, v5
    v_fmac_f32 v6, v7, v7
    v_fmac_f32 v124, v125, v125
    v_sub_f32 v7, v194, v5
    v_sub_f32 v125, v195, v5
    v_fmac_f32 v6, v7, v7
    v_fmac_f32 v124, v125, v125
    v_sub_f32 v7, v196, v5
    v_sub_f32 v125, v197, v5
    v_fmac_f32 v6, v7, v7
    v_fmac_f32 v124, v125, v125
    v_sub_f32 v7, v198, v5
    v_sub_f32 v125, v199, v5
    v_fmac_f32 v6, v7, v7
    v_fmac_f32 v124, v125, v125
    v_add_f32 v6, v6, v124
    s_nop 1
    v_add_f32_dpp v6, v6, v6 quad_perm:[1,0,3,2] row_mask:0xf bank_mask:0xf
    s_nop 1
    v_add_f32_dpp v6, v6, v6 quad_perm:[2,3,0,1] row_mask:0xf bank_mask:0xf
    s_nop 1
    v_add_f32_dpp v6, v6, v6 row_half_mirror row_mask:0xf bank_mask:0xf
    v_mul_f32 v6, 0x3ae38e39, v6
    v_cvt_pk_bf16_f32 v7, v5, v6
    v_lshlrev_b32 v5, 16, v7
    v_and_b32 v6, 0xffff0000, v7
    v_add_f32 v6, 0x3727c5ac, v6
    v_cvt_pk_bf16_f32 v7, v6, v6
    v_lshlrev_b32 v6, 16, v7
    v_sqrt_f32 v6, v6
    s_nop 0
    v_cvt_pk_bf16_f32 v7, v6, v6
    v_lshlrev_b32 v6, 16, v7
    v_rcp_f32 v6, v6
    v_sub_f32 v128, v128, v5
    v_sub_f32 v129, v129, v5
    v_cvt_pk_bf16_f32 v122, v128, v129
    v_lshlrev_b32 v128, 16, v122
    v_and_b32 v129, 0xffff0000, v122
    v_mul_f32 v128, v128, v6
    v_mul_f32 v129, v129, v6
    v_cvt_pk_bf16_f32 v124, v128, v129
    v_lshlrev_b32 v128, 16, v124
    v_and_b32 v129, 0xffff0000, v124
    v_sub_f32 v130, v130, v5
    v_sub_f32 v131, v131, v5
    v_cvt_pk_bf16_f32 v7, v130, v131
    v_lshlrev_b32 v130, 16, v7
    v_and_b32 v131, 0xffff0000, v7
    v_mul_f32 v130, v130, v6
    v_mul_f32 v131, v131, v6
    v_cvt_pk_bf16_f32 v123, v130, v131
    v_lshlrev_b32 v130, 16, v123
    v_and_b32 v131, 0xffff0000, v123
    v_sub_f32 v132, v132, v5
    v_sub_f32 v133, v133, v5
    v_cvt_pk_bf16_f32 v122, v132, v133
    v_lshlrev_b32 v132, 16, v122
    v_and_b32 v133, 0xffff0000, v122
    v_mul_f32 v132, v132, v6
    v_mul_f32 v133, v133, v6
    v_cvt_pk_bf16_f32 v124, v132, v133
    v_lshlrev_b32 v132, 16, v124
    v_and_b32 v133, 0xffff0000, v124
    v_sub_f32 v134, v134, v5
    v_sub_f32 v135, v135, v5
    v_cvt_pk_bf16_f32 v7, v134, v135
    v_lshlrev_b32 v134, 16, v7
    v_and_b32 v135, 0xffff0000, v7
    v_mul_f32 v134, v134, v6
    v_mul_f32 v135, v135, v6
    v_cvt_pk_bf16_f32 v123, v134, v135
    v_lshlrev_b32 v134, 16, v123
    v_and_b32 v135, 0xffff0000, v123
    v_sub_f32 v136, v136, v5
    v_sub_f32 v137, v137, v5
    v_cvt_pk_bf16_f32 v122, v136, v137
    v_lshlrev_b32 v136, 16, v122
    v_and_b32 v137, 0xffff0000, v122
    v_mul_f32 v136, v136, v6
    v_mul_f32 v137, v137, v6
    v_cvt_pk_bf16_f32 v124, v136, v137
    v_lshlrev_b32 v136, 16, v124
    v_and_b32 v137, 0xffff0000, v124
    v_sub_f32 v138, v138, v5
    v_sub_f32 v139, v139, v5
    v_cvt_pk_bf16_f32 v7, v138, v139
    v_lshlrev_b32 v138, 16, v7
    v_and_b32 v139, 0xffff0000, v7
    v_mul_f32 v138, v138, v6
    v_mul_f32 v139, v139, v6
    v_cvt_pk_bf16_f32 v123, v138, v139
    v_lshlrev_b32 v138, 16, v123
    v_and_b32 v139, 0xffff0000, v123
    v_sub_f32 v140, v140, v5
    v_sub_f32 v141, v141, v5
    v_cvt_pk_bf16_f32 v122, v140, v141
    v_lshlrev_b32 v140, 16, v122
    v_and_b32 v141, 0xffff0000, v122
    v_mul_f32 v140, v140, v6
    v_mul_f32 v141, v141, v6
    v_cvt_pk_bf16_f32 v124, v140, v141
    v_lshlrev_b32 v140, 16, v124
    v_and_b32 v141, 0xffff0000, v124
    v_sub_f32 v142, v142, v5
    v_sub_f32 v143, v143, v5
    v_cvt_pk_bf16_f32 v7, v142, v143
    v_lshlrev_b32 v142, 16, v7
    v_and_b32 v143, 0xffff0000, v7
    v_mul_f32 v142, v142, v6
    v_mul_f32 v143, v143, v6
    v_cvt_pk_bf16_f32 v123, v142, v143
    v_lshlrev_b32 v142, 16, v123
    v_and_b32 v143, 0xffff0000, v123
    v_sub_f32 v144, v144, v5
    v_sub_f32 v145, v145, v5
    v_cvt_pk_bf16_f32 v122, v144, v145
    v_lshlrev_b32 v144, 16, v122
    v_and_b32 v145, 0xffff0000, v122
    v_mul_f32 v144, v144, v6
    v_mul_f32 v145, v145, v6
    v_cvt_pk_bf16_f32 v124, v144, v145
    v_lshlrev_b32 v144, 16, v124
    v_and_b32 v145, 0xffff0000, v124
    v_sub_f32 v146, v146, v5
    v_sub_f32 v147, v147, v5
    v_cvt_pk_bf16_f32 v7, v146, v147
    v_lshlrev_b32 v146, 16, v7
    v_and_b32 v147, 0xffff0000, v7
    v_mul_f32 v146, v146, v6
    v_mul_f32 v147, v147, v6
    v_cvt_pk_bf16_f32 v123, v146, v147
    v_lshlrev_b32 v146, 16, v123
    v_and_b32 v147, 0xffff0000, v123
    v_sub_f32 v148, v148, v5
    v_sub_f32 v149, v149, v5
    v_cvt_pk_bf16_f32 v122, v148, v149
    v_lshlrev_b32 v148, 16, v122
    v_and_b32 v149, 0xffff0000, v122
    v_mul_f32 v148, v148, v6
    v_mul_f32 v149, v149, v6
    v_cvt_pk_bf16_f32 v124, v148, v149
    v_lshlrev_b32 v148, 16, v124
    v_and_b32 v149, 0xffff0000, v124
    v_sub_f32 v150, v150, v5
    v_sub_f32 v151, v151, v5
    v_cvt_pk_bf16_f32 v7, v150, v151
    v_lshlrev_b32 v150, 16, v7
    v_and_b32 v151, 0xffff0000, v7
    v_mul_f32 v150, v150, v6
    v_mul_f32 v151, v151, v6
    v_cvt_pk_bf16_f32 v123, v150, v151
    v_lshlrev_b32 v150, 16, v123
    v_and_b32 v151, 0xffff0000, v123
    v_sub_f32 v152, v152, v5
    v_sub_f32 v153, v153, v5
    v_cvt_pk_bf16_f32 v122, v152, v153
    v_lshlrev_b32 v152, 16, v122
    v_and_b32 v153, 0xffff0000, v122
    v_mul_f32 v152, v152, v6
    v_mul_f32 v153, v153, v6
    v_cvt_pk_bf16_f32 v124, v152, v153
    v_lshlrev_b32 v152, 16, v124
    v_and_b32 v153, 0xffff0000, v124
    v_sub_f32 v154, v154, v5
    v_sub_f32 v155, v155, v5
    v_cvt_pk_bf16_f32 v7, v154, v155
    v_lshlrev_b32 v154, 16, v7
    v_and_b32 v155, 0xffff0000, v7
    v_mul_f32 v154, v154, v6
    v_mul_f32 v155, v155, v6
    v_cvt_pk_bf16_f32 v123, v154, v155
    v_lshlrev_b32 v154, 16, v123
    v_and_b32 v155, 0xffff0000, v123
    v_sub_f32 v156, v156, v5
    v_sub_f32 v157, v157, v5
    v_cvt_pk_bf16_f32 v122, v156, v157
    v_lshlrev_b32 v156, 16, v122
    v_and_b32 v157, 0xffff0000, v122
    v_mul_f32 v156, v156, v6
    v_mul_f32 v157, v157, v6
    v_cvt_pk_bf16_f32 v124, v156, v157
    v_lshlrev_b32 v156, 16, v124
    v_and_b32 v157, 0xffff0000, v124
    v_sub_f32 v158, v158, v5
    v_sub_f32 v159, v159, v5
    v_cvt_pk_bf16_f32 v7, v158, v159
    v_lshlrev_b32 v158, 16, v7
    v_and_b32 v159, 0xffff0000, v7
    v_mul_f32 v158, v158, v6
    v_mul_f32 v159, v159, v6
    v_cvt_pk_bf16_f32 v123, v158, v159
    v_lshlrev_b32 v158, 16, v123
    v_and_b32 v159, 0xffff0000, v123
    v_sub_f32 v160, v160, v5
    v_sub_f32 v161, v161, v5
    v_cvt_pk_bf16_f32 v122, v160, v161
    v_lshlrev_b32 v160, 16, v122
    v_and_b32 v161, 0xffff0000, v122
    v_mul_f32 v160, v160, v6
    v_mul_f32 v161, v161, v6
    v_cvt_pk_bf16_f32 v124, v160, v161
    v_lshlrev_b32 v160, 16, v124
    v_and_b32 v161, 0xffff0000, v124
    v_sub_f32 v162, v162, v5
    v_sub_f32 v163, v163, v5
    v_cvt_pk_bf16_f32 v7, v162, v163
    v_lshlrev_b32 v162, 16, v7
    v_and_b32 v163, 0xffff0000, v7
    v_mul_f32 v162, v162, v6
    v_mul_f32 v163, v163, v6
    v_cvt_pk_bf16_f32 v123, v162, v163
    v_lshlrev_b32 v162, 16, v123
    v_and_b32 v163, 0xffff0000, v123
    v_sub_f32 v164, v164, v5
    v_sub_f32 v165, v165, v5
    v_cvt_pk_bf16_f32 v122, v164, v165
    v_lshlrev_b32 v164, 16, v122
    v_and_b32 v165, 0xffff0000, v122
    v_mul_f32 v164, v164, v6
    v_mul_f32 v165, v165, v6
    v_cvt_pk_bf16_f32 v124, v164, v165
    v_lshlrev_b32 v164, 16, v124
    v_and_b32 v165, 0xffff0000, v124
    v_sub_f32 v166, v166, v5
    v_sub_f32 v167, v167, v5
    v_cvt_pk_bf16_f32 v7, v166, v167
    v_lshlrev_b32 v166, 16, v7
    v_and_b32 v167, 0xffff0000, v7
    v_mul_f32 v166, v166, v6
    v_mul_f32 v167, v167, v6
    v_cvt_pk_bf16_f32 v123, v166, v167
    v_lshlrev_b32 v166, 16, v123
    v_and_b32 v167, 0xffff0000, v123
    v_sub_f32 v168, v168, v5
    v_sub_f32 v169, v169, v5
    v_cvt_pk_bf16_f32 v122, v168, v169
    v_lshlrev_b32 v168, 16, v122
    v_and_b32 v169, 0xffff0000, v122
    v_mul_f32 v168, v168, v6
    v_mul_f32 v169, v169, v6
    v_cvt_pk_bf16_f32 v124, v168, v169
    v_lshlrev_b32 v168, 16, v124
    v_and_b32 v169, 0xffff0000, v124
    v_sub_f32 v170, v170, v5
    v_sub_f32 v171, v171, v5
    v_cvt_pk_bf16_f32 v7, v170, v171
    v_lshlrev_b32 v170, 16, v7
    v_and_b32 v171, 0xffff0000, v7
    v_mul_f32 v170, v170, v6
    v_mul_f32 v171, v171, v6
    v_cvt_pk_bf16_f32 v123, v170, v171
    v_lshlrev_b32 v170, 16, v123
    v_and_b32 v171, 0xffff0000, v123
    v_sub_f32 v172, v172, v5
    v_sub_f32 v173, v173, v5
    v_cvt_pk_bf16_f32 v122, v172, v173
    v_lshlrev_b32 v172, 16, v122
    v_and_b32 v173, 0xffff0000, v122
    v_mul_f32 v172, v172, v6
    v_mul_f32 v173, v173, v6
    v_cvt_pk_bf16_f32 v124, v172, v173
    v_lshlrev_b32 v172, 16, v124
    v_and_b32 v173, 0xffff0000, v124
    v_sub_f32 v174, v174, v5
    v_sub_f32 v175, v175, v5
    v_cvt_pk_bf16_f32 v7, v174, v175
    v_lshlrev_b32 v174, 16, v7
    v_and_b32 v175, 0xffff0000, v7
    v_mul_f32 v174, v174, v6
    v_mul_f32 v175, v175, v6
    v_cvt_pk_bf16_f32 v123, v174, v175
    v_lshlrev_b32 v174, 16, v123
    v_and_b32 v175, 0xffff0000, v123
    v_sub_f32 v176, v176, v5
    v_sub_f32 v177, v177, v5
    v_cvt_pk_bf16_f32 v122, v176, v177
    v_lshlrev_b32 v176, 16, v122
    v_and_b32 v177, 0xffff0000, v122
    v_mul_f32 v176, v176, v6
    v_mul_f32 v177, v177, v6
    v_cvt_pk_bf16_f32 v124, v176, v177
    v_lshlrev_b32 v176, 16, v124
    v_and_b32 v177, 0xffff0000, v124
    v_sub_f32 v178, v178, v5
    v_sub_f32 v179, v179, v5
    v_cvt_pk_bf16_f32 v7, v178, v179
    v_lshlrev_b32 v178, 16, v7
    v_and_b32 v179, 0xffff0000, v7
    v_mul_f32 v178, v178, v6
    v_mul_f32 v179, v179, v6
    v_cvt_pk_bf16_f32 v123, v178, v179
    v_lshlrev_b32 v178, 16, v123
    v_and_b32 v179, 0xffff0000, v123
    v_sub_f32 v180, v180, v5
    v_sub_f32 v181, v181, v5
    v_cvt_pk_bf16_f32 v122, v180, v181
    v_lshlrev_b32 v180, 16, v122
    v_and_b32 v181, 0xffff0000, v122
    v_mul_f32 v180, v180, v6
    v_mul_f32 v181, v181, v6
    v_cvt_pk_bf16_f32 v124, v180, v181
    v_lshlrev_b32 v180, 16, v124
    v_and_b32 v181, 0xffff0000, v124
    v_sub_f32 v182, v182, v5
    v_sub_f32 v183, v183, v5
    v_cvt_pk_bf16_f32 v7, v182, v183
    v_lshlrev_b32 v182, 16, v7
    v_and_b32 v183, 0xffff0000, v7
    v_mul_f32 v182, v182, v6
    v_mul_f32 v183, v183, v6
    v_cvt_pk_bf16_f32 v123, v182, v183
    v_lshlrev_b32 v182, 16, v123
    v_and_b32 v183, 0xffff0000, v123
    v_sub_f32 v184, v184, v5
    v_sub_f32 v185, v185, v5
    v_cvt_pk_bf16_f32 v122, v184, v185
    v_lshlrev_b32 v184, 16, v122
    v_and_b32 v185, 0xffff0000, v122
    v_mul_f32 v184, v184, v6
    v_mul_f32 v185, v185, v6
    v_cvt_pk_bf16_f32 v124, v184, v185
    v_lshlrev_b32 v184, 16, v124
    v_and_b32 v185, 0xffff0000, v124
    v_sub_f32 v186, v186, v5
    v_sub_f32 v187, v187, v5
    v_cvt_pk_bf16_f32 v7, v186, v187
    v_lshlrev_b32 v186, 16, v7
    v_and_b32 v187, 0xffff0000, v7
    v_mul_f32 v186, v186, v6
    v_mul_f32 v187, v187, v6
    v_cvt_pk_bf16_f32 v123, v186, v187
    v_lshlrev_b32 v186, 16, v123
    v_and_b32 v187, 0xffff0000, v123
    v_sub_f32 v188, v188, v5
    v_sub_f32 v189, v189, v5
    v_cvt_pk_bf16_f32 v122, v188, v189
    v_lshlrev_b32 v188, 16, v122
    v_and_b32 v189, 0xffff0000, v122
    v_mul_f32 v188, v188, v6
    v_mul_f32 v189, v189, v6
    v_cvt_pk_bf16_f32 v124, v188, v189
    v_lshlrev_b32 v188, 16, v124
    v_and_b32 v189, 0xffff0000, v124
    v_sub_f32 v190, v190, v5
    v_sub_f32 v191, v191, v5
    v_cvt_pk_bf16_f32 v7, v190, v191
    v_lshlrev_b32 v190, 16, v7
    v_and_b32 v191, 0xffff0000, v7
    v_mul_f32 v190, v190, v6
    v_mul_f32 v191, v191, v6
    v_cvt_pk_bf16_f32 v123, v190, v191
    v_lshlrev_b32 v190, 16, v123
    v_and_b32 v191, 0xffff0000, v123
    v_sub_f32 v192, v192, v5
    v_sub_f32 v193, v193, v5
    v_cvt_pk_bf16_f32 v122, v192, v193
    v_lshlrev_b32 v192, 16, v122
    v_and_b32 v193, 0xffff0000, v122
    v_mul_f32 v192, v192, v6
    v_mul_f32 v193, v193, v6
    v_cvt_pk_bf16_f32 v124, v192, v193
    v_lshlrev_b32 v192, 16, v124
    v_and_b32 v193, 0xffff0000, v124
    v_sub_f32 v194, v194, v5
    v_sub_f32 v195, v195, v5
    v_cvt_pk_bf16_f32 v7, v194, v195
    v_lshlrev_b32 v194, 16, v7
    v_and_b32 v195, 0xffff0000, v7
    v_mul_f32 v194, v194, v6
    v_mul_f32 v195, v195, v6
    v_cvt_pk_bf16_f32 v123, v194, v195
    v_lshlrev_b32 v194, 16, v123
    v_and_b32 v195, 0xffff0000, v123
    v_sub_f32 v196, v196, v5
    v_sub_f32 v197, v197, v5
    v_cvt_pk_bf16_f32 v122, v196, v197
    v_lshlrev_b32 v196, 16, v122
    v_and_b32 v197, 0xffff0000, v122
    v_mul_f32 v196, v196, v6
    v_mul_f32 v197, v197, v6
    v_cvt_pk_bf16_f32 v124, v196, v197
    v_lshlrev_b32 v196, 16, v124
    v_and_b32 v197, 0xffff0000, v124
    v_sub_f32 v198, v198, v5
    v_sub_f32 v199, v199, v5
    v_cvt_pk_bf16_f32 v7, v198, v199
    v_lshlrev_b32 v198, 16, v7
    v_and_b32 v199, 0xffff0000, v7
    v_mul_f32 v198, v198, v6
    v_mul_f32 v199, v199, v6
    v_cvt_pk_bf16_f32 v123, v198, v199
    v_lshlrev_b32 v198, 16, v123
    v_and_b32 v199, 0xffff0000, v123
    s_waitcnt vmcnt(0)
    v_lshlrev_b32 v122, 16, v44
    v_and_b32 v123, 0xffff0000, v44
    v_lshlrev_b32 v124, 16, v80
    v_and_b32 v125, 0xffff0000, v80
    v_mul_f32 v128, v128, v122
    v_mul_f32 v129, v129, v123
    v_cvt_pk_bf16_f32 v7, v128, v129
    v_lshlrev_b32 v128, 16, v7
    v_and_b32 v129, 0xffff0000, v7
    v_add_f32 v128, v128, v124
    v_add_f32 v129, v129, v125
    v_cvt_pk_bf16_f32 v8, v128, v129
    v_lshlrev_b32 v122, 16, v45
    v_and_b32 v123, 0xffff0000, v45
    v_lshlrev_b32 v124, 16, v81
    v_and_b32 v125, 0xffff0000, v81
    v_mul_f32 v130, v130, v122
    v_mul_f32 v131, v131, v123
    v_cvt_pk_bf16_f32 v7, v130, v131
    v_lshlrev_b32 v130, 16, v7
    v_and_b32 v131, 0xffff0000, v7
    v_add_f32 v130, v130, v124
    v_add_f32 v131, v131, v125
    v_cvt_pk_bf16_f32 v9, v130, v131
    v_lshlrev_b32 v122, 16, v46
    v_and_b32 v123, 0xffff0000, v46
    v_lshlrev_b32 v124, 16, v82
    v_and_b32 v125, 0xffff0000, v82
    v_mul_f32 v132, v132, v122
    v_mul_f32 v133, v133, v123
    v_cvt_pk_bf16_f32 v7, v132, v133
    v_lshlrev_b32 v132, 16, v7
    v_and_b32 v133, 0xffff0000, v7
    v_add_f32 v132, v132, v124
    v_add_f32 v133, v133, v125
    v_cvt_pk_bf16_f32 v10, v132, v133
    v_lshlrev_b32 v122, 16, v47
    v_and_b32 v123, 0xffff0000, v47
    v_lshlrev_b32 v124, 16, v83
    v_and_b32 v125, 0xffff0000, v83
    v_mul_f32 v134, v134, v122
    v_mul_f32 v135, v135, v123
    v_cvt_pk_bf16_f32 v7, v134, v135
    v_lshlrev_b32 v134, 16, v7
    v_and_b32 v135, 0xffff0000, v7
    v_add_f32 v134, v134, v124
    v_add_f32 v135, v135, v125
    v_cvt_pk_bf16_f32 v11, v134, v135
    s_mov_b32 s28, 0
    buffer_store_dwordx4 v[8:11], v120, s[20:23], s28 offen
    v_lshlrev_b32 v122, 16, v48
    v_and_b32 v123, 0xffff0000, v48
    v_lshlrev_b32 v124, 16, v84
    v_and_b32 v125, 0xffff0000, v84
    v_mul_f32 v136, v136, v122
    v_mul_f32 v137, v137, v123
    v_cvt_pk_bf16_f32 v7, v136, v137
    v_lshlrev_b32 v136, 16, v7
    v_and_b32 v137, 0xffff0000, v7
    v_add_f32 v136, v136, v124
    v_add_f32 v137, v137, v125
    v_cvt_pk_bf16_f32 v12, v136, v137
    v_lshlrev_b32 v122, 16, v49
    v_and_b32 v123, 0xffff0000, v49
    v_lshlrev_b32 v124, 16, v85
    v_and_b32 v125, 0xffff0000, v85
    v_mul_f32 v138, v138, v122
    v_mul_f32 v139, v139, v123
    v_cvt_pk_bf16_f32 v7, v138, v139
    v_lshlrev_b32 v138, 16, v7
    v_and_b32 v139, 0xffff0000, v7
    v_add_f32 v138, v138, v124
    v_add_f32 v139, v139, v125
    v_cvt_pk_bf16_f32 v13, v138, v139
    v_lshlrev_b32 v122, 16, v50
    v_and_b32 v123, 0xffff0000, v50
    v_lshlrev_b32 v124, 16, v86
    v_and_b32 v125, 0xffff0000, v86
    v_mul_f32 v140, v140, v122
    v_mul_f32 v141, v141, v123
    v_cvt_pk_bf16_f32 v7, v140, v141
    v_lshlrev_b32 v140, 16, v7
    v_and_b32 v141, 0xffff0000, v7
    v_add_f32 v140, v140, v124
    v_add_f32 v141, v141, v125
    v_cvt_pk_bf16_f32 v14, v140, v141
    v_lshlrev_b32 v122, 16, v51
    v_and_b32 v123, 0xffff0000, v51
    v_lshlrev_b32 v124, 16, v87
    v_and_b32 v125, 0xffff0000, v87
    v_mul_f32 v142, v142, v122
    v_mul_f32 v143, v143, v123
    v_cvt_pk_bf16_f32 v7, v142, v143
    v_lshlrev_b32 v142, 16, v7
    v_and_b32 v143, 0xffff0000, v7
    v_add_f32 v142, v142, v124
    v_add_f32 v143, v143, v125
    v_cvt_pk_bf16_f32 v15, v142, v143
    s_mov_b32 s28, 4096
    buffer_store_dwordx4 v[12:15], v120, s[20:23], s28 offen
    v_lshlrev_b32 v122, 16, v52
    v_and_b32 v123, 0xffff0000, v52
    v_lshlrev_b32 v124, 16, v88
    v_and_b32 v125, 0xffff0000, v88
    v_mul_f32 v144, v144, v122
    v_mul_f32 v145, v145, v123
    v_cvt_pk_bf16_f32 v7, v144, v145
    v_lshlrev_b32 v144, 16, v7
    v_and_b32 v145, 0xffff0000, v7
    v_add_f32 v144, v144, v124
    v_add_f32 v145, v145, v125
    v_cvt_pk_bf16_f32 v16, v144, v145
    v_lshlrev_b32 v122, 16, v53
    v_and_b32 v123, 0xffff0000, v53
    v_lshlrev_b32 v124, 16, v89
    v_and_b32 v125, 0xffff0000, v89
    v_mul_f32 v146, v146, v122
    v_mul_f32 v147, v147, v123
    v_cvt_pk_bf16_f32 v7, v146, v147
    v_lshlrev_b32 v146, 16, v7
    v_and_b32 v147, 0xffff0000, v7
    v_add_f32 v146, v146, v124
    v_add_f32 v147, v147, v125
    v_cvt_pk_bf16_f32 v17, v146, v147
    v_lshlrev_b32 v122, 16, v54
    v_and_b32 v123, 0xffff0000, v54
    v_lshlrev_b32 v124, 16, v90
    v_and_b32 v125, 0xffff0000, v90
    v_mul_f32 v148, v148, v122
    v_mul_f32 v149, v149, v123
    v_cvt_pk_bf16_f32 v7, v148, v149
    v_lshlrev_b32 v148, 16, v7
    v_and_b32 v149, 0xffff0000, v7
    v_add_f32 v148, v148, v124
    v_add_f32 v149, v149, v125
    v_cvt_pk_bf16_f32 v18, v148, v149
    v_lshlrev_b32 v122, 16, v55
    v_and_b32 v123, 0xffff0000, v55
    v_lshlrev_b32 v124, 16, v91
    v_and_b32 v125, 0xffff0000, v91
    v_mul_f32 v150, v150, v122
    v_mul_f32 v151, v151, v123
    v_cvt_pk_bf16_f32 v7, v150, v151
    v_lshlrev_b32 v150, 16, v7
    v_and_b32 v151, 0xffff0000, v7
    v_add_f32 v150, v150, v124
    v_add_f32 v151, v151, v125
    v_cvt_pk_bf16_f32 v19, v150, v151
    s_mov_b32 s28, 8192
    buffer_store_dwordx4 v[16:19], v120, s[20:23], s28 offen
    v_lshlrev_b32 v122, 16, v56
    v_and_b32 v123, 0xffff0000, v56
    v_lshlrev_b32 v124, 16, v92
    v_and_b32 v125, 0xffff0000, v92
    v_mul_f32 v152, v152, v122
    v_mul_f32 v153, v153, v123
    v_cvt_pk_bf16_f32 v7, v152, v153
    v_lshlrev_b32 v152, 16, v7
    v_and_b32 v153, 0xffff0000, v7
    v_add_f32 v152, v152, v124
    v_add_f32 v153, v153, v125
    v_cvt_pk_bf16_f32 v20, v152, v153
    v_lshlrev_b32 v122, 16, v57
    v_and_b32 v123, 0xffff0000, v57
    v_lshlrev_b32 v124, 16, v93
    v_and_b32 v125, 0xffff0000, v93
    v_mul_f32 v154, v154, v122
    v_mul_f32 v155, v155, v123
    v_cvt_pk_bf16_f32 v7, v154, v155
    v_lshlrev_b32 v154, 16, v7
    v_and_b32 v155, 0xffff0000, v7
    v_add_f32 v154, v154, v124
    v_add_f32 v155, v155, v125
    v_cvt_pk_bf16_f32 v21, v154, v155
    v_lshlrev_b32 v122, 16, v58
    v_and_b32 v123, 0xffff0000, v58
    v_lshlrev_b32 v124, 16, v94
    v_and_b32 v125, 0xffff0000, v94
    v_mul_f32 v156, v156, v122
    v_mul_f32 v157, v157, v123
    v_cvt_pk_bf16_f32 v7, v156, v157
    v_lshlrev_b32 v156, 16, v7
    v_and_b32 v157, 0xffff0000, v7
    v_add_f32 v156, v156, v124
    v_add_f32 v157, v157, v125
    v_cvt_pk_bf16_f32 v22, v156, v157
    v_lshlrev_b32 v122, 16, v59
    v_and_b32 v123, 0xffff0000, v59
    v_lshlrev_b32 v124, 16, v95
    v_and_b32 v125, 0xffff0000, v95
    v_mul_f32 v158, v158, v122
    v_mul_f32 v159, v159, v123
    v_cvt_pk_bf16_f32 v7, v158, v159
    v_lshlrev_b32 v158, 16, v7
    v_and_b32 v159, 0xffff0000, v7
    v_add_f32 v158, v158, v124
    v_add_f32 v159, v159, v125
    v_cvt_pk_bf16_f32 v23, v158, v159
    s_mov_b32 s28, 12288
    buffer_store_dwordx4 v[20:23], v120, s[20:23], s28 offen
    v_lshlrev_b32 v122, 16, v60
    v_and_b32 v123, 0xffff0000, v60
    v_lshlrev_b32 v124, 16, v96
    v_and_b32 v125, 0xffff0000, v96
    v_mul_f32 v160, v160, v122
    v_mul_f32 v161, v161, v123
    v_cvt_pk_bf16_f32 v7, v160, v161
    v_lshlrev_b32 v160, 16, v7
    v_and_b32 v161, 0xffff0000, v7
    v_add_f32 v160, v160, v124
    v_add_f32 v161, v161, v125
    v_cvt_pk_bf16_f32 v24, v160, v161
    v_lshlrev_b32 v122, 16, v61
    v_and_b32 v123, 0xffff0000, v61
    v_lshlrev_b32 v124, 16, v97
    v_and_b32 v125, 0xffff0000, v97
    v_mul_f32 v162, v162, v122
    v_mul_f32 v163, v163, v123
    v_cvt_pk_bf16_f32 v7, v162, v163
    v_lshlrev_b32 v162, 16, v7
    v_and_b32 v163, 0xffff0000, v7
    v_add_f32 v162, v162, v124
    v_add_f32 v163, v163, v125
    v_cvt_pk_bf16_f32 v25, v162, v163
    v_lshlrev_b32 v122, 16, v62
    v_and_b32 v123, 0xffff0000, v62
    v_lshlrev_b32 v124, 16, v98
    v_and_b32 v125, 0xffff0000, v98
    v_mul_f32 v164, v164, v122
    v_mul_f32 v165, v165, v123
    v_cvt_pk_bf16_f32 v7, v164, v165
    v_lshlrev_b32 v164, 16, v7
    v_and_b32 v165, 0xffff0000, v7
    v_add_f32 v164, v164, v124
    v_add_f32 v165, v165, v125
    v_cvt_pk_bf16_f32 v26, v164, v165
    v_lshlrev_b32 v122, 16, v63
    v_and_b32 v123, 0xffff0000, v63
    v_lshlrev_b32 v124, 16, v99
    v_and_b32 v125, 0xffff0000, v99
    v_mul_f32 v166, v166, v122
    v_mul_f32 v167, v167, v123
    v_cvt_pk_bf16_f32 v7, v166, v167
    v_lshlrev_b32 v166, 16, v7
    v_and_b32 v167, 0xffff0000, v7
    v_add_f32 v166, v166, v124
    v_add_f32 v167, v167, v125
    v_cvt_pk_bf16_f32 v27, v166, v167
    s_mov_b32 s28, 16384
    buffer_store_dwordx4 v[24:27], v120, s[20:23], s28 offen
    v_lshlrev_b32 v122, 16, v64
    v_and_b32 v123, 0xffff0000, v64
    v_lshlrev_b32 v124, 16, v100
    v_and_b32 v125, 0xffff0000, v100
    v_mul_f32 v168, v168, v122
    v_mul_f32 v169, v169, v123
    v_cvt_pk_bf16_f32 v7, v168, v169
    v_lshlrev_b32 v168, 16, v7
    v_and_b32 v169, 0xffff0000, v7
    v_add_f32 v168, v168, v124
    v_add_f32 v169, v169, v125
    v_cvt_pk_bf16_f32 v28, v168, v169
    v_lshlrev_b32 v122, 16, v65
    v_and_b32 v123, 0xffff0000, v65
    v_lshlrev_b32 v124, 16, v101
    v_and_b32 v125, 0xffff0000, v101
    v_mul_f32 v170, v170, v122
    v_mul_f32 v171, v171, v123
    v_cvt_pk_bf16_f32 v7, v170, v171
    v_lshlrev_b32 v170, 16, v7
    v_and_b32 v171, 0xffff0000, v7
    v_add_f32 v170, v170, v124
    v_add_f32 v171, v171, v125
    v_cvt_pk_bf16_f32 v29, v170, v171
    v_lshlrev_b32 v122, 16, v66
    v_and_b32 v123, 0xffff0000, v66
    v_lshlrev_b32 v124, 16, v102
    v_and_b32 v125, 0xffff0000, v102
    v_mul_f32 v172, v172, v122
    v_mul_f32 v173, v173, v123
    v_cvt_pk_bf16_f32 v7, v172, v173
    v_lshlrev_b32 v172, 16, v7
    v_and_b32 v173, 0xffff0000, v7
    v_add_f32 v172, v172, v124
    v_add_f32 v173, v173, v125
    v_cvt_pk_bf16_f32 v30, v172, v173
    v_lshlrev_b32 v122, 16, v67
    v_and_b32 v123, 0xffff0000, v67
    v_lshlrev_b32 v124, 16, v103
    v_and_b32 v125, 0xffff0000, v103
    v_mul_f32 v174, v174, v122
    v_mul_f32 v175, v175, v123
    v_cvt_pk_bf16_f32 v7, v174, v175
    v_lshlrev_b32 v174, 16, v7
    v_and_b32 v175, 0xffff0000, v7
    v_add_f32 v174, v174, v124
    v_add_f32 v175, v175, v125
    v_cvt_pk_bf16_f32 v31, v174, v175
    s_mov_b32 s28, 20480
    buffer_store_dwordx4 v[28:31], v120, s[20:23], s28 offen
    v_lshlrev_b32 v122, 16, v68
    v_and_b32 v123, 0xffff0000, v68
    v_lshlrev_b32 v124, 16, v104
    v_and_b32 v125, 0xffff0000, v104
    v_mul_f32 v176, v176, v122
    v_mul_f32 v177, v177, v123
    v_cvt_pk_bf16_f32 v7, v176, v177
    v_lshlrev_b32 v176, 16, v7
    v_and_b32 v177, 0xffff0000, v7
    v_add_f32 v176, v176, v124
    v_add_f32 v177, v177, v125
    v_cvt_pk_bf16_f32 v32, v176, v177
    v_lshlrev_b32 v122, 16, v69
    v_and_b32 v123, 0xffff0000, v69
    v_lshlrev_b32 v124, 16, v105
    v_and_b32 v125, 0xffff0000, v105
    v_mul_f32 v178, v178, v122
    v_mul_f32 v179, v179, v123
    v_cvt_pk_bf16_f32 v7, v178, v179
    v_lshlrev_b32 v178, 16, v7
    v_and_b32 v179, 0xffff0000, v7
    v_add_f32 v178, v178, v124
    v_add_f32 v179, v179, v125
    v_cvt_pk_bf16_f32 v33, v178, v179
    v_lshlrev_b32 v122, 16, v70
    v_and_b32 v123, 0xffff0000, v70
    v_lshlrev_b32 v124, 16, v106
    v_and_b32 v125, 0xffff0000, v106
    v_mul_f32 v180, v180, v122
    v_mul_f32 v181, v181, v123
    v_cvt_pk_bf16_f32 v7, v180, v181
    v_lshlrev_b32 v180, 16, v7
    v_and_b32 v181, 0xffff0000, v7
    v_add_f32 v180, v180, v124
    v_add_f32 v181, v181, v125
    v_cvt_pk_bf16_f32 v34, v180, v181
    v_lshlrev_b32 v122, 16, v71
    v_and_b32 v123, 0xffff0000, v71
    v_lshlrev_b32 v124, 16, v107
    v_and_b32 v125, 0xffff0000, v107
    v_mul_f32 v182, v182, v122
    v_mul_f32 v183, v183, v123
    v_cvt_pk_bf16_f32 v7, v182, v183
    v_lshlrev_b32 v182, 16, v7
    v_and_b32 v183, 0xffff0000, v7
    v_add_f32 v182, v182, v124
    v_add_f32 v183, v183, v125
    v_cvt_pk_bf16_f32 v35, v182, v183
    s_mov_b32 s28, 24576
    buffer_store_dwordx4 v[32:35], v120, s[20:23], s28 offen
    v_lshlrev_b32 v122, 16, v72
    v_and_b32 v123, 0xffff0000, v72
    v_lshlrev_b32 v124, 16, v108
    v_and_b32 v125, 0xffff0000, v108
    v_mul_f32 v184, v184, v122
    v_mul_f32 v185, v185, v123
    v_cvt_pk_bf16_f32 v7, v184, v185
    v_lshlrev_b32 v184, 16, v7
    v_and_b32 v185, 0xffff0000, v7
    v_add_f32 v184, v184, v124
    v_add_f32 v185, v185, v125
    v_cvt_pk_bf16_f32 v36, v184, v185
    v_lshlrev_b32 v122, 16, v73
    v_and_b32 v123, 0xffff0000, v73
    v_lshlrev_b32 v124, 16, v109
    v_and_b32 v125, 0xffff0000, v109
    v_mul_f32 v186, v186, v122
    v_mul_f32 v187, v187, v123
    v_cvt_pk_bf16_f32 v7, v186, v187
    v_lshlrev_b32 v186, 16, v7
    v_and_b32 v187, 0xffff0000, v7
    v_add_f32 v186, v186, v124
    v_add_f32 v187, v187, v125
    v_cvt_pk_bf16_f32 v37, v186, v187
    v_lshlrev_b32 v122, 16, v74
    v_and_b32 v123, 0xffff0000, v74
    v_lshlrev_b32 v124, 16, v110
    v_and_b32 v125, 0xffff0000, v110
    v_mul_f32 v188, v188, v122
    v_mul_f32 v189, v189, v123
    v_cvt_pk_bf16_f32 v7, v188, v189
    v_lshlrev_b32 v188, 16, v7
    v_and_b32 v189, 0xffff0000, v7
    v_add_f32 v188, v188, v124
    v_add_f32 v189, v189, v125
    v_cvt_pk_bf16_f32 v38, v188, v189
    v_lshlrev_b32 v122, 16, v75
    v_and_b32 v123, 0xffff0000, v75
    v_lshlrev_b32 v124, 16, v111
    v_and_b32 v125, 0xffff0000, v111
    v_mul_f32 v190, v190, v122
    v_mul_f32 v191, v191, v123
    v_cvt_pk_bf16_f32 v7, v190, v191
    v_lshlrev_b32 v190, 16, v7
    v_and_b32 v191, 0xffff0000, v7
    v_add_f32 v190, v190, v124
    v_add_f32 v191, v191, v125
    v_cvt_pk_bf16_f32 v39, v190, v191
    s_mov_b32 s28, 28672
    buffer_store_dwordx4 v[36:39], v120, s[20:23], s28 offen
    v_lshlrev_b32 v122, 16, v76
    v_and_b32 v123, 0xffff0000, v76
    v_lshlrev_b32 v124, 16, v112
    v_and_b32 v125, 0xffff0000, v112
    v_mul_f32 v192, v192, v122
    v_mul_f32 v193, v193, v123
    v_cvt_pk_bf16_f32 v7, v192, v193
    v_lshlrev_b32 v192, 16, v7
    v_and_b32 v193, 0xffff0000, v7
    v_add_f32 v192, v192, v124
    v_add_f32 v193, v193, v125
    v_cvt_pk_bf16_f32 v40, v192, v193
    v_lshlrev_b32 v122, 16, v77
    v_and_b32 v123, 0xffff0000, v77
    v_lshlrev_b32 v124, 16, v113
    v_and_b32 v125, 0xffff0000, v113
    v_mul_f32 v194, v194, v122
    v_mul_f32 v195, v195, v123
    v_cvt_pk_bf16_f32 v7, v194, v195
    v_lshlrev_b32 v194, 16, v7
    v_and_b32 v195, 0xffff0000, v7
    v_add_f32 v194, v194, v124
    v_add_f32 v195, v195, v125
    v_cvt_pk_bf16_f32 v41, v194, v195
    v_lshlrev_b32 v122, 16, v78
    v_and_b32 v123, 0xffff0000, v78
    v_lshlrev_b32 v124, 16, v114
    v_and_b32 v125, 0xffff0000, v114
    v_mul_f32 v196, v196, v122
    v_mul_f32 v197, v197, v123
    v_cvt_pk_bf16_f32 v7, v196, v197
    v_lshlrev_b32 v196, 16, v7
    v_and_b32 v197, 0xffff0000, v7
    v_add_f32 v196, v196, v124
    v_add_f32 v197, v197, v125
    v_cvt_pk_bf16_f32 v42, v196, v197
    v_lshlrev_b32 v122, 16, v79
    v_and_b32 v123, 0xffff0000, v79
    v_lshlrev_b32 v124, 16, v115
    v_and_b32 v125, 0xffff0000, v115
    v_mul_f32 v198, v198, v122
    v_mul_f32 v199, v199, v123
    v_cvt_pk_bf16_f32 v7, v198, v199
    v_lshlrev_b32 v198, 16, v7
    v_and_b32 v199, 0xffff0000, v7
    v_add_f32 v198, v198, v124
    v_add_f32 v199, v199, v125
    v_cvt_pk_bf16_f32 v43, v198, v199
    s_mov_b32 s28, 32768
    buffer_store_dwordx4 v[40:43], v120, s[20:23], s28 offen
end_ln1_kernel_1:
    s_endpgm
.globl k1_qkv_kernel
.p2align 8
.type k1_qkv_kernel,@function
k1_qkv_kernel:
    s_load_dwordx2 s[4:5], s[0:1], 8
    s_load_dwordx2 s[6:7], s[0:1], 16
    s_load_dwordx2 s[8:9], s[0:1], 96
    s_waitcnt lgkmcnt(0)
    s_mov_b32 s12, s4
    s_and_b32 s13, s5, 0xffff
    s_mov_b32 s14, 1990656
    s_mov_b32 s15, 0x00020000
    s_mov_b32 s16, s6
    s_and_b32 s17, s7, 0xffff
    s_mov_b32 s18, 20736
    s_mov_b32 s19, 0x00020000
    s_mov_b32 s20, s8
    s_and_b32 s21, s9, 0xffff
    s_mov_b32 s22, 268435456
    s_mov_b32 s23, 0x00020000
    s_cmp_ge_u32 s2, 256
    s_cbranch_scc1 end_k1_qkv_kernel_1
    s_and_b32 s24, s2, 31
    s_lshr_b32 s25, s2, 5
    v_lshrrev_b32 v1, 6, v0
    v_and_b32 v2, 63, v0
    s_mov_b32 s30, 0
    s_mov_b32 s31, -1
    v_readfirstlane_b32 s26, v1
    v_lshlrev_b32 v13, 4, v2
    s_mul_i32 s28, s24, 110592
    s_add_u32 s28, s28, 70254592
    s_lshl_b32 s29, s26, 10
    s_add_u32 s28, s28, s29
    s_lshl_b32 s36, s25, 3
    s_add_u32 s36, s36, s26
    s_mul_i32 s37, s36, 36864
    s_add_u32 s37, s37, 262144
    s_add_u32 m0, s29, 0
    s_add_u32 s34, s28, 0
    buffer_load_dwordx4 v13, s[20:23], s34 offen lds
    s_add_u32 m0, s29, 8192
    s_add_u32 s34, s28, 8192
    buffer_load_dwordx4 v13, s[20:23], s34 offen lds
    s_add_u32 m0, s29, 16384
    s_add_u32 s34, s28, 16384
    buffer_load_dwordx4 v13, s[20:23], s34 offen lds
    s_add_u32 m0, s29, 24576
    s_add_u32 s34, s28, 24576
    buffer_load_dwordx4 v13, s[20:23], s34 offen lds
    s_add_u32 m0, s29, 32768
    s_add_u32 s34, s28, 32768
    buffer_load_dwordx4 v13, s[20:23], s34 offen lds
    s_add_u32 s35, s37, 0
    buffer_load_dwordx4 v[16:19], v13, s[20:23], s35 offen
    s_add_u32 s35, s37, 1024
    buffer_load_dwordx4 v[20:23], v13, s[20:23], s35 offen
    s_add_u32 s35, s37, 2048
    buffer_load_dwordx4 v[24:27], v13, s[20:23], s35 offen
    s_add_u32 s35, s37, 3072
    buffer_load_dwordx4 v[28:31], v13, s[20:23], s35 offen
    s_add_u32 s35, s37, 4096
    buffer_load_dwordx4 v[32:35], v13, s[20:23], s35 offen
    s_add_u32 s35, s37, 5120
    buffer_load_dwordx4 v[36:39], v13, s[20:23], s35 offen
    s_add_u32 m0, s29, 40960
    s_add_u32 s34, s28, 40960
    buffer_load_dwordx4 v13, s[20:23], s34 offen lds
    s_add_u32 m0, s29, 49152
    s_add_u32 s34, s28, 49152
    buffer_load_dwordx4 v13, s[20:23], s34 offen lds
    s_add_u32 m0, s29, 57344
    s_add_u32 s34, s28, 57344
    buffer_load_dwordx4 v13, s[20:23], s34 offen lds
    s_add_u32 m0, s29, 65536
    s_add_u32 s34, s28, 65536
    buffer_load_dwordx4 v13, s[20:23], s34 offen lds
    s_add_u32 m0, s29, 73728
    s_add_u32 s34, s28, 73728
    buffer_load_dwordx4 v13, s[20:23], s34 offen lds
    s_add_u32 m0, s29, 81920
    s_add_u32 s34, s28, 81920
    buffer_load_dwordx4 v13, s[20:23], s34 offen lds
    s_add_u32 m0, s29, 90112
    s_add_u32 s34, s28, 90112
    buffer_load_dwordx4 v13, s[20:23], s34 offen lds
    s_add_u32 m0, s29, 98304
    s_add_u32 s34, s28, 98304
    buffer_load_dwordx4 v13, s[20:23], s34 offen lds
    s_cmp_ge_u32 s26, 4
    s_cbranch_scc1 nod_k1_qkv_kernel_2
    s_add_u32 m0, s29, 106496
    s_add_u32 s34, s28, 106496
    buffer_load_dwordx4 v13, s[20:23], s34 offen lds
nod_k1_qkv_kernel_2:
    v_and_b32 v4, 31, v2
    v_lshrrev_b32 v5, 5, v2
    s_mul_i32 s27, s24, 648
    v_lshlrev_b32 v6, 1, v4
    v_mul_u32_u24 v7, 144, v5
    v_add_u32 v6, v6, v7
    v_add_u32 v6, s27, v6
    v_cmp_gt_u32 vcc, 18, v4
    v_mov_b32 v7, 0x7fffffff
    s_nop 0
    v_cndmask_b32 v6, v7, v6, vcc
    buffer_load_ushort v176, v6, s[16:19], 0 offen offset:0
    buffer_load_ushort v177, v6, s[16:19], 0 offen offset:36
    buffer_load_ushort v178, v6, s[16:19], 0 offen offset:72
    buffer_load_ushort v179, v6, s[16:19], 0 offen offset:108
    buffer_load_ushort v180, v6, s[16:19], 0 offen offset:288
    buffer_load_ushort v181, v6, s[16:19], 0 offen offset:324
    buffer_load_ushort v182, v6, s[16:19], 0 offen offset:360
    buffer_load_ushort v183, v6, s[16:19], 0 offen offset:396
    v_cndmask_b32 v8, v6, v7, s[30:31]
    buffer_load_ushort v184, v8, s[16:19], 0 offen offset:576
    buffer_load_ushort v185, v8, s[16:19], 0 offen offset:612
    v_lshlrev_b32 v9, 2, v5
    v_sub_u32 v9, v4, v9
    v_mov_b32 v10, 0x3f80
    v_mov_b32 v11, 0x3f800000
    v_cmp_eq_u32 vcc, 0, v9
    s_nop 1
    v_cndmask_b32 v80, 0, v10, vcc
    v_cmp_eq_u32 vcc, 1, v9
    s_nop 1
    v_cndmask_b32 v12, 0, v11, vcc
    v_or_b32 v80, v80, v12
    v_cmp_eq_u32 vcc, 2, v9
    s_nop 1
    v_cndmask_b32 v81, 0, v10, vcc
    v_cmp_eq_u32 vcc, 3, v9
    s_nop 1
    v_cndmask_b32 v12, 0, v11, vcc
    v_or_b32 v81, v81, v12
    v_cmp_eq_u32 vcc, 8, v9
    s_nop 1
    v_cndmask_b32 v82, 0, v10, vcc
    v_cmp_eq_u32 vcc, 9, v9
    s_nop 1
    v_cndmask_b32 v12, 0, v11, vcc
    v_or_b32 v82, v82, v12
    v_cmp_eq_u32 vcc, 10, v9
    s_nop 1
    v_cndmask_b32 v83, 0, v10, vcc
    v_cmp_eq_u32 vcc, 11, v9
    s_nop 1
    v_cndmask_b32 v12, 0, v11, vcc
    v_or_b32 v83, v83, v12
    v_cmp_eq_u32 vcc, 16, v2
    s_nop 1
    v_cndmask_b32 v84, 0, v10, vcc
    v_cmp_eq_u32 vcc, 17, v2
    s_nop 1
    v_cndmask_b32 v12, 0, v11, vcc
    v_or_b32 v84, v84, v12
    v_mov_b32 v85, 0
    v_mov_b32 v86, 0
    v_mov_b32 v87, 0
    v_mov_b32 v88, 0
    v_mov_b32 v89, v84
    v_mov_b32 v90, 0
    v_mov_b32 v91, 0
    v_cmp_eq_u32 s[32:33], 18, v4
    v_and_b32 v3, 15, v2
    v_lshrrev_b32 v6, 2, v3
    v_and_b32 v3, 3, v3
    v_lshlrev_b32 v7, 3, v5
    v_add_u32 v6, v6, v7
    v_mul_u32_u24 v6, 192, v6
    v_lshlrev_b32 v3, 3, v3
    v_add_u32 v6, v6, v3
    v_lshrrev_b32 v7, 4, v2
    v_and_b32 v7, 1, v7
    v_lshlrev_b32 v7, 5, v7
    v_add_u32 v14, v6, v7
    v_add_u32 v15, 61440, v14
    s_waitcnt vmcnt(24) lgkmcnt(0)
    s_barrier
    ds_read_b64_tr_b16 v[48:49], v14 offset:0
    ds_read_b64_tr_b16 v[50:51], v14 offset:768
    ds_read_b64_tr_b16 v[52:53], v14 offset:64
    ds_read_b64_tr_b16 v[54:55], v14 offset:832
    ds_read_b64_tr_b16 v[56:57], v14 offset:128
    ds_read_b64_tr_b16 v[58:59], v14 offset:896
    ds_read_b64_tr_b16 v[60:61], v14 offset:3072
    ds_read_b64_tr_b16 v[62:63], v14 offset:3840
    ds_read_b64_tr_b16 v[64:65], v14 offset:3136
    ds_read_b64_tr_b16 v[66:67], v14 offset:3904
    ds_read_b64_tr_b16 v[68:69], v14 offset:3200
    ds_read_b64_tr_b16 v[70:71], v14 offset:3968
    s_waitcnt vmcnt(23) lgkmcnt(6)
    v_mfma_f32_32x32x16_bf16 v[128:143], v[48:51], v[16:19], 0
    v_mfma_f32_32x32x16_bf16 v[144:159], v[52:55], v[16:19], 0
    v_mfma_f32_32x32x16_bf16 v[160:175], v[16:19], v[56:59], 0
    s_add_u32 s35, s37, 6144
    buffer_load_dwordx4 v[40:43], v13, s[20:23], s35 offen
    ds_read_b64_tr_b16 v[48:49], v14 offset:6144
    ds_read_b64_tr_b16 v[50:51], v14 offset:6912
    ds_read_b64_tr_b16 v[52:53], v14 offset:6208
    ds_read_b64_tr_b16 v[54:55], v14 offset:6976
    ds_read_b64_tr_b16 v[56:57], v14 offset:6272
    ds_read_b64_tr_b16 v[58:59], v14 offset:7040
    s_waitcnt vmcnt(23) lgkmcnt(6)
    v_mfma_f32_32x32x16_bf16 v[128:143], v[60:63], v[20:23], v[128:143]
    v_mfma_f32_32x32x16_bf16 v[144:159], v[64:67], v[20:23], v[144:159]
    v_mfma_f32_32x32x16_bf16 v[160:175], v[20:23], v[68:71], v[160:175]
    s_add_u32 s35, s37, 7168
    buffer_load_dwordx4 v[44:47], v13, s[20:23], s35 offen
    ds_read_b64_tr_b16 v[60:61], v14 offset:9216
    ds_read_b64_tr_b16 v[62:63], v14 offset:9984
    ds_read_b64_tr_b16 v[64:65], v14 offset:9280
    ds_read_b64_tr_b16 v[66:67], v14 offset:10048
    ds_read_b64_tr_b16 v[68:69], v14 offset:9344
    ds_read_b64_tr_b16 v[70:71], v14 offset:10112
    s_waitcnt vmcnt(23) lgkmcnt(6)
    v_mfma_f32_32x32x16_bf16 v[128:143], v[48:51], v[24:27], v[128:143]
    v_mfma_f32_32x32x16_bf16 v[144:159], v[52:55], v[24:27], v[144:159]
    v_mfma_f32_32x32x16_bf16 v[160:175], v[24:27], v[56:59], v[160:175]
    s_add_u32 s35, s37, 8192
    buffer_load_dwordx4 v[16:19], v13, s[20:23], s35 offen
    ds_read_b64_tr_b16 v[48:49], v14 offset:12288
    ds_read_b64_tr_b16 v[50:51], v14 offset:13056
    ds_read_b64_tr_b16 v[52:53], v14 offset:12352
    ds_read_b64_tr_b16 v[54:55], v14 offset:13120
    ds_read_b64_tr_b16 v[56:57], v14 offset:12416
    ds_read_b64_tr_b16 v[58:59], v14 offset:13184
    s_waitcnt vmcnt(23) lgkmcnt(6)
    v_mfma_f32_32x32x16_bf16 v[128:143], v[60:63], v[28:31], v[128:143]
    v_mfma_f32_32x32x16_bf16 v[144:159], v[64:67], v[28:31], v[144:159]
    v_mfma_f32_32x32x16_bf16 v[160:175], v[28:31], v[68:71], v[160:175]
    s_add_u32 s35, s37, 9216
    buffer_load_dwordx4 v[20:23], v13, s[20:23], s35 offen
    ds_read_b64_tr_b16 v[60:61], v14 offset:15360
    ds_read_b64_tr_b16 v[62:63], v14 offset:16128
    ds_read_b64_tr_b16 v[64:65], v14 offset:15424
    ds_read_b64_tr_b16 v[66:67], v14 offset:16192
    ds_read_b64_tr_b16 v[68:69], v14 offset:15488
    ds_read_b64_tr_b16 v[70:71], v14 offset:16256
    s_waitcnt vmcnt(23) lgkmcnt(6)
    v_mfma_f32_32x32x16_bf16 v[128:143], v[48:51], v[32:35], v[128:143]
    v_mfma_f32_32x32x16_bf16 v[144:159], v[52:55], v[32:35], v[144:159]
    v_mfma_f32_32x32x16_bf16 v[160:175], v[32:35], v[56:59], v[160:175]
    s_add_u32 s35, s37, 10240
    buffer_load_dwordx4 v[24:27], v13, s[20:23], s35 offen
    ds_read_b64_tr_b16 v[48:49], v14 offset:18432
    ds_read_b64_tr_b16 v[50:51], v14 offset:19200
    ds_read_b64_tr_b16 v[52:53], v14 offset:18496
    ds_read_b64_tr_b16 v[54:55], v14 offset:19264
    ds_read_b64_tr_b16 v[56:57], v14 offset:18560
    ds_read_b64_tr_b16 v[58:59], v14 offset:19328
    s_waitcnt vmcnt(23) lgkmcnt(6)
    v_mfma_f32_32x32x16_bf16 v[128:143], v[60:63], v[36:39], v[128:143]
    v_mfma_f32_32x32x16_bf16 v[144:159], v[64:67], v[36:39], v[144:159]
    v_mfma_f32_32x32x16_bf16 v[160:175], v[36:39], v[68:71], v[160:175]
    s_add_u32 s35, s37, 11264
    buffer_load_dwordx4 v[28:31], v13, s[20:23], s35 offen
    ds_read_b64_tr_b16 v[60:61], v14 offset:21504
    ds_read_b64_tr_b16 v[62:63], v14 offset:22272
    ds_read_b64_tr_b16 v[64:65], v14 offset:21568
    ds_read_b64_tr_b16 v[66:67], v14 offset:22336
    ds_read_b64_tr_b16 v[68:69], v14 offset:21632
    ds_read_b64_tr_b16 v[70:71], v14 offset:22400
    s_waitcnt vmcnt(5) lgkmcnt(6)
    v_mfma_f32_32x32x16_bf16 v[128:143], v[48:51], v[40:43], v[128:143]
    v_mfma_f32_32x32x16_bf16 v[144:159], v[52:55], v[40:43], v[144:159]
    v_mfma_f32_32x32x16_bf16 v[160:175], v[40:43], v[56:59], v[160:175]
    s_add_u32 s35, s37, 12288
    buffer_load_dwordx4 v[32:35], v13, s[20:23], s35 offen
    ds_read_b64_tr_b16 v[48:49], v14 offset:24576
    ds_read_b64_tr_b16 v[50:51], v14 offset:25344
    ds_read_b64_tr_b16 v[52:53], v14 offset:24640
    ds_read_b64_tr_b16 v[54:55], v14 offset:25408
    ds_read_b64_tr_b16 v[56:57], v14 offset:24704
    ds_read_b64_tr_b16 v[58:59], v14 offset:25472
    s_waitcnt vmcnt(5) lgkmcnt(6)
    v_mfma_f32_32x32x16_bf16 v[128:143], v[60:63], v[44:47], v[128:143]
    v_mfma_f32_32x32x16_bf16 v[144:159], v[64:67], v[44:47], v[144:159]
    v_mfma_f32_32x32x16_bf16 v[160:175], v[44:47], v[68:71], v[160:175]
    s_add_u32 s35, s37, 13312
    buffer_load_dwordx4 v[36:39], v13, s[20:23], s35 offen
    ds_read_b64_tr_b16 v[60:61], v14 offset:27648
    ds_read_b64_tr_b16 v[62:63], v14 offset:28416
    ds_read_b64_tr_b16 v[64:65], v14 offset:27712
    ds_read_b64_tr_b16 v[66:67], v14 offset:28480
    ds_read_b64_tr_b16 v[68:69], v14 offset:27776
    ds_read_b64_tr_b16 v[70:71], v14 offset:28544
    s_waitcnt vmcnt(5) lgkmcnt(6)
    v_mfma_f32_32x32x16_bf16 v[128:143], v[48:51], v[16:19], v[128:143]
    v_mfma_f32_32x32x16_bf16 v[144:159], v[52:55], v[16:19], v[144:159]
    v_mfma_f32_32x32x16_bf16 v[160:175], v[16:19], v[56:59], v[160:175]
    s_add_u32 s35, s37, 14336
    buffer_load_dwordx4 v[40:43], v13, s[20:23], s35 offen
    ds_read_b64_tr_b16 v[48:49], v14 offset:30720
    ds_read_b64_tr_b16 v[50:51], v14 offset:31488
    ds_read_b64_tr_b16 v[52:53], v14 offset:30784
    ds_read_b64_tr_b16 v[54:55], v14 offset:31552
    ds_read_b64_tr_b16 v[56:57], v14 offset:30848
    ds_read_b64_tr_b16 v[58:59], v14 offset:31616
    s_waitcnt vmcnt(5) lgkmcnt(6)
    v_mfma_f32_32x32x16_bf16 v[128:143], v[60:63], v[20:23], v[128:143]
    v_mfma_f32_32x32x16_bf16 v[144:159], v[64:67], v[20:23], v[144:159]
    v_mfma_f32_32x32x16_bf16 v[160:175], v[20:23], v[68:71], v[160:175]
    s_add_u32 s35, s37, 15360
    buffer_load_dwordx4 v[44:47], v13, s[20:23], s35 offen
    ds_read_b64_tr_b16 v[60:61], v14 offset:33792
    ds_read_b64_tr_b16 v[62:63], v14 offset:34560
    ds_read_b64_tr_b16 v[64:65], v14 offset:33856
    ds_read_b64_tr_b16 v[66:67], v14 offset:34624
    ds_read_b64_tr_b16 v[68:69], v14 offset:33920
    ds_read_b64_tr_b16 v[70:71], v14 offset:34688
    s_waitcnt vmcnt(5) lgkmcnt(6)
    v_mfma_f32_32x32x16_bf16 v[128:143], v[48:51], v[24:27], v[128:143]
    v_mfma_f32_32x32x16_bf16 v[144:159], v[52:55], v[24:27], v[144:159]
    v_mfma_f32_32x32x16_bf16 v[160:175], v[24:27], v[56:59], v[160:175]
    s_add_u32 s35, s37, 16384
    buffer_load_dwordx4 v[16:19], v13, s[20:23], s35 offen
    s_waitcnt vmcnt(5) lgkmcnt(0)
    v_mfma_f32_32x32x16_bf16 v[128:143], v[60:63], v[28:31], v[128:143]
    v_mfma_f32_32x32x16_bf16 v[144:159], v[64:67], v[28:31], v[144:159]
    v_mfma_f32_32x32x16_bf16 v[160:175], v[28:31], v[68:71], v[160:175]
    s_add_u32 s35, s37, 17408
    buffer_load_dwordx4 v[20:23], v13, s[20:23], s35 offen
    s_waitcnt vmcnt(6) lgkmcnt(0)
    s_barrier
    ds_read_b64_tr_b16 v[48:49], v14 offset:36864
    ds_read_b64_tr_b16 v[50:51], v14 offset:37632
    ds_read_b64_tr_b16 v[52:53], v14 offset:36928
    ds_read_b64_tr_b16 v[54:55], v14 offset:37696
    ds_read_b64_tr_b16 v[56:57], v14 offset:36992
    ds_read_b64_tr_b16 v[58:59], v14 offset:37760
    ds_read_b64_tr_b16 v[60:61], v14 offset:39936
    ds_read_b64_tr_b16 v[62:63], v14 offset:40704
    ds_read_b64_tr_b16 v[64:65], v14 offset:40000
    ds_read_b64_tr_b16 v[66:67], v14 offset:40768
    ds_read_b64_tr_b16 v[68:69], v14 offset:40064
    ds_read_b64_tr_b16 v[70:71], v14 offset:40832
    s_waitcnt vmcnt(5) lgkmcnt(6)
    v_mfma_f32_32x32x16_bf16 v[128:143], v[48:51], v[32:35], v[128:143]
    v_mfma_f32_32x32x16_bf16 v[144:159], v[52:55], v[32:35], v[144:159]
    v_mfma_f32_32x32x16_bf16 v[160:175], v[32:35], v[56:59], v[160:175]
    s_add_u32 s35, s37, 18432
    buffer_load_dwordx4 v[24:27], v13, s[20:23], s35 offen
    ds_read_b64_tr_b16 v[48:49], v14 offset:43008
    ds_read_b64_tr_b16 v[50:51], v14 offset:43776
    ds_read_b64_tr_b16 v[52:53], v14 offset:43072
    ds_read_b64_tr_b16 v[54:55], v14 offset:43840
    ds_read_b64_tr_b16 v[56:57], v14 offset:43136
    ds_read_b64_tr_b16 v[58:59], v14 offset:43904
    s_waitcnt vmcnt(5) lgkmcnt(6)
    v_mfma_f32_32x32x16_bf16 v[128:143], v[60:63], v[36:39], v[128:143]
    v_mfma_f32_32x32x16_bf16 v[144:159], v[64:67], v[36:39], v[144:159]
    v_mfma_f32_32x32x16_bf16 v[160:175], v[36:39], v[68:71], v[160:175]
    s_add_u32 s35, s37, 19456
    buffer_load_dwordx4 v[28:31], v13, s[20:23], s35 offen
    ds_read_b64_tr_b16 v[60:61], v14 offset:46080
    ds_read_b64_tr_b16 v[62:63], v14 offset:46848
    ds_read_b64_tr_b16 v[64:65], v14 offset:46144
    ds_read_b64_tr_b16 v[66:67], v14 offset:46912
    ds_read_b64_tr_b16 v[68:69], v14 offset:46208
    ds_read_b64_tr_b16 v[70:71], v14 offset:46976
    s_waitcnt vmcnt(5) lgkmcnt(6)
    v_mfma_f32_32x32x16_bf16 v[128:143], v[48:51], v[40:43], v[128:143]
    v_mfma_f32_32x32x16_bf16 v[144:159], v[52:55], v[40:43], v[144:159]
    v_mfma_f32_32x32x16_bf16 v[160:175], v[40:43], v[56:59], v[160:175]
    s_add_u32 s35, s37, 20480
    buffer_load_dwordx4 v[32:35], v13, s[20:23], s35 offen
    ds_read_b64_tr_b16 v[48:49], v14 offset:49152
    ds_read_b64_tr_b16 v[50:51], v14 offset:49920
    ds_read_b64_tr_b16 v[52:53], v14 offset:49216
    ds_read_b64_tr_b16 v[54:55], v14 offset:49984
    ds_read_b64_tr_b16 v[56:57], v14 offset:49280
    ds_read_b64_tr_b16 v[58:59], v14 offset:50048
    s_waitcnt vmcnt(5) lgkmcnt(6)
    v_mfma_f32_32x32x16_bf16 v[128:143], v[60:63], v[44:47], v[128:143]
    v_mfma_f32_32x32x16_bf16 v[144:159], v[64:67], v[44:47], v[144:159]
    v_mfma_f32_32x32x16_bf16 v[160:175], v[44:47], v[68:71], v[160:175]
    s_add_u32 s35, s37, 21504
    buffer_load_dwordx4 v[36:39], v13, s[20:23], s35 offen
    ds_read_b64_tr_b16 v[60:61], v14 offset:52224
    ds_read_b64_tr_b16 v[62:63], v14 offset:52992
    ds_read_b64_tr_b16 v[64:65], v14 offset:52288
    ds_read_b64_tr_b16 v[66:67], v14 offset:53056
    ds_read_b64_tr_b16 v[68:69], v14 offset:52352
    ds_read_b64_tr_b16 v[70:71], v14 offset:53120
    s_waitcnt vmcnt(5) lgkmcnt(6)
    v_mfma_f32_32x32x16_bf16 v[128:143], v[48:51], v[16:19], v[128:143]
    v_mfma_f32_32x32x16_bf16 v[144:159], v[52:55], v[16:19], v[144:159]
    v_mfma_f32_32x32x16_bf16 v[160:175], v[16:19], v[56:59], v[160:175]
    s_add_u32 s35, s37, 22528
    buffer_load_dwordx4 v[40:43], v13, s[20:23], s35 offen
    ds_read_b64_tr_b16 v[48:49], v14 offset:55296
    ds_read_b64_tr_b16 v[50:51], v14 offset:56064
    ds_read_b64_tr_b16 v[52:53], v14 offset:55360
    ds_read_b64_tr_b16 v[54:55], v14 offset:56128
    ds_read_b64_tr_b16 v[56:57], v14 offset:55424
    ds_read_b64_tr_b16 v[58:59], v14 offset:56192
    s_waitcnt vmcnt(5) lgkmcnt(6)
    v_mfma_f32_32x32x16_bf16 v[128:143], v[60:63], v[20:23], v[128:143]
    v_mfma_f32_32x32x16_bf16 v[144:159], v[64:67], v[20:23], v[144:159]
    v_mfma_f32_32x32x16_bf16 v[160:175], v[20:23], v[68:71], v[160:175]
    s_add_u32 s35, s37, 23552
    buffer_load_dwordx4 v[44:47], v13, s[20:23], s35 offen
    ds_read_b64_tr_b16 v[60:61], v14 offset:58368
    ds_read_b64_tr_b16 v[62:63], v14 offset:59136
    ds_read_b64_tr_b16 v[64:65], v14 offset:58432
    ds_read_b64_tr_b16 v[66:67], v14 offset:59200
    ds_read_b64_tr_b16 v[68:69], v14 offset:58496
    ds_read_b64_tr_b16 v[70:71], v14 offset:59264
    s_waitcnt vmcnt(5) lgkmcnt(6)
    v_mfma_f32_32x32x16_bf16 v[128:143], v[48:51], v[24:27], v[128:143]
    v_mfma_f32_32x32x16_bf16 v[144:159], v[52:55], v[24:27], v[144:159]
    v_mfma_f32_32x32x16_bf16 v[160:175], v[24:27], v[56:59], v[160:175]
    s_add_u32 s35, s37, 24576
    buffer_load_dwordx4 v[16:19], v13, s[20:23], s35 offen
    ds_read_b64_tr_b16 v[48:49], v15 offset:0
    ds_read_b64_tr_b16 v[50:51], v15 offset:768
    ds_read_b64_tr_b16 v[52:53], v15 offset:64
    ds_read_b64_tr_b16 v[54:55], v15 offset:832
    ds_read_b64_tr_b16 v[56:57], v15 offset:128
    ds_read_b64_tr_b16 v[58:59], v15 offset:896
    s_waitcnt vmcnt(5) lgkmcnt(6)
    v_mfma_f32_32x32x16_bf16 v[128:143], v[60:63], v[28:31], v[128:143]
    v_mfma_f32_32x32x16_bf16 v[144:159], v[64:67], v[28:31], v[144:159]
    v_mfma_f32_32x32x16_bf16 v[160:175], v[28:31], v[68:71], v[160:175]
    s_add_u32 s35, s37, 25600
    buffer_load_dwordx4 v[20:23], v13, s[20:23], s35 offen
    ds_read_b64_tr_b16 v[60:61], v15 offset:3072
    ds_read_b64_tr_b16 v[62:63], v15 offset:3840
    ds_read_b64_tr_b16 v[64:65], v15 offset:3136
    ds_read_b64_tr_b16 v[66:67], v15 offset:3904
    ds_read_b64_tr_b16 v[68:69], v15 offset:3200
    ds_read_b64_tr_b16 v[70:71], v15 offset:3968
    s_waitcnt vmcnt(5) lgkmcnt(6)
    v_mfma_f32_32x32x16_bf16 v[128:143], v[48:51], v[32:35], v[128:143]
    v_mfma_f32_32x32x16_bf16 v[144:159], v[52:55], v[32:35], v[144:159]
    v_mfma_f32_32x32x16_bf16 v[160:175], v[32:35], v[56:59], v[160:175]
    s_add_u32 s35, s37, 26624
    buffer_load_dwordx4 v[24:27], v13, s[20:23], s35 offen
    ds_read_b64_tr_b16 v[48:49], v15 offset:6144
    ds_read_b64_tr_b16 v[50:51], v15 offset:6912
    ds_read_b64_tr_b16 v[52:53], v15 offset:6208
    ds_read_b64_tr_b16 v[54:55], v15 offset:6976
    ds_read_b64_tr_b16 v[56:57], v15 offset:6272
    ds_read_b64_tr_b16 v[58:59], v15 offset:7040
    s_waitcnt vmcnt(5) lgkmcnt(6)
    v_mfma_f32_32x32x16_bf16 v[128:143], v[60:63], v[36:39], v[128:143]
    v_mfma_f32_32x32x16_bf16 v[144:159], v[64:67], v[36:39], v[144:159]
    v_mfma_f32_32x32x16_bf16 v[160:175], v[36:39], v[68:71], v[160:175]
    s_add_u32 s35, s37, 27648
    buffer_load_dwordx4 v[28:31], v13, s[20:23], s35 offen
    ds_read_b64_tr_b16 v[60:61], v15 offset:9216
    ds_read_b64_tr_b16 v[62:63], v15 offset:9984
    ds_read_b64_tr_b16 v[64:65], v15 offset:9280
    ds_read_b64_tr_b16 v[66:67], v15 offset:10048
    ds_read_b64_tr_b16 v[68:69], v15 offset:9344
    ds_read_b64_tr_b16 v[70:71], v15 offset:10112
    s_waitcnt vmcnt(5) lgkmcnt(6)
    v_mfma_f32_32x32x16_bf16 v[128:143], v[48:51], v[40:43], v[128:143]
    v_mfma_f32_32x32x16_bf16 v[144:159], v[52:55], v[40:43], v[144:159]
    v_mfma_f32_32x32x16_bf16 v[160:175], v[40:43], v[56:59], v[160:175]
    s_add_u32 s35, s37, 28672
    buffer_load_dwordx4 v[32:35], v13, s[20:23], s35 offen
    s_waitcnt vmcnt(5) lgkmcnt(0)
    v_mfma_f32_32x32x16_bf16 v[128:143], v[60:63], v[44:47], v[128:143]
    v_mfma_f32_32x32x16_bf16 v[144:159], v[64:67], v[44:47], v[144:159]
    v_mfma_f32_32x32x16_bf16 v[160:175], v[44:47], v[68:71], v[160:175]
    s_add_u32 s35, s37, 29696
    buffer_load_dwordx4 v[36:39], v13, s[20:23], s35 offen
    s_waitcnt vmcnt(6) lgkmcnt(0)
    s_barrier
    ds_read_b64_tr_b16 v[48:49], v15 offset:12288
    ds_read_b64_tr_b16 v[50:51], v15 offset:13056
    ds_read_b64_tr_b16 v[52:53], v15 offset:12352
    ds_read_b64_tr_b16 v[54:55], v15 offset:13120
    ds_read_b64_tr_b16 v[56:57], v15 offset:12416
    ds_read_b64_tr_b16 v[58:59], v15 offset:13184
    ds_read_b64_tr_b16 v[60:61], v15 offset:15360
    ds_read_b64_tr_b16 v[62:63], v15 offset:16128
    ds_read_b64_tr_b16 v[64:65], v15 offset:15424
    ds_read_b64_tr_b16 v[66:67], v15 offset:16192
    ds_read_b64_tr_b16 v[68:69], v15 offset:15488
    ds_read_b64_tr_b16 v[70:71], v15 offset:16256
    s_waitcnt vmcnt(5) lgkmcnt(6)
    v_mfma_f32_32x32x16_bf16 v[128:143], v[48:51], v[16:19], v[128:143]
    v_mfma_f32_32x32x16_bf16 v[144:159], v[52:55], v[16:19], v[144:159]
    v_mfma_f32_32x32x16_bf16 v[160:175], v[16:19], v[56:59], v[160:175]
    s_add_u32 s35, s37, 30720
    buffer_load_dwordx4 v[40:43], v13, s[20:23], s35 offen
    ds_read_b64_tr_b16 v[48:49], v15 offset:18432
    ds_read_b64_tr_b16 v[50:51], v15 offset:19200
    ds_read_b64_tr_b16 v[52:53], v15 offset:18496
    ds_read_b64_tr_b16 v[54:55], v15 offset:19264
    ds_read_b64_tr_b16 v[56:57], v15 offset:18560
    ds_read_b64_tr_b16 v[58:59], v15 offset:19328
    s_waitcnt vmcnt(5) lgkmcnt(6)
    v_mfma_f32_32x32x16_bf16 v[128:143], v[60:63], v[20:23], v[128:143]
    v_mfma_f32_32x32x16_bf16 v[144:159], v[64:67], v[20:23], v[144:159]
    v_mfma_f32_32x32x16_bf16 v[160:175], v[20:23], v[68:71], v[160:175]
    s_add_u32 s35, s37, 31744
    buffer_load_dwordx4 v[44:47], v13, s[20:23], s35 offen
    ds_read_b64_tr_b16 v[60:61], v15 offset:21504
    ds_read_b64_tr_b16 v[62:63], v15 offset:22272
    ds_read_b64_tr_b16 v[64:65], v15 offset:21568
    ds_read_b64_tr_b16 v[66:67], v15 offset:22336
    ds_read_b64_tr_b16 v[68:69], v15 offset:21632
    ds_read_b64_tr_b16 v[70:71], v15 offset:22400
    s_waitcnt vmcnt(5) lgkmcnt(6)
    v_mfma_f32_32x32x16_bf16 v[128:143], v[48:51], v[24:27], v[128:143]
    v_mfma_f32_32x32x16_bf16 v[144:159], v[52:55], v[24:27], v[144:159]
    v_mfma_f32_32x32x16_bf16 v[160:175], v[24:27], v[56:59], v[160:175]
    s_add_u32 s35, s37, 32768
    buffer_load_dwordx4 v[16:19], v13, s[20:23], s35 offen
    ds_read_b64_tr_b16 v[48:49], v15 offset:24576
    ds_read_b64_tr_b16 v[50:51], v15 offset:25344
    ds_read_b64_tr_b16 v[52:53], v15 offset:24640
    ds_read_b64_tr_b16 v[54:55], v15 offset:25408
    ds_read_b64_tr_b16 v[56:57], v15 offset:24704
    ds_read_b64_tr_b16 v[58:59], v15 offset:25472
    s_waitcnt vmcnt(5) lgkmcnt(6)
    v_mfma_f32_32x32x16_bf16 v[128:143], v[60:63], v[28:31], v[128:143]
    v_mfma_f32_32x32x16_bf16 v[144:159], v[64:67], v[28:31], v[144:159]
    v_mfma_f32_32x32x16_bf16 v[160:175], v[28:31], v[68:71], v[160:175]
    s_add_u32 s35, s37, 33792
    buffer_load_dwordx4 v[20:23], v13, s[20:23], s35 offen
    ds_read_b64_tr_b16 v[60:61], v15 offset:27648
    ds_read_b64_tr_b16 v[62:63], v15 offset:28416
    ds_read_b64_tr_b16 v[64:65], v15 offset:27712
    ds_read_b64_tr_b16 v[66:67], v15 offset:28480
    ds_read_b64_tr_b16 v[68:69], v15 offset:27776
    ds_read_b64_tr_b16 v[70:71], v15 offset:28544
    s_waitcnt vmcnt(5) lgkmcnt(6)
    v_mfma_f32_32x32x16_bf16 v[128:143], v[48:51], v[32:35], v[128:143]
    v_mfma_f32_32x32x16_bf16 v[144:159], v[52:55], v[32:35], v[144:159]
    v_mfma_f32_32x32x16_bf16 v[160:175], v[32:35], v[56:59], v[160:175]
    s_add_u32 s35, s37, 34816
    buffer_load_dwordx4 v[24:27], v13, s[20:23], s35 offen
    ds_read_b64_tr_b16 v[48:49], v15 offset:30720
    ds_read_b64_tr_b16 v[50:51], v15 offset:31488
    ds_read_b64_tr_b16 v[52:53], v15 offset:30784
    ds_read_b64_tr_b16 v[54:55], v15 offset:31552
    ds_read_b64_tr_b16 v[56:57], v15 offset:30848
    ds_read_b64_tr_b16 v[58:59], v15 offset:31616
    s_waitcnt vmcnt(5) lgkmcnt(6)
    v_mfma_f32_32x32x16_bf16 v[128:143], v[60:63], v[36:39], v[128:143]
    v_mfma_f32_32x32x16_bf16 v[144:159], v[64:67], v[36:39], v[144:159]
    v_mfma_f32_32x32x16_bf16 v[160:175], v[36:39], v[68:71], v[160:175]
    s_add_u32 s35, s37, 35840
    buffer_load_dwordx4 v[28:31], v13, s[20:23], s35 offen
    ds_read_b64_tr_b16 v[60:61], v15 offset:33792
    ds_read_b64_tr_b16 v[62:63], v15 offset:34560
    ds_read_b64_tr_b16 v[64:65], v15 offset:33856
    ds_read_b64_tr_b16 v[66:67], v15 offset:34624
    ds_read_b64_tr_b16 v[68:69], v15 offset:33920
    ds_read_b64_tr_b16 v[70:71], v15 offset:34688
    s_waitcnt vmcnt(5) lgkmcnt(6)
    v_mfma_f32_32x32x16_bf16 v[128:143], v[48:51], v[40:43], v[128:143]
    v_mfma_f32_32x32x16_bf16 v[144:159], v[52:55], v[40:43], v[144:159]
    v_mfma_f32_32x32x16_bf16 v[160:175], v[40:43], v[56:59], v[160:175]
    ds_read_b64_tr_b16 v[48:49], v15 offset:36864
    ds_read_b64_tr_b16 v[50:51], v15 offset:37632
    ds_read_b64_tr_b16 v[52:53], v15 offset:36928
    ds_read_b64_tr_b16 v[54:55], v15 offset:37696
    ds_read_b64_tr_b16 v[56:57], v15 offset:36992
    ds_read_b64_tr_b16 v[58:59], v15 offset:37760
    s_waitcnt vmcnt(4) lgkmcnt(6)
    v_mfma_f32_32x32x16_bf16 v[128:143], v[60:63], v[44:47], v[128:143]
    v_mfma_f32_32x32x16_bf16 v[144:159], v[64:67], v[44:47], v[144:159]
    v_mfma_f32_32x32x16_bf16 v[160:175], v[44:47], v[68:71], v[160:175]
    ds_read_b64_tr_b16 v[60:61], v15 offset:39936
    ds_read_b64_tr_b16 v[62:63], v15 offset:40704
    ds_read_b64_tr_b16 v[64:65], v15 offset:40000
    ds_read_b64_tr_b16 v[66:67], v15 offset:40768
    ds_read_b64_tr_b16 v[68:69], v15 offset:40064
    ds_read_b64_tr_b16 v[70:71], v15 offset:40832
    s_waitcnt vmcnt(3) lgkmcnt(6)
    v_mfma_f32_32x32x16_bf16 v[128:143], v[48:51], v[16:19], v[128:143]
    v_mfma_f32_32x32x16_bf16 v[144:159], v[52:55], v[16:19], v[144:159]
    v_mfma_f32_32x32x16_bf16 v[160:175], v[16:19], v[56:59], v[160:175]
    ds_read_b64_tr_b16 v[48:49], v15 offset:43008
    ds_read_b64_tr_b16 v[50:51], v15 offset:43776
    ds_read_b64_tr_b16 v[52:53], v15 offset:43072
    ds_read_b64_tr_b16 v[54:55], v15 offset:43840
    ds_read_b64_tr_b16 v[56:57], v15 offset:43136
    ds_read_b64_tr_b16 v[58:59], v15 offset:43904
    s_waitcnt vmcnt(2) lgkmcnt(6)
    v_mfma_f32_32x32x16_bf16 v[128:143], v[60:63], v[20:23], v[128:143]
    v_mfma_f32_32x32x16_bf16 v[144:159], v[64:67], v[20:23], v[144:159]
    v_mfma_f32_32x32x16_bf16 v[160:175], v[20:23], v[68:71], v[160:175]
    ds_read_b64_tr_b16 v[60:61], v15 offset:46080
    ds_read_b64_tr_b16 v[62:63], v15 offset:46848
    ds_read_b64_tr_b16 v[64:65], v15 offset:46144
    ds_read_b64_tr_b16 v[66:67], v15 offset:46912
    ds_read_b64_tr_b16 v[68:69], v15 offset:46208
    ds_read_b64_tr_b16 v[70:71], v15 offset:46976
    s_waitcnt vmcnt(1) lgkmcnt(6)
    v_mfma_f32_32x32x16_bf16 v[128:143], v[48:51], v[24:27], v[128:143]
    v_mfma_f32_32x32x16_bf16 v[144:159], v[52:55], v[24:27], v[144:159]
    v_mfma_f32_32x32x16_bf16 v[160:175], v[24:27], v[56:59], v[160:175]
    s_waitcnt vmcnt(0) lgkmcnt(0)
    v_mfma_f32_32x32x16_bf16 v[128:143], v[60:63], v[28:31], v[128:143]
    v_mfma_f32_32x32x16_bf16 v[144:159], v[64:67], v[28:31], v[144:159]
    v_mfma_f32_32x32x16_bf16 v[160:175], v[28:31], v[68:71], v[160:175]
    v_lshl_or_b32 v72, v177, 16, v176
    v_lshl_or_b32 v73, v179, 16, v178
    v_lshl_or_b32 v74, v181, 16, v180
    v_lshl_or_b32 v75, v183, 16, v182
    v_lshl_or_b32 v76, v185, 16, v184
    v_mov_b32 v77, 0
    v_mov_b32 v78, 0
    v_mov_b32 v79, 0
    s_lshl_b32 s36, s36, 5
    s_add_u32 s36, s36, s24
    s_mul_i32 s36, s36, 2304
    s_add_u32 s36, s36, 2621440
    v_cvt_pk_bf16_f32 v64, v144, v145
    v_cvt_pk_bf16_f32 v65, v146, v147
    v_cvt_pk_bf16_f32 v66, v148, v149
    v_cvt_pk_bf16_f32 v67, v150, v151
    v_cvt_pk_bf16_f32 v32, v152, v153
    v_cvt_pk_bf16_f32 v33, v154, v155
    v_cvt_pk_bf16_f32 v34, v156, v157
    v_cvt_pk_bf16_f32 v35, v158, v159
    v_mfma_f32_32x32x16_bf16 v[16:31], v[72:75], v[64:67], 0
    s_nop 0
    v_mfma_f32_32x32x16_bf16 v[16:31], v[76:79], v[32:35], v[16:31]
    v_cvt_pk_bf16_f32 v60, v128, v129
    v_cvt_pk_bf16_f32 v61, v130, v131
    v_cvt_pk_bf16_f32 v62, v132, v133
    v_cvt_pk_bf16_f32 v63, v134, v135
    v_cvt_pk_bf16_f32 v192, v136, v137
    v_cvt_pk_bf16_f32 v193, v138, v139
    v_cvt_pk_bf16_f32 v194, v140, v141
    v_cvt_pk_bf16_f32 v195, v142, v143
    v_mfma_f32_32x32x16_bf16 v[176:191], v[72:75], v[60:63], 0
    s_nop 0
    v_mfma_f32_32x32x16_bf16 v[176:191], v[76:79], v[192:195], v[176:191]
    s_nop 0
    v_cvt_pk_bf16_f32 v32, v16, v17
    v_lshlrev_b32 v16, 16, v32
    v_and_b32 v17, 0xffff0000, v32
    v_cvt_pk_bf16_f32 v32, v18, v19
    v_lshlrev_b32 v18, 16, v32
    v_and_b32 v19, 0xffff0000, v32
    v_cvt_pk_bf16_f32 v32, v20, v21
    v_lshlrev_b32 v20, 16, v32
    v_and_b32 v21, 0xffff0000, v32
    v_cvt_pk_bf16_f32 v32, v22, v23
    v_lshlrev_b32 v22, 16, v32
    v_and_b32 v23, 0xffff0000, v32
    v_cvt_pk_bf16_f32 v32, v24, v25
    v_lshlrev_b32 v24, 16, v32
    v_and_b32 v25, 0xffff0000, v32
    v_cndmask_b32 v33, v24, v16, s[30:31]
    v_cndmask_b32 v34, v25, v16, s[30:31]
    v_max3_f32 v35, v16, v17, v18
    v_min3_f32 v36, v16, v17, v18
    v_max3_f32 v35, v35, v19, v20
    v_min3_f32 v36, v36, v19, v20
    v_max3_f32 v35, v35, v21, v22
    v_min3_f32 v36, v36, v21, v22
    v_max3_f32 v35, v35, v23, v33
    v_min3_f32 v36, v36, v23, v33
    v_max_f32 v35, v35, v34
    v_min_f32 v36, v36, v34
    v_mov_b32 v37, v35
    s_nop 1
    v_permlane32_swap_b32 v35, v37
    v_max_f32 v35, v35, v37
    v_mov_b32 v37, v36
    s_nop 1
    v_permlane32_swap_b32 v36, v37
    v_min_f32 v36, v36, v37
    v_sub_f32 v38, v16, v35
    v_sub_f32 v48, v36, v16
    v_mul_f32 v38, 1069066811, v38
    v_mul_f32 v48, 1069066811, v48
    v_exp_f32 v38, v38
    v_exp_f32 v48, v48
    v_sub_f32 v39, v17, v35
    v_sub_f32 v49, v36, v17
    v_mul_f32 v39, 1069066811, v39
    v_mul_f32 v49, 1069066811, v49
    v_exp_f32 v39, v39
    v_exp_f32 v49, v49
    v_sub_f32 v40, v18, v35
    v_sub_f32 v50, v36, v18
    v_mul_f32 v40, 1069066811, v40
    v_mul_f32 v50, 1069066811, v50
    v_exp_f32 v40, v40
    v_exp_f32 v50, v50
    v_sub_f32 v41, v19, v35
    v_sub_f32 v51, v36, v19
    v_mul_f32 v41, 1069066811, v41
    v_mul_f32 v51, 1069066811, v51
    v_exp_f32 v41, v41
    v_exp_f32 v51, v51
    v_sub_f32 v42, v20, v35
    v_sub_f32 v52, v36, v20
    v_mul_f32 v42, 1069066811, v42
    v_mul_f32 v52, 1069066811, v52
    v_exp_f32 v42, v42
    v_exp_f32 v52, v52
    v_sub_f32 v43, v21, v35
    v_sub_f32 v53, v36, v21
    v_mul_f32 v43, 1069066811, v43
    v_mul_f32 v53, 1069066811, v53
    v_exp_f32 v43, v43
    v_exp_f32 v53, v53
    v_sub_f32 v44, v22, v35
    v_sub_f32 v54, v36, v22
    v_mul_f32 v44, 1069066811, v44
    v_mul_f32 v54, 1069066811, v54
    v_exp_f32 v44, v44
    v_exp_f32 v54, v54
    v_sub_f32 v45, v23, v35
    v_sub_f32 v55, v36, v23
    v_mul_f32 v45, 1069066811, v45
    v_mul_f32 v55, 1069066811, v55
    v_exp_f32 v45, v45
    v_exp_f32 v55, v55
    v_sub_f32 v46, v24, v35
    v_sub_f32 v56, v36, v24
    v_mul_f32 v46, 1069066811, v46
    v_mul_f32 v56, 1069066811, v56
    v_exp_f32 v46, v46
    v_exp_f32 v56, v56
    v_sub_f32 v47, v25, v35
    v_sub_f32 v57, v36, v25
    v_mul_f32 v47, 1069066811, v47
    v_mul_f32 v57, 1069066811, v57
    v_exp_f32 v47, v47
    v_exp_f32 v57, v57
    v_cndmask_b32 v46, v46, 0, s[30:31]
    v_cndmask_b32 v56, v56, 0, s[30:31]
    v_cndmask_b32 v47, v47, 0, s[30:31]
    v_cndmask_b32 v57, v57, 0, s[30:31]
    v_add_f32 v58, v38, v39
    v_add_f32 v59, v48, v49
    v_add_f32 v58, v58, v40
    v_add_f32 v59, v59, v50
    v_add_f32 v58, v58, v41
    v_add_f32 v59, v59, v51
    v_add_f32 v58, v58, v42
    v_add_f32 v59, v59, v52
    v_add_f32 v58, v58, v43
    v_add_f32 v59, v59, v53
    v_add_f32 v58, v58, v44
    v_add_f32 v59, v59, v54
    v_add_f32 v58, v58, v45
    v_add_f32 v59, v59, v55
    v_add_f32 v58, v58, v46
    v_add_f32 v59, v59, v56
    v_add_f32 v58, v58, v47
    v_add_f32 v59, v59, v57
    v_mov_b32 v37, v58
    s_nop 1
    v_permlane32_swap_b32 v58, v37
    v_add_f32 v58, v58, v37
    v_mov_b32 v37, v59
    s_nop 1
    v_permlane32_swap_b32 v59, v37
    v_add_f32 v59, v59, v37
    v_rcp_f32 v58, v58
    v_rcp_f32 v59, v59
    v_mul_f32 v38, v38, v58
    v_mul_f32 v48, v48, v59
    v_mul_f32 v39, v39, v58
    v_mul_f32 v49, v49, v59
    v_mul_f32 v40, v40, v58
    v_mul_f32 v50, v50, v59
    v_mul_f32 v41, v41, v58
    v_mul_f32 v51, v51, v59
    v_mul_f32 v42, v42, v58
    v_mul_f32 v52, v52, v59
    v_mul_f32 v43, v43, v58
    v_mul_f32 v53, v53, v59
    v_mul_f32 v44, v44, v58
    v_mul_f32 v54, v54, v59
    v_mul_f32 v45, v45, v58
    v_mul_f32 v55, v55, v59
    v_mul_f32 v46, v46, v58
    v_mul_f32 v56, v56, v59
    v_mul_f32 v47, v47, v58
    v_mul_f32 v57, v57, v59
    v_cvt_pk_bf16_f32 v68, v38, v39
    v_cvt_pk_bf16_f32 v92, v48, v49
    v_cvt_pk_bf16_f32 v69, v40, v41
    v_cvt_pk_bf16_f32 v93, v50, v51
    v_cvt_pk_bf16_f32 v70, v42, v43
    v_cvt_pk_bf16_f32 v94, v52, v53
    v_cvt_pk_bf16_f32 v71, v44, v45
    v_cvt_pk_bf16_f32 v95, v54, v55
    v_cvt_pk_bf16_f32 v60, v46, v47
    v_cvt_pk_bf16_f32 v61, v56, v57
    v_mov_b32 v62, 0
    v_mov_b32 v63, 0
    v_mfma_f32_32x32x16_bf16 v[16:31], v[68:71], v[80:83], 0
    v_mfma_f32_32x32x16_bf16 v[32:47], v[92:95], v[80:83], 0
    v_mfma_f32_32x32x16_bf16 v[16:31], v[60:63], v[84:87], v[16:31]
    v_mfma_f32_32x32x16_bf16 v[32:47], v[60:63], v[88:91], v[32:47]
    v_cvt_pk_bf16_f32 v48, v160, v161
    v_cvt_pk_bf16_f32 v49, v162, v163
    v_cvt_pk_bf16_f32 v50, v164, v165
    v_cvt_pk_bf16_f32 v51, v166, v167
    v_cvt_pk_bf16_f32 v52, v168, v169
    v_cvt_pk_bf16_f32 v53, v170, v171
    v_cvt_pk_bf16_f32 v54, v172, v173
    v_cvt_pk_bf16_f32 v55, v174, v175
    v_mov_b32 v56, 0x3f803f80
    v_cndmask_b32 v48, v48, v56, s[32:33]
    v_cndmask_b32 v49, v49, v56, s[32:33]
    v_cndmask_b32 v50, v50, v56, s[32:33]
    v_cndmask_b32 v51, v51, v56, s[32:33]
    v_cndmask_b32 v52, v52, v56, s[32:33]
    v_cndmask_b32 v53, v53, v56, s[32:33]
    v_cndmask_b32 v54, v54, v56, s[32:33]
    v_cndmask_b32 v55, v55, v56, s[32:33]
    v_cvt_pk_bf16_f32 v128, v176, v177
    v_lshlrev_b32 v176, 16, v128
    v_and_b32 v177, 0xffff0000, v128
    v_cvt_pk_bf16_f32 v128, v178, v179
    v_lshlrev_b32 v178, 16, v128
    v_and_b32 v179, 0xffff0000, v128
    v_cvt_pk_bf16_f32 v128, v180, v181
    v_lshlrev_b32 v180, 16, v128
    v_and_b32 v181, 0xffff0000, v128
    v_cvt_pk_bf16_f32 v128, v182, v183
    v_lshlrev_b32 v182, 16, v128
    v_and_b32 v183, 0xffff0000, v128
    v_cvt_pk_bf16_f32 v128, v184, v185
    v_lshlrev_b32 v184, 16, v128
    v_and_b32 v185, 0xffff0000, v128
    v_cndmask_b32 v129, v184, v176, s[30:31]
    v_cndmask_b32 v130, v185, v176, s[30:31]
    v_max3_f32 v131, v176, v177, v178
    v_min3_f32 v132, v176, v177, v178
    v_max3_f32 v131, v131, v179, v180
    v_min3_f32 v132, v132, v179, v180
    v_max3_f32 v131, v131, v181, v182
    v_min3_f32 v132, v132, v181, v182
    v_max3_f32 v131, v131, v183, v129
    v_min3_f32 v132, v132, v183, v129
    v_max_f32 v131, v131, v130
    v_min_f32 v132, v132, v130
    v_mov_b32 v133, v131
    s_nop 1
    v_permlane32_swap_b32 v131, v133
    v_max_f32 v131, v131, v133
    v_mov_b32 v133, v132
    s_nop 1
    v_permlane32_swap_b32 v132, v133
    v_min_f32 v132, v132, v133
    v_sub_f32 v134, v176, v131
    v_sub_f32 v144, v132, v176
    v_mul_f32 v134, 1069066811, v134
    v_mul_f32 v144, 1069066811, v144
    v_exp_f32 v134, v134
    v_exp_f32 v144, v144
    v_sub_f32 v135, v177, v131
    v_sub_f32 v145, v132, v177
    v_mul_f32 v135, 1069066811, v135
    v_mul_f32 v145, 1069066811, v145
    v_exp_f32 v135, v135
    v_exp_f32 v145, v145
    v_sub_f32 v136, v178, v131
    v_sub_f32 v146, v132, v178
    v_mul_f32 v136, 1069066811, v136
    v_mul_f32 v146, 1069066811, v146
    v_exp_f32 v136, v136
    v_exp_f32 v146, v146
    v_sub_f32 v137, v179, v131
    v_sub_f32 v147, v132, v179
    v_mul_f32 v137, 1069066811, v137
    v_mul_f32 v147, 1069066811, v147
    v_exp_f32 v137, v137
    v_exp_f32 v147, v147
    v_sub_f32 v138, v180, v131
    v_sub_f32 v148, v132, v180
    v_mul_f32 v138, 1069066811, v138
    v_mul_f32 v148, 1069066811, v148
    v_exp_f32 v138, v138
    v_exp_f32 v148, v148
    v_sub_f32 v139, v181, v131
    v_sub_f32 v149, v132, v181
    v_mul_f32 v139, 1069066811, v139
    v_mul_f32 v149, 1069066811, v149
    v_exp_f32 v139, v139
    v_exp_f32 v149, v149
    v_sub_f32 v140, v182, v131
    v_sub_f32 v150, v132, v182
    v_mul_f32 v140, 1069066811, v140
    v_mul_f32 v150, 1069066811, v150
    v_exp_f32 v140, v140
    v_exp_f32 v150, v150
    v_sub_f32 v141, v183, v131
    v_sub_f32 v151, v132, v183
    v_mul_f32 v141, 1069066811, v141
    v_mul_f32 v151, 1069066811, v151
    v_exp_f32 v141, v141
    v_exp_f32 v151, v151
    v_sub_f32 v142, v184, v131
    v_sub_f32 v152, v132, v184
    v_mul_f32 v142, 1069066811, v142
    v_mul_f32 v152, 1069066811, v152
    v_exp_f32 v142, v142
    v_exp_f32 v152, v152
    v_sub_f32 v143, v185, v131
    v_sub_f32 v153, v132, v185
    v_mul_f32 v143, 1069066811, v143
    v_mul_f32 v153, 1069066811, v153
    v_exp_f32 v143, v143
    v_exp_f32 v153, v153
    v_cndmask_b32 v142, v142, 0, s[30:31]
    v_cndmask_b32 v152, v152, 0, s[30:31]
    v_cndmask_b32 v143, v143, 0, s[30:31]
    v_cndmask_b32 v153, v153, 0, s[30:31]
    v_add_f32 v154, v134, v135
    v_add_f32 v155, v144, v145
    v_add_f32 v154, v154, v136
    v_add_f32 v155, v155, v146
    v_add_f32 v154, v154, v137
    v_add_f32 v155, v155, v147
    v_add_f32 v154, v154, v138
    v_add_f32 v155, v155, v148
    v_add_f32 v154, v154, v139
    v_add_f32 v155, v155, v149
    v_add_f32 v154, v154, v140
    v_add_f32 v155, v155, v150
    v_add_f32 v154, v154, v141
    v_add_f32 v155, v155, v151
    v_add_f32 v154, v154, v142
    v_add_f32 v155, v155, v152
    v_add_f32 v154, v154, v143
    v_add_f32 v155, v155, v153
    v_mov_b32 v133, v154
    s_nop 1
    v_permlane32_swap_b32 v154, v133
    v_add_f32 v154, v154, v133
    v_mov_b32 v133, v155
    s_nop 1
    v_permlane32_swap_b32 v155, v133
    v_add_f32 v155, v155, v133
    v_rcp_f32 v154, v154
    v_rcp_f32 v155, v155
    v_mul_f32 v134, v134, v154
    v_mul_f32 v144, v144, v155
    v_mul_f32 v135, v135, v154
    v_mul_f32 v145, v145, v155
    v_mul_f32 v136, v136, v154
    v_mul_f32 v146, v146, v155
    v_mul_f32 v137, v137, v154
    v_mul_f32 v147, v147, v155
    v_mul_f32 v138, v138, v154
    v_mul_f32 v148, v148, v155
    v_mul_f32 v139, v139, v154
    v_mul_f32 v149, v149, v155
    v_mul_f32 v140, v140, v154
    v_mul_f32 v150, v150, v155
    v_mul_f32 v141, v141, v154
    v_mul_f32 v151, v151, v155
    v_mul_f32 v142, v142, v154
    v_mul_f32 v152, v152, v155
    v_mul_f32 v143, v143, v154
    v_mul_f32 v153, v153, v155
    v_cvt_pk_bf16_f32 v160, v134, v135
    v_cvt_pk_bf16_f32 v164, v144, v145
    v_cvt_pk_bf16_f32 v161, v136, v137
    v_cvt_pk_bf16_f32 v165, v146, v147
    v_cvt_pk_bf16_f32 v162, v138, v139
    v_cvt_pk_bf16_f32 v166, v148, v149
    v_cvt_pk_bf16_f32 v163, v140, v141
    v_cvt_pk_bf16_f32 v167, v150, v151
    v_cvt_pk_bf16_f32 v168, v142, v143
    v_cvt_pk_bf16_f32 v169, v152, v153
    v_mov_b32 v170, 0
    v_mov_b32 v171, 0
    buffer_store_dwordx4 v[160:163], v13, s[20:23], s36 offen
    buffer_store_dwordx4 v[164:167], v13, s[20:23], s36 offen offset:1024
    v_lshlrev_b32 v172, 3, v2
    s_mov_b32 exec_hi, 0
    buffer_store_dwordx2 v[168:169], v172, s[20:23], s36 offen offset:2048
    s_mov_b32 exec_hi, -1
    v_cvt_pk_bf16_f32 v60, v16, v17
    v_cvt_pk_bf16_f32 v61, v18, v19
    v_cvt_pk_bf16_f32 v62, v20, v21
    v_cvt_pk_bf16_f32 v63, v22, v23
    v_cvt_pk_bf16_f32 v64, v24, v25
    v_cvt_pk_bf16_f32 v65, v26, v27
    v_cvt_pk_bf16_f32 v66, v28, v29
    v_cvt_pk_bf16_f32 v67, v30, v31
    v_cvt_pk_bf16_f32 v68, v32, v33
    v_cvt_pk_bf16_f32 v69, v34, v35
    v_cvt_pk_bf16_f32 v70, v36, v37
    v_cvt_pk_bf16_f32 v71, v38, v39
    v_cvt_pk_bf16_f32 v92, v40, v41
    v_cvt_pk_bf16_f32 v93, v42, v43
    v_cvt_pk_bf16_f32 v94, v44, v45
    v_cvt_pk_bf16_f32 v95, v46, v47
    v_mfma_f32_32x32x16_bf16 v[96:111], v[60:63], v[48:51], 0
    v_mfma_f32_32x32x16_bf16 v[112:127], v[68:71], v[48:51], 0
    v_mfma_f32_32x32x16_bf16 v[96:111], v[64:67], v[52:55], v[96:111]
    v_mfma_f32_32x32x16_bf16 v[112:127], v[92:95], v[52:55], v[112:127]
    v_mul_u32_u24 v3, 192, v4
    v_lshlrev_b32 v6, 5, v5
    v_add_u32 v3, v3, v6
    s_mul_i32 s27, s26, 3840
    s_add_u32 s27, s27, 110592
    v_add_u32 v3, s27, v3
    s_mov_b32 exec_lo, 0x7ffff
    s_mov_b32 exec_hi, 0x7ffff
    s_nop 2
    ds_write_b128 v3, v[96:99]
    ds_write_b128 v3, v[100:103] offset:16
    ds_write_b128 v3, v[112:115] offset:64
    ds_write_b128 v3, v[116:119] offset:80
    s_mov_b32 exec_hi, 0
    ds_write_b64 v3, v[104:105] offset:128
    ds_write_b64 v3, v[120:121] offset:136
    s_mov_b64 exec, -1
    s_waitcnt lgkmcnt(0)
    s_barrier
    v_lshlrev_b32 v3, 2, v0
    v_add_u32 v6, 110592, v3
    s_mul_i32 s36, s24, 3840
    s_add_u32 s36, s36, 16384
    v_add_u32 v7, 0, v0
    v_mul_u32_u24 v8, 1366, v7
    v_lshrrev_b32 v8, 16, v8
    v_mul_u32_u24 v8, 48, v8
    v_sub_u32 v8, v7, v8
    v_cmp_gt_u32 vcc, 36, v8
    s_nop 0
    s_mov_b64 s[40:41], vcc
    v_cmp_gt_u32 vcc, 512, v0
    s_nop 0
    s_and_b64 vcc, vcc, s[40:41]
    s_and_saveexec_b64 s[38:39], vcc
    s_cbranch_execz skip_k1_qkv_kernel_3
    ds_read_b32 v16, v6 offset:0
    ds_read_b32 v17, v6 offset:3840
    ds_read_b32 v18, v6 offset:7680
    ds_read_b32 v19, v6 offset:11520
    ds_read_b32 v20, v6 offset:15360
    ds_read_b32 v21, v6 offset:19200
    ds_read_b32 v22, v6 offset:23040
    ds_read_b32 v23, v6 offset:26880
    s_waitcnt lgkmcnt(0)
    v_add_f32 v16, v16, v17
    v_add_f32 v16, v16, v18
    v_add_f32 v16, v16, v19
    v_add_f32 v16, v16, v20
    v_add_f32 v16, v16, v21
    v_add_f32 v16, v16, v22
    v_add_f32 v16, v16, v23
    buffer_atomic_add_f32 v16, v3, s[20:23], s36 offen offset:0
skip_k1_qkv_kernel_3:
    s_mov_b64 exec, s[38:39]
    v_add_u32 v7, 512, v0
    v_mul_u32_u24 v8, 1366, v7
    v_lshrrev_b32 v8, 16, v8
    v_mul_u32_u24 v8, 48, v8
    v_sub_u32 v8, v7, v8
    v_cmp_gt_u32 vcc, 36, v8
    s_nop 0
    s_mov_b64 s[40:41], vcc
    v_cmp_gt_u32 vcc, 400, v0
    s_nop 0
    s_and_b64 vcc, vcc, s[40:41]
    s_and_saveexec_b64 s[38:39], vcc
    s_cbranch_execz skip_k1_qkv_kernel_4
    ds_read_b32 v16, v6 offset:2048
    ds_read_b32 v17, v6 offset:5888
    ds_read_b32 v18, v6 offset:9728
    ds_read_b32 v19, v6 offset:13568
    ds_read_b32 v20, v6 offset:17408
    ds_read_b32 v21, v6 offset:21248
    ds_read_b32 v22, v6 offset:25088
    ds_read_b32 v23, v6 offset:28928
    s_waitcnt lgkmcnt(0)
    v_add_f32 v16, v16, v17
    v_add_f32 v16, v16, v18
    v_add_f32 v16, v16, v19
    v_add_f32 v16, v16, v20
    v_add_f32 v16, v16, v21
    v_add_f32 v16, v16, v22
    v_add_f32 v16, v16, v23
    buffer_atomic_add_f32 v16, v3, s[20:23], s36 offen offset:2048
skip_k1_qkv_kernel_4:
    s_mov_b64 exec, s[38:39]
end_k1_qkv_kernel_1:
    s_endpgm
.globl k2_attn_kernel
.p2align 8
.type k2_attn_kernel,@function
k2_attn_kernel:
    s_load_dwordx2 s[6:7], s[0:1], 0
    s_load_dwordx2 s[8:9], s[0:1], 96
    s_waitcnt lgkmcnt(0)
    s_mov_b32 s16, s6
    s_and_b32 s17, s7, 0xffff
    s_mov_b32 s18, 2359296
    s_mov_b32 s19, 0x00020000
    s_mov_b32 s20, s8
    s_and_b32 s21, s9, 0xffff
    s_mov_b32 s22, 268435456
    s_mov_b32 s23, 0x00020000
    s_cmp_ge_u32 s2, 144
    s_cbranch_scc1 end_k2_attn_kernel_1
    s_mul_i32 s25, s2, 7282
    s_lshr_b32 s25, s25, 16
    s_mul_i32 s24, s25, 9
    s_sub_u32 s24, s2, s24
    v_lshrrev_b32 v1, 6, v0
    v_and_b32 v2, 63, v0
    v_readfirstlane_b32 s26, v1
    v_and_b32 v4, 31, v2
    v_lshrrev_b32 v5, 5, v2
    v_lshlrev_b32 v13, 4, v2
    s_and_b32 s31, s26, 3
    s_lshr_b32 s32, s26, 2
    v_lshlrev_b32 v7, 4, v0
    v_lshlrev_b32 v8, 3, v0
    v_add_u32 v8, 73728, v8
    s_mov_b32 s34, 16384
    buffer_load_dwordx4 v[16:19], v7, s[20:23], s34 offen
    s_mov_b32 s34, 24576
    buffer_load_dwordx4 v[20:23], v7, s[20:23], s34 offen
    s_mov_b32 s34, 32768
    buffer_load_dwordx4 v[24:27], v7, s[20:23], s34 offen
    s_mov_b32 s34, 40960
    buffer_load_dwordx4 v[28:31], v7, s[20:23], s34 offen
    s_mov_b32 s34, 49152
    buffer_load_dwordx4 v[32:35], v7, s[20:23], s34 offen
    s_mov_b32 s34, 57344
    buffer_load_dwordx4 v[36:39], v7, s[20:23], s34 offen
    s_mov_b32 s34, 65536
    buffer_load_dwordx4 v[40:43], v7, s[20:23], s34 offen
    s_mov_b32 s34, 73728
    buffer_load_dwordx4 v[44:47], v7, s[20:23], s34 offen
    s_mov_b32 s34, 81920
    buffer_load_dwordx4 v[48:51], v7, s[20:23], s34 offen
    s_mov_b32 s34, 90112
    buffer_load_dwordx4 v[52:55], v7, s[20:23], s34 offen
    s_mov_b32 s34, 98304
    buffer_load_dwordx4 v[56:59], v7, s[20:23], s34 offen
    s_mov_b32 s34, 106496
    buffer_load_dwordx4 v[60:63], v7, s[20:23], s34 offen
    s_mov_b32 s34, 114688
    buffer_load_dwordx4 v[64:67], v7, s[20:23], s34 offen
    s_mov_b32 s34, 122880
    buffer_load_dwordx4 v[68:71], v7, s[20:23], s34 offen
    s_mov_b32 s34, 131072
    buffer_load_dwordx4 v[72:75], v7, s[20:23], s34 offen
    s_mul_i32 s28, s24, 73728
    s_add_u32 s28, s28, 73793536
    s_lshl_b32 s29, s26, 10
    s_add_u32 s28, s28, s29
    s_add_u32 m0, s29, 0
    s_add_u32 s34, s28, 0
    buffer_load_dwordx4 v13, s[20:23], s34 offen lds
    s_add_u32 m0, s29, 8192
    s_add_u32 s34, s28, 8192
    buffer_load_dwordx4 v13, s[20:23], s34 offen lds
    s_add_u32 m0, s29, 16384
    s_add_u32 s34, s28, 16384
    buffer_load_dwordx4 v13, s[20:23], s34 offen lds
    s_add_u32 m0, s29, 24576
    s_add_u32 s34, s28, 24576
    buffer_load_dwordx4 v13, s[20:23], s34 offen lds
    s_add_u32 m0, s29, 32768
    s_add_u32 s34, s28, 32768
    buffer_load_dwordx4 v13, s[20:23], s34 offen lds
    s_add_u32 m0, s29, 40960
    s_add_u32 s34, s28, 40960
    buffer_load_dwordx4 v13, s[20:23], s34 offen lds
    s_add_u32 m0, s29, 49152
    s_add_u32 s34, s28, 49152
    buffer_load_dwordx4 v13, s[20:23], s34 offen lds
    s_add_u32 m0, s29, 57344
    s_add_u32 s34, s28, 57344
    buffer_load_dwordx4 v13, s[20:23], s34 offen lds
    s_add_u32 m0, s29, 65536
    s_add_u32 s34, s28, 65536
    buffer_load_dwordx4 v13, s[20:23], s34 offen lds
    s_lshl_b32 s36, s25, 2
    s_add_u32 s36, s36, s31
    s_mul_i32 s37, s36, 73728
    s_mul_i32 s27, s32, 36864
    s_add_u32 s37, s37, s27
    s_add_u32 s37, s37, 2621440
    v_lshlrev_b32 v15, 3, v2
    v_mov_b32 v3, 0x7fffff00
    v_cmp_gt_u32 vcc, 32, v2
    s_nop 1
    v_cndmask_b32 v15, v3, v15, vcc
    v_mov_b32 v110, 0
    v_mov_b32 v111, 0
    v_mov_b32 v122, 0
    v_mov_b32 v123, 0
    v_mov_b32 v134, 0
    v_mov_b32 v135, 0
    v_mov_b32 v146, 0
    v_mov_b32 v147, 0
    v_mov_b32 v158, 0
    v_mov_b32 v159, 0
    v_mov_b32 v170, 0
    v_mov_b32 v171, 0
    v_mov_b32 v182, 0
    v_mov_b32 v183, 0
    v_mov_b32 v194, 0
    v_mov_b32 v195, 0
    s_add_u32 s38, s37, 0
    buffer_load_dwordx4 v[100:103], v13, s[20:23], s38 offen offset:0
    buffer_load_dwordx4 v[104:107], v13, s[20:23], s38 offen offset:1024
    buffer_load_dwordx2 v[108:109], v15, s[20:23], s38 offen offset:2048
    s_add_u32 s38, s37, 2304
    buffer_load_dwordx4 v[112:115], v13, s[20:23], s38 offen offset:0
    buffer_load_dwordx4 v[116:119], v13, s[20:23], s38 offen offset:1024
    buffer_load_dwordx2 v[120:121], v15, s[20:23], s38 offen offset:2048
    s_add_u32 s38, s37, 4608
    buffer_load_dwordx4 v[124:127], v13, s[20:23], s38 offen offset:0
    buffer_load_dwordx4 v[128:131], v13, s[20:23], s38 offen offset:1024
    buffer_load_dwordx2 v[132:133], v15, s[20:23], s38 offen offset:2048
    s_add_u32 s38, s37, 6912
    buffer_load_dwordx4 v[136:139], v13, s[20:23], s38 offen offset:0
    buffer_load_dwordx4 v[140:143], v13, s[20:23], s38 offen offset:1024
    buffer_load_dwordx2 v[144:145], v15, s[20:23], s38 offen offset:2048
    s_add_u32 s38, s37, 9216
    buffer_load_dwordx4 v[148:151], v13, s[20:23], s38 offen offset:0
    buffer_load_dwordx4 v[152:155], v13, s[20:23], s38 offen offset:1024
    buffer_load_dwordx2 v[156:157], v15, s[20:23], s38 offen offset:2048
    s_add_u32 s38, s37, 11520
    buffer_load_dwordx4 v[160:163], v13, s[20:23], s38 offen offset:0
    buffer_load_dwordx4 v[164:167], v13, s[20:23], s38 offen offset:1024
    buffer_load_dwordx2 v[168:169], v15, s[20:23], s38 offen offset:2048
    s_add_u32 s38, s37, 13824
    buffer_load_dwordx4 v[172:175], v13, s[20:23], s38 offen offset:0
    buffer_load_dwordx4 v[176:179], v13, s[20:23], s38 offen offset:1024
    buffer_load_dwordx2 v[180:181], v15, s[20:23], s38 offen offset:2048
    s_waitcnt vmcnt(44)
    v_cvt_pk_bf16_f32 v16, v16, v17
    v_cvt_pk_bf16_f32 v17, v18, v19
    ds_write_b64 v8, v[16:17] offset:0
    s_waitcnt vmcnt(43)
    v_cvt_pk_bf16_f32 v20, v20, v21
    v_cvt_pk_bf16_f32 v21, v22, v23
    ds_write_b64 v8, v[20:21] offset:4096
    s_waitcnt vmcnt(42)
    v_cvt_pk_bf16_f32 v24, v24, v25
    v_cvt_pk_bf16_f32 v25, v26, v27
    ds_write_b64 v8, v[24:25] offset:8192
    s_waitcnt vmcnt(41)
    v_cvt_pk_bf16_f32 v28, v28, v29
    v_cvt_pk_bf16_f32 v29, v30, v31
    ds_write_b64 v8, v[28:29] offset:12288
    s_waitcnt vmcnt(40)
    v_cvt_pk_bf16_f32 v32, v32, v33
    v_cvt_pk_bf16_f32 v33, v34, v35
    ds_write_b64 v8, v[32:33] offset:16384
    s_waitcnt vmcnt(39)
    v_cvt_pk_bf16_f32 v36, v36, v37
    v_cvt_pk_bf16_f32 v37, v38, v39
    ds_write_b64 v8, v[36:37] offset:20480
    s_waitcnt vmcnt(38)
    v_cvt_pk_bf16_f32 v40, v40, v41
    v_cvt_pk_bf16_f32 v41, v42, v43
    ds_write_b64 v8, v[40:41] offset:24576
    s_waitcnt vmcnt(37)
    v_cvt_pk_bf16_f32 v44, v44, v45
    v_cvt_pk_bf16_f32 v45, v46, v47
    ds_write_b64 v8, v[44:45] offset:28672
    s_waitcnt vmcnt(36)
    v_cvt_pk_bf16_f32 v48, v48, v49
    v_cvt_pk_bf16_f32 v49, v50, v51
    ds_write_b64 v8, v[48:49] offset:32768
    s_waitcnt vmcnt(35)
    v_cvt_pk_bf16_f32 v52, v52, v53
    v_cvt_pk_bf16_f32 v53, v54, v55
    ds_write_b64 v8, v[52:53] offset:36864
    s_waitcnt vmcnt(34)
    v_cvt_pk_bf16_f32 v56, v56, v57
    v_cvt_pk_bf16_f32 v57, v58, v59
    ds_write_b64 v8, v[56:57] offset:40960
    s_waitcnt vmcnt(33)
    v_cvt_pk_bf16_f32 v60, v60, v61
    v_cvt_pk_bf16_f32 v61, v62, v63
    ds_write_b64 v8, v[60:61] offset:45056
    s_waitcnt vmcnt(32)
    v_cvt_pk_bf16_f32 v64, v64, v65
    v_cvt_pk_bf16_f32 v65, v66, v67
    ds_write_b64 v8, v[64:65] offset:49152
    s_waitcnt vmcnt(31)
    v_cvt_pk_bf16_f32 v68, v68, v69
    v_cvt_pk_bf16_f32 v69, v70, v71
    ds_write_b64 v8, v[68:69] offset:53248
    s_waitcnt vmcnt(30)
    v_cvt_pk_bf16_f32 v72, v72, v73
    v_cvt_pk_bf16_f32 v73, v74, v75
    ds_write_b64 v8, v[72:73] offset:57344
    v_cmp_gt_u32 vcc, 19, v4
    v_mov_b32 v9, 19
    s_nop 0
    v_cndmask_b32 v9, v9, v4, vcc
    v_cmp_eq_u32 vcc, 22, v4
    s_nop 1
    v_cndmask_b32 v9, v9, 18, vcc
    v_mul_u32_u24 v9, 96, v9
    v_lshlrev_b32 v10, 4, v5
    v_add_u32 v9, v9, v10
    s_mul_i32 s27, s32, 30720
    s_add_u32 s27, s27, 73728
    v_add_u32 v9, s27, v9
    v_and_b32 v3, 15, v2
    v_lshrrev_b32 v6, 2, v3
    v_and_b32 v3, 3, v3
    v_lshlrev_b32 v3, 3, v3
    v_lshrrev_b32 v7, 4, v2
    v_and_b32 v7, 1, v7
    v_lshlrev_b32 v7, 5, v7
    v_add_u32 v3, v3, v7
    s_mul_i32 s27, s32, 18432
    v_add_u32 v3, s27, v3
    v_lshlrev_b32 v7, 2, v5
    v_add_u32 v7, v7, v6
    v_lshlrev_b32 v7, 6, v7
    v_add_u32 v10, v3, v7
    v_add_u32 v11, 36864, v10
    v_lshrrev_b32 v7, 1, v6
    v_mul_u32_u24 v7, 18, v7
    v_and_b32 v8, 1, v6
    v_add_u32 v7, v7, v8
    v_lshlrev_b32 v7, 6, v7
    v_add_u32 v12, v3, v7
    v_add_u32 v14, 36864, v12
    s_waitcnt vmcnt(21) lgkmcnt(0)
    s_barrier
    s_add_u32 s38, s37, 16128
    buffer_load_dwordx4 v[184:187], v13, s[20:23], s38 offen offset:0
    buffer_load_dwordx4 v[188:191], v13, s[20:23], s38 offen offset:1024
    buffer_load_dwordx2 v[192:193], v15, s[20:23], s38 offen offset:2048
    ds_read_b128 v[76:79], v9 offset:0
    ds_read_b128 v[80:83], v9 offset:32
    ds_read_b128 v[84:87], v9 offset:64
    ds_read_b64_tr_b16 v[88:89], v10 offset:0
    ds_read_b64_tr_b16 v[90:91], v10 offset:512
    ds_read_b64_tr_b16 v[92:93], v11 offset:0
    ds_read_b64_tr_b16 v[94:95], v11 offset:512
    s_waitcnt vmcnt(21) lgkmcnt(4)
    v_mfma_f32_32x32x16_bf16 v[16:31], v[76:79], v[100:103], 0
    v_mfma_f32_32x32x16_bf16 v[16:31], v[80:83], v[104:107], v[16:31]
    v_mfma_f32_32x32x16_bf16 v[16:31], v[84:87], v[108:111], v[16:31]
    s_nop 11
    v_cvt_pk_bf16_f32 v40, v16, v17
    v_lshlrev_b32 v16, 16, v40
    v_and_b32 v17, 0xffff0000, v40
    v_cvt_pk_bf16_f32 v41, v18, v19
    v_lshlrev_b32 v18, 16, v41
    v_and_b32 v19, 0xffff0000, v41
    v_cvt_pk_bf16_f32 v40, v20, v21
    v_lshlrev_b32 v20, 16, v40
    v_and_b32 v21, 0xffff0000, v40
    v_cvt_pk_bf16_f32 v41, v22, v23
    v_lshlrev_b32 v22, 16, v41
    v_and_b32 v23, 0xffff0000, v41
    v_cvt_pk_bf16_f32 v40, v24, v25
    v_lshlrev_b32 v24, 16, v40
    v_and_b32 v25, 0xffff0000, v40
    v_cvt_pk_bf16_f32 v42, v26, v26
    v_lshlrev_b32 v26, 16, v42
    v_add_f32 v26, 0x358637bd, v26
    v_cvt_pk_bf16_f32 v42, v26, v26
    v_lshlrev_b32 v26, 16, v42
    v_rcp_f32 v26, v26
    s_nop 0
    v_mul_f32 v16, v16, v26
    v_mul_f32 v17, v17, v26
    v_mul_f32 v18, v18, v26
    v_mul_f32 v19, v19, v26
    v_mul_f32 v20, v20, v26
    v_mul_f32 v21, v21, v26
    v_mul_f32 v22, v22, v26
    v_mul_f32 v23, v23, v26
    v_mul_f32 v24, v24, v26
    v_mul_f32 v25, v25, v26
    v_cvt_pk_bf16_f32 v32, v16, v17
    v_cvt_pk_bf16_f32 v33, v18, v19
    v_cvt_pk_bf16_f32 v34, v20, v21
    v_cvt_pk_bf16_f32 v35, v22, v23
    v_cvt_pk_bf16_f32 v36, v24, v25
    s_waitcnt lgkmcnt(0)
    v_mfma_f32_32x32x16_bf16 v[44:59], v[88:91], v[32:35], 0
    v_mfma_f32_32x32x16_bf16 v[60:75], v[92:95], v[32:35], 0
    s_add_u32 s38, s37, 18432
    buffer_load_dwordx4 v[100:103], v13, s[20:23], s38 offen offset:0
    buffer_load_dwordx4 v[104:107], v13, s[20:23], s38 offen offset:1024
    buffer_load_dwordx2 v[108:109], v15, s[20:23], s38 offen offset:2048
    ds_read_b128 v[76:79], v9 offset:1920
    ds_read_b128 v[80:83], v9 offset:1952
    ds_read_b128 v[84:87], v9 offset:1984
    ds_read_b64_tr_b16 v[88:89], v10 offset:1152
    ds_read_b64_tr_b16 v[90:91], v10 offset:1664
    ds_read_b64_tr_b16 v[92:93], v11 offset:1152
    ds_read_b64_tr_b16 v[94:95], v11 offset:1664
    s_waitcnt vmcnt(21) lgkmcnt(4)
    v_mfma_f32_32x32x16_bf16 v[16:31], v[76:79], v[112:115], 0
    v_mfma_f32_32x32x16_bf16 v[16:31], v[80:83], v[116:119], v[16:31]
    v_mfma_f32_32x32x16_bf16 v[16:31], v[84:87], v[120:123], v[16:31]
    s_nop 11
    v_cvt_pk_bf16_f32 v40, v16, v17
    v_lshlrev_b32 v16, 16, v40
    v_and_b32 v17, 0xffff0000, v40
    v_cvt_pk_bf16_f32 v41, v18, v19
    v_lshlrev_b32 v18, 16, v41
    v_and_b32 v19, 0xffff0000, v41
    v_cvt_pk_bf16_f32 v40, v20, v21
    v_lshlrev_b32 v20, 16, v40
    v_and_b32 v21, 0xffff0000, v40
    v_cvt_pk_bf16_f32 v41, v22, v23
    v_lshlrev_b32 v22, 16, v41
    v_and_b32 v23, 0xffff0000, v41
    v_cvt_pk_bf16_f32 v40, v24, v25
    v_lshlrev_b32 v24, 16, v40
    v_and_b32 v25, 0xffff0000, v40
    v_cvt_pk_bf16_f32 v42, v26, v26
    v_lshlrev_b32 v26, 16, v42
    v_add_f32 v26, 0x358637bd, v26
    v_cvt_pk_bf16_f32 v42, v26, v26
    v_lshlrev_b32 v26, 16, v42
    v_rcp_f32 v26, v26
    s_nop 0
    v_mul_f32 v16, v16, v26
    v_mul_f32 v17, v17, v26
    v_mul_f32 v18, v18, v26
    v_mul_f32 v19, v19, v26
    v_mul_f32 v20, v20, v26
    v_mul_f32 v21, v21, v26
    v_mul_f32 v22, v22, v26
    v_mul_f32 v23, v23, v26
    v_mul_f32 v24, v24, v26
    v_mul_f32 v25, v25, v26
    v_cvt_pk_bf16_f32 v32, v16, v17
    v_cvt_pk_bf16_f32 v33, v18, v19
    v_cvt_pk_bf16_f32 v34, v20, v21
    v_cvt_pk_bf16_f32 v35, v22, v23
    v_cvt_pk_bf16_f32 v37, v24, v25
    s_waitcnt lgkmcnt(0)
    v_mfma_f32_32x32x16_bf16 v[44:59], v[88:91], v[32:35], v[44:59]
    v_mfma_f32_32x32x16_bf16 v[60:75], v[92:95], v[32:35], v[60:75]
    s_add_u32 s38, s37, 20736
    buffer_load_dwordx4 v[112:115], v13, s[20:23], s38 offen offset:0
    buffer_load_dwordx4 v[116:119], v13, s[20:23], s38 offen offset:1024
    buffer_load_dwordx2 v[120:121], v15, s[20:23], s38 offen offset:2048
    ds_read_b128 v[76:79], v9 offset:3840
    ds_read_b128 v[80:83], v9 offset:3872
    ds_read_b128 v[84:87], v9 offset:3904
    ds_read_b64_tr_b16 v[88:89], v10 offset:2304
    ds_read_b64_tr_b16 v[90:91], v10 offset:2816
    ds_read_b64_tr_b16 v[92:93], v11 offset:2304
    ds_read_b64_tr_b16 v[94:95], v11 offset:2816
    s_waitcnt vmcnt(21) lgkmcnt(4)
    v_mfma_f32_32x32x16_bf16 v[16:31], v[76:79], v[124:127], 0
    v_mfma_f32_32x32x16_bf16 v[16:31], v[80:83], v[128:131], v[16:31]
    v_mfma_f32_32x32x16_bf16 v[16:31], v[84:87], v[132:135], v[16:31]
    s_nop 11
    v_cvt_pk_bf16_f32 v40, v16, v17
    v_lshlrev_b32 v16, 16, v40
    v_and_b32 v17, 0xffff0000, v40
    v_cvt_pk_bf16_f32 v41, v18, v19
    v_lshlrev_b32 v18, 16, v41
    v_and_b32 v19, 0xffff0000, v41
    v_cvt_pk_bf16_f32 v40, v20, v21
    v_lshlrev_b32 v20, 16, v40
    v_and_b32 v21, 0xffff0000, v40
    v_cvt_pk_bf16_f32 v41, v22, v23
    v_lshlrev_b32 v22, 16, v41
    v_and_b32 v23, 0xffff0000, v41
    v_cvt_pk_bf16_f32 v40, v24, v25
    v_lshlrev_b32 v24, 16, v40
    v_and_b32 v25, 0xffff0000, v40
    v_cvt_pk_bf16_f32 v42, v26, v26
    v_lshlrev_b32 v26, 16, v42
    v_add_f32 v26, 0x358637bd, v26
    v_cvt_pk_bf16_f32 v42, v26, v26
    v_lshlrev_b32 v26, 16, v42
    v_rcp_f32 v26, v26
    s_nop 0
    v_mul_f32 v16, v16, v26
    v_mul_f32 v17, v17, v26
    v_mul_f32 v18, v18, v26
    v_mul_f32 v19, v19, v26
    v_mul_f32 v20, v20, v26
    v_mul_f32 v21, v21, v26
    v_mul_f32 v22, v22, v26
    v_mul_f32 v23, v23, v26
    v_mul_f32 v24, v24, v26
    v_mul_f32 v25, v25, v26
    v_cvt_pk_bf16_f32 v32, v16, v17
    v_cvt_pk_bf16_f32 v33, v18, v19
    v_cvt_pk_bf16_f32 v34, v20, v21
    v_cvt_pk_bf16_f32 v35, v22, v23
    v_cvt_pk_bf16_f32 v38, v24, v25
    s_waitcnt lgkmcnt(0)
    v_mfma_f32_32x32x16_bf16 v[44:59], v[88:91], v[32:35], v[44:59]
    v_mfma_f32_32x32x16_bf16 v[60:75], v[92:95], v[32:35], v[60:75]
    s_add_u32 s38, s37, 23040
    buffer_load_dwordx4 v[124:127], v13, s[20:23], s38 offen offset:0
    buffer_load_dwordx4 v[128:131], v13, s[20:23], s38 offen offset:1024
    buffer_load_dwordx2 v[132:133], v15, s[20:23], s38 offen offset:2048
    ds_read_b128 v[76:79], v9 offset:5760
    ds_read_b128 v[80:83], v9 offset:5792
    ds_read_b128 v[84:87], v9 offset:5824
    ds_read_b64_tr_b16 v[88:89], v10 offset:3456
    ds_read_b64_tr_b16 v[90:91], v10 offset:3968
    ds_read_b64_tr_b16 v[92:93], v11 offset:3456
    ds_read_b64_tr_b16 v[94:95], v11 offset:3968
    s_waitcnt vmcnt(21) lgkmcnt(4)
    v_mfma_f32_32x32x16_bf16 v[16:31], v[76:79], v[136:139], 0
    v_mfma_f32_32x32x16_bf16 v[16:31], v[80:83], v[140:143], v[16:31]
    v_mfma_f32_32x32x16_bf16 v[16:31], v[84:87], v[144:147], v[16:31]
    s_nop 11
    v_cvt_pk_bf16_f32 v40, v16, v17
    v_lshlrev_b32 v16, 16, v40
    v_and_b32 v17, 0xffff0000, v40
    v_cvt_pk_bf16_f32 v41, v18, v19
    v_lshlrev_b32 v18, 16, v41
    v_and_b32 v19, 0xffff0000, v41
    v_cvt_pk_bf16_f32 v40, v20, v21
    v_lshlrev_b32 v20, 16, v40
    v_and_b32 v21, 0xffff0000, v40
    v_cvt_pk_bf16_f32 v41, v22, v23
    v_lshlrev_b32 v22, 16, v41
    v_and_b32 v23, 0xffff0000, v41
    v_cvt_pk_bf16_f32 v40, v24, v25
    v_lshlrev_b32 v24, 16, v40
    v_and_b32 v25, 0xffff0000, v40
    v_cvt_pk_bf16_f32 v42, v26, v26
    v_lshlrev_b32 v26, 16, v42
    v_add_f32 v26, 0x358637bd, v26
    v_cvt_pk_bf16_f32 v42, v26, v26
    v_lshlrev_b32 v26, 16, v42
    v_rcp_f32 v26, v26
    s_nop 0
    v_mul_f32 v16, v16, v26
    v_mul_f32 v17, v17, v26
    v_mul_f32 v18, v18, v26
    v_mul_f32 v19, v19, v26
    v_mul_f32 v20, v20, v26
    v_mul_f32 v21, v21, v26
    v_mul_f32 v22, v22, v26
    v_mul_f32 v23, v23, v26
    v_mul_f32 v24, v24, v26
    v_mul_f32 v25, v25, v26
    v_cvt_pk_bf16_f32 v32, v16, v17
    v_cvt_pk_bf16_f32 v33, v18, v19
    v_cvt_pk_bf16_f32 v34, v20, v21
    v_cvt_pk_bf16_f32 v35, v22, v23
    v_cvt_pk_bf16_f32 v39, v24, v25
    s_waitcnt lgkmcnt(0)
    v_mfma_f32_32x32x16_bf16 v[44:59], v[88:91], v[32:35], v[44:59]
    v_mfma_f32_32x32x16_bf16 v[60:75], v[92:95], v[32:35], v[60:75]
    ds_read_b64_tr_b16 v[88:89], v12 offset:1024
    ds_read_b64_tr_b16 v[90:91], v12 offset:3328
    ds_read_b64_tr_b16 v[92:93], v14 offset:1024
    ds_read_b64_tr_b16 v[94:95], v14 offset:3328
    s_waitcnt lgkmcnt(0)
    v_mfma_f32_32x32x16_bf16 v[44:59], v[88:91], v[36:39], v[44:59]
    v_mfma_f32_32x32x16_bf16 v[60:75], v[92:95], v[36:39], v[60:75]
    s_add_u32 s38, s37, 25344
    buffer_load_dwordx4 v[136:139], v13, s[20:23], s38 offen offset:0
    buffer_load_dwordx4 v[140:143], v13, s[20:23], s38 offen offset:1024
    buffer_load_dwordx2 v[144:145], v15, s[20:23], s38 offen offset:2048
    ds_read_b128 v[76:79], v9 offset:7680
    ds_read_b128 v[80:83], v9 offset:7712
    ds_read_b128 v[84:87], v9 offset:7744
    ds_read_b64_tr_b16 v[88:89], v10 offset:4608
    ds_read_b64_tr_b16 v[90:91], v10 offset:5120
    ds_read_b64_tr_b16 v[92:93], v11 offset:4608
    ds_read_b64_tr_b16 v[94:95], v11 offset:5120
    s_waitcnt vmcnt(21) lgkmcnt(4)
    v_mfma_f32_32x32x16_bf16 v[16:31], v[76:79], v[148:151], 0
    v_mfma_f32_32x32x16_bf16 v[16:31], v[80:83], v[152:155], v[16:31]
    v_mfma_f32_32x32x16_bf16 v[16:31], v[84:87], v[156:159], v[16:31]
    s_nop 11
    v_cvt_pk_bf16_f32 v40, v16, v17
    v_lshlrev_b32 v16, 16, v40
    v_and_b32 v17, 0xffff0000, v40
    v_cvt_pk_bf16_f32 v41, v18, v19
    v_lshlrev_b32 v18, 16, v41
    v_and_b32 v19, 0xffff0000, v41
    v_cvt_pk_bf16_f32 v40, v20, v21
    v_lshlrev_b32 v20, 16, v40
    v_and_b32 v21, 0xffff0000, v40
    v_cvt_pk_bf16_f32 v41, v22, v23
    v_lshlrev_b32 v22, 16, v41
    v_and_b32 v23, 0xffff0000, v41
    v_cvt_pk_bf16_f32 v40, v24, v25
    v_lshlrev_b32 v24, 16, v40
    v_and_b32 v25, 0xffff0000, v40
    v_cvt_pk_bf16_f32 v42, v26, v26
    v_lshlrev_b32 v26, 16, v42
    v_add_f32 v26, 0x358637bd, v26
    v_cvt_pk_bf16_f32 v42, v26, v26
    v_lshlrev_b32 v26, 16, v42
    v_rcp_f32 v26, v26
    s_nop 0
    v_mul_f32 v16, v16, v26
    v_mul_f32 v17, v17, v26
    v_mul_f32 v18, v18, v26
    v_mul_f32 v19, v19, v26
    v_mul_f32 v20, v20, v26
    v_mul_f32 v21, v21, v26
    v_mul_f32 v22, v22, v26
    v_mul_f32 v23, v23, v26
    v_mul_f32 v24, v24, v26
    v_mul_f32 v25, v25, v26
    v_cvt_pk_bf16_f32 v32, v16, v17
    v_cvt_pk_bf16_f32 v33, v18, v19
    v_cvt_pk_bf16_f32 v34, v20, v21
    v_cvt_pk_bf16_f32 v35, v22, v23
    v_cvt_pk_bf16_f32 v36, v24, v25
    s_waitcnt lgkmcnt(0)
    v_mfma_f32_32x32x16_bf16 v[44:59], v[88:91], v[32:35], v[44:59]
    v_mfma_f32_32x32x16_bf16 v[60:75], v[92:95], v[32:35], v[60:75]
    s_add_u32 s38, s37, 27648
    buffer_load_dwordx4 v[148:151], v13, s[20:23], s38 offen offset:0
    buffer_load_dwordx4 v[152:155], v13, s[20:23], s38 offen offset:1024
    buffer_load_dwordx2 v[156:157], v15, s[20:23], s38 offen offset:2048
    ds_read_b128 v[76:79], v9 offset:9600
    ds_read_b128 v[80:83], v9 offset:9632
    ds_read_b128 v[84:87], v9 offset:9664
    ds_read_b64_tr_b16 v[88:89], v10 offset:5760
    ds_read_b64_tr_b16 v[90:91], v10 offset:6272
    ds_read_b64_tr_b16 v[92:93], v11 offset:5760
    ds_read_b64_tr_b16 v[94:95], v11 offset:6272
    s_waitcnt vmcnt(21) lgkmcnt(4)
    v_mfma_f32_32x32x16_bf16 v[16:31], v[76:79], v[160:163], 0
    v_mfma_f32_32x32x16_bf16 v[16:31], v[80:83], v[164:167], v[16:31]
    v_mfma_f32_32x32x16_bf16 v[16:31], v[84:87], v[168:171], v[16:31]
    s_nop 11
    v_cvt_pk_bf16_f32 v40, v16, v17
    v_lshlrev_b32 v16, 16, v40
    v_and_b32 v17, 0xffff0000, v40
    v_cvt_pk_bf16_f32 v41, v18, v19
    v_lshlrev_b32 v18, 16, v41
    v_and_b32 v19, 0xffff0000, v41
    v_cvt_pk_bf16_f32 v40, v20, v21
    v_lshlrev_b32 v20, 16, v40
    v_and_b32 v21, 0xffff0000, v40
    v_cvt_pk_bf16_f32 v41, v22, v23
    v_lshlrev_b32 v22, 16, v41
    v_and_b32 v23, 0xffff0000, v41
    v_cvt_pk_bf16_f32 v40, v24, v25
    v_lshlrev_b32 v24, 16, v40
    v_and_b32 v25, 0xffff0000, v40
    v_cvt_pk_bf16_f32 v42, v26, v26
    v_lshlrev_b32 v26, 16, v42
    v_add_f32 v26, 0x358637bd, v26
    v_cvt_pk_bf16_f32 v42, v26, v26
    v_lshlrev_b32 v26, 16, v42
    v_rcp_f32 v26, v26
    s_nop 0
    v_mul_f32 v16, v16, v26
    v_mul_f32 v17, v17, v26
    v_mul_f32 v18, v18, v26
    v_mul_f32 v19, v19, v26
    v_mul_f32 v20, v20, v26
    v_mul_f32 v21, v21, v26
    v_mul_f32 v22, v22, v26
    v_mul_f32 v23, v23, v26
    v_mul_f32 v24, v24, v26
    v_mul_f32 v25, v25, v26
    v_cvt_pk_bf16_f32 v32, v16, v17
    v_cvt_pk_bf16_f32 v33, v18, v19
    v_cvt_pk_bf16_f32 v34, v20, v21
    v_cvt_pk_bf16_f32 v35, v22, v23
    v_cvt_pk_bf16_f32 v37, v24, v25
    s_waitcnt lgkmcnt(0)
    v_mfma_f32_32x32x16_bf16 v[44:59], v[88:91], v[32:35], v[44:59]
    v_mfma_f32_32x32x16_bf16 v[60:75], v[92:95], v[32:35], v[60:75]
    s_add_u32 s38, s37, 29952
    buffer_load_dwordx4 v[160:163], v13, s[20:23], s38 offen offset:0
    buffer_load_dwordx4 v[164:167], v13, s[20:23], s38 offen offset:1024
    buffer_load_dwordx2 v[168:169], v15, s[20:23], s38 offen offset:2048
    ds_read_b128 v[76:79], v9 offset:11520
    ds_read_b128 v[80:83], v9 offset:11552
    ds_read_b128 v[84:87], v9 offset:11584
    ds_read_b64_tr_b16 v[88:89], v10 offset:6912
    ds_read_b64_tr_b16 v[90:91], v10 offset:7424
    ds_read_b64_tr_b16 v[92:93], v11 offset:6912
    ds_read_b64_tr_b16 v[94:95], v11 offset:7424
    s_waitcnt vmcnt(21) lgkmcnt(4)
    v_mfma_f32_32x32x16_bf16 v[16:31], v[76:79], v[172:175], 0
    v_mfma_f32_32x32x16_bf16 v[16:31], v[80:83], v[176:179], v[16:31]
    v_mfma_f32_32x32x16_bf16 v[16:31], v[84:87], v[180:183], v[16:31]
    s_nop 11
    v_cvt_pk_bf16_f32 v40, v16, v17
    v_lshlrev_b32 v16, 16, v40
    v_and_b32 v17, 0xffff0000, v40
    v_cvt_pk_bf16_f32 v41, v18, v19
    v_lshlrev_b32 v18, 16, v41
    v_and_b32 v19, 0xffff0000, v41
    v_cvt_pk_bf16_f32 v40, v20, v21
    v_lshlrev_b32 v20, 16, v40
    v_and_b32 v21, 0xffff0000, v40
    v_cvt_pk_bf16_f32 v41, v22, v23
    v_lshlrev_b32 v22, 16, v41
    v_and_b32 v23, 0xffff0000, v41
    v_cvt_pk_bf16_f32 v40, v24, v25
    v_lshlrev_b32 v24, 16, v40
    v_and_b32 v25, 0xffff0000, v40
    v_cvt_pk_bf16_f32 v42, v26, v26
    v_lshlrev_b32 v26, 16, v42
    v_add_f32 v26, 0x358637bd, v26
    v_cvt_pk_bf16_f32 v42, v26, v26
    v_lshlrev_b32 v26, 16, v42
    v_rcp_f32 v26, v26
    s_nop 0
    v_mul_f32 v16, v16, v26
    v_mul_f32 v17, v17, v26
    v_mul_f32 v18, v18, v26
    v_mul_f32 v19, v19, v26
    v_mul_f32 v20, v20, v26
    v_mul_f32 v21, v21, v26
    v_mul_f32 v22, v22, v26
    v_mul_f32 v23, v23, v26
    v_mul_f32 v24, v24, v26
    v_mul_f32 v25, v25, v26
    v_cvt_pk_bf16_f32 v32, v16, v17
    v_cvt_pk_bf16_f32 v33, v18, v19
    v_cvt_pk_bf16_f32 v34, v20, v21
    v_cvt_pk_bf16_f32 v35, v22, v23
    v_cvt_pk_bf16_f32 v38, v24, v25
    s_waitcnt lgkmcnt(0)
    v_mfma_f32_32x32x16_bf16 v[44:59], v[88:91], v[32:35], v[44:59]
    v_mfma_f32_32x32x16_bf16 v[60:75], v[92:95], v[32:35], v[60:75]
    s_add_u32 s38, s37, 32256
    buffer_load_dwordx4 v[172:175], v13, s[20:23], s38 offen offset:0
    buffer_load_dwordx4 v[176:179], v13, s[20:23], s38 offen offset:1024
    buffer_load_dwordx2 v[180:181], v15, s[20:23], s38 offen offset:2048
    ds_read_b128 v[76:79], v9 offset:13440
    ds_read_b128 v[80:83], v9 offset:13472
    ds_read_b128 v[84:87], v9 offset:13504
    ds_read_b64_tr_b16 v[88:89], v10 offset:8064
    ds_read_b64_tr_b16 v[90:91], v10 offset:8576
    ds_read_b64_tr_b16 v[92:93], v11 offset:8064
    ds_read_b64_tr_b16 v[94:95], v11 offset:8576
    s_waitcnt vmcnt(21) lgkmcnt(4)
    v_mfma_f32_32x32x16_bf16 v[16:31], v[76:79], v[184:187], 0
    v_mfma_f32_32x32x16_bf16 v[16:31], v[80:83], v[188:191], v[16:31]
    v_mfma_f32_32x32x16_bf16 v[16:31], v[84:87], v[192:195], v[16:31]
    s_nop 11
    v_cvt_pk_bf16_f32 v40, v16, v17
    v_lshlrev_b32 v16, 16, v40
    v_and_b32 v17, 0xffff0000, v40
    v_cvt_pk_bf16_f32 v41, v18, v19
    v_lshlrev_b32 v18, 16, v41
    v_and_b32 v19, 0xffff0000, v41
    v_cvt_pk_bf16_f32 v40, v20, v21
    v_lshlrev_b32 v20, 16, v40
    v_and_b32 v21, 0xffff0000, v40
    v_cvt_pk_bf16_f32 v41, v22, v23
    v_lshlrev_b32 v22, 16, v41
    v_and_b32 v23, 0xffff0000, v41
    v_cvt_pk_bf16_f32 v40, v24, v25
    v_lshlrev_b32 v24, 16, v40
    v_and_b32 v25, 0xffff0000, v40
    v_cvt_pk_bf16_f32 v42, v26, v26
    v_lshlrev_b32 v26, 16, v42
    v_add_f32 v26, 0x358637bd, v26
    v_cvt_pk_bf16_f32 v42, v26, v26
    v_lshlrev_b32 v26, 16, v42
    v_rcp_f32 v26, v26
    s_nop 0
    v_mul_f32 v16, v16, v26
    v_mul_f32 v17, v17, v26
    v_mul_f32 v18, v18, v26
    v_mul_f32 v19, v19, v26
    v_mul_f32 v20, v20, v26
    v_mul_f32 v21, v21, v26
    v_mul_f32 v22, v22, v26
    v_mul_f32 v23, v23, v26
    v_mul_f32 v24, v24, v26
    v_mul_f32 v25, v25, v26
    v_cvt_pk_bf16_f32 v32, v16, v17
    v_cvt_pk_bf16_f32 v33, v18, v19
    v_cvt_pk_bf16_f32 v34, v20, v21
    v_cvt_pk_bf16_f32 v35, v22, v23
    v_cvt_pk_bf16_f32 v39, v24, v25
    s_waitcnt lgkmcnt(0)
    v_mfma_f32_32x32x16_bf16 v[44:59], v[88:91], v[32:35], v[44:59]
    v_mfma_f32_32x32x16_bf16 v[60:75], v[92:95], v[32:35], v[60:75]
    ds_read_b64_tr_b16 v[88:89], v12 offset:5632
    ds_read_b64_tr_b16 v[90:91], v12 offset:7936
    ds_read_b64_tr_b16 v[92:93], v14 offset:5632
    ds_read_b64_tr_b16 v[94:95], v14 offset:7936
    s_waitcnt lgkmcnt(0)
    v_mfma_f32_32x32x16_bf16 v[44:59], v[88:91], v[36:39], v[44:59]
    v_mfma_f32_32x32x16_bf16 v[60:75], v[92:95], v[36:39], v[60:75]
    s_add_u32 s38, s37, 34560
    buffer_load_dwordx4 v[184:187], v13, s[20:23], s38 offen offset:0
    buffer_load_dwordx4 v[188:191], v13, s[20:23], s38 offen offset:1024
    buffer_load_dwordx2 v[192:193], v15, s[20:23], s38 offen offset:2048
    ds_read_b128 v[76:79], v9 offset:15360
    ds_read_b128 v[80:83], v9 offset:15392
    ds_read_b128 v[84:87], v9 offset:15424
    ds_read_b64_tr_b16 v[88:89], v10 offset:9216
    ds_read_b64_tr_b16 v[90:91], v10 offset:9728
    ds_read_b64_tr_b16 v[92:93], v11 offset:9216
    ds_read_b64_tr_b16 v[94:95], v11 offset:9728
    s_waitcnt vmcnt(21) lgkmcnt(4)
    v_mfma_f32_32x32x16_bf16 v[16:31], v[76:79], v[100:103], 0
    v_mfma_f32_32x32x16_bf16 v[16:31], v[80:83], v[104:107], v[16:31]
    v_mfma_f32_32x32x16_bf16 v[16:31], v[84:87], v[108:111], v[16:31]
    s_nop 11
    v_cvt_pk_bf16_f32 v40, v16, v17
    v_lshlrev_b32 v16, 16, v40
    v_and_b32 v17, 0xffff0000, v40
    v_cvt_pk_bf16_f32 v41, v18, v19
    v_lshlrev_b32 v18, 16, v41
    v_and_b32 v19, 0xffff0000, v41
    v_cvt_pk_bf16_f32 v40, v20, v21
    v_lshlrev_b32 v20, 16, v40
    v_and_b32 v21, 0xffff0000, v40
    v_cvt_pk_bf16_f32 v41, v22, v23
    v_lshlrev_b32 v22, 16, v41
    v_and_b32 v23, 0xffff0000, v41
    v_cvt_pk_bf16_f32 v40, v24, v25
    v_lshlrev_b32 v24, 16, v40
    v_and_b32 v25, 0xffff0000, v40
    v_cvt_pk_bf16_f32 v42, v26, v26
    v_lshlrev_b32 v26, 16, v42
    v_add_f32 v26, 0x358637bd, v26
    v_cvt_pk_bf16_f32 v42, v26, v26
    v_lshlrev_b32 v26, 16, v42
    v_rcp_f32 v26, v26
    s_nop 0
    v_mul_f32 v16, v16, v26
    v_mul_f32 v17, v17, v26
    v_mul_f32 v18, v18, v26
    v_mul_f32 v19, v19, v26
    v_mul_f32 v20, v20, v26
    v_mul_f32 v21, v21, v26
    v_mul_f32 v22, v22, v26
    v_mul_f32 v23, v23, v26
    v_mul_f32 v24, v24, v26
    v_mul_f32 v25, v25, v26
    v_cvt_pk_bf16_f32 v32, v16, v17
    v_cvt_pk_bf16_f32 v33, v18, v19
    v_cvt_pk_bf16_f32 v34, v20, v21
    v_cvt_pk_bf16_f32 v35, v22, v23
    v_cvt_pk_bf16_f32 v36, v24, v25
    s_waitcnt lgkmcnt(0)
    v_mfma_f32_32x32x16_bf16 v[44:59], v[88:91], v[32:35], v[44:59]
    v_mfma_f32_32x32x16_bf16 v[60:75], v[92:95], v[32:35], v[60:75]
    ds_read_b128 v[76:79], v9 offset:17280
    ds_read_b128 v[80:83], v9 offset:17312
    ds_read_b128 v[84:87], v9 offset:17344
    ds_read_b64_tr_b16 v[88:89], v10 offset:10368
    ds_read_b64_tr_b16 v[90:91], v10 offset:10880
    ds_read_b64_tr_b16 v[92:93], v11 offset:10368
    ds_read_b64_tr_b16 v[94:95], v11 offset:10880
    s_waitcnt vmcnt(18) lgkmcnt(4)
    v_mfma_f32_32x32x16_bf16 v[16:31], v[76:79], v[112:115], 0
    v_mfma_f32_32x32x16_bf16 v[16:31], v[80:83], v[116:119], v[16:31]
    v_mfma_f32_32x32x16_bf16 v[16:31], v[84:87], v[120:123], v[16:31]
    s_nop 11
    v_cvt_pk_bf16_f32 v40, v16, v17
    v_lshlrev_b32 v16, 16, v40
    v_and_b32 v17, 0xffff0000, v40
    v_cvt_pk_bf16_f32 v41, v18, v19
    v_lshlrev_b32 v18, 16, v41
    v_and_b32 v19, 0xffff0000, v41
    v_cvt_pk_bf16_f32 v40, v20, v21
    v_lshlrev_b32 v20, 16, v40
    v_and_b32 v21, 0xffff0000, v40
    v_cvt_pk_bf16_f32 v41, v22, v23
    v_lshlrev_b32 v22, 16, v41
    v_and_b32 v23, 0xffff0000, v41
    v_cvt_pk_bf16_f32 v40, v24, v25
    v_lshlrev_b32 v24, 16, v40
    v_and_b32 v25, 0xffff0000, v40
    v_cvt_pk_bf16_f32 v42, v26, v26
    v_lshlrev_b32 v26, 16, v42
    v_add_f32 v26, 0x358637bd, v26
    v_cvt_pk_bf16_f32 v42, v26, v26
    v_lshlrev_b32 v26, 16, v42
    v_rcp_f32 v26, v26
    s_nop 0
    v_mul_f32 v16, v16, v26
    v_mul_f32 v17, v17, v26
    v_mul_f32 v18, v18, v26
    v_mul_f32 v19, v19, v26
    v_mul_f32 v20, v20, v26
    v_mul_f32 v21, v21, v26
    v_mul_f32 v22, v22, v26
    v_mul_f32 v23, v23, v26
    v_mul_f32 v24, v24, v26
    v_mul_f32 v25, v25, v26
    v_cvt_pk_bf16_f32 v32, v16, v17
    v_cvt_pk_bf16_f32 v33, v18, v19
    v_cvt_pk_bf16_f32 v34, v20, v21
    v_cvt_pk_bf16_f32 v35, v22, v23
    v_cvt_pk_bf16_f32 v37, v24, v25
    s_waitcnt lgkmcnt(0)
    v_mfma_f32_32x32x16_bf16 v[44:59], v[88:91], v[32:35], v[44:59]
    v_mfma_f32_32x32x16_bf16 v[60:75], v[92:95], v[32:35], v[60:75]
    ds_read_b128 v[76:79], v9 offset:19200
    ds_read_b128 v[80:83], v9 offset:19232
    ds_read_b128 v[84:87], v9 offset:19264
    ds_read_b64_tr_b16 v[88:89], v10 offset:11520
    ds_read_b64_tr_b16 v[90:91], v10 offset:12032
    ds_read_b64_tr_b16 v[92:93], v11 offset:11520
    ds_read_b64_tr_b16 v[94:95], v11 offset:12032
    s_waitcnt vmcnt(15) lgkmcnt(4)
    v_mfma_f32_32x32x16_bf16 v[16:31], v[76:79], v[124:127], 0
    v_mfma_f32_32x32x16_bf16 v[16:31], v[80:83], v[128:131], v[16:31]
    v_mfma_f32_32x32x16_bf16 v[16:31], v[84:87], v[132:135], v[16:31]
    s_nop 11
    v_cvt_pk_bf16_f32 v40, v16, v17
    v_lshlrev_b32 v16, 16, v40
    v_and_b32 v17, 0xffff0000, v40
    v_cvt_pk_bf16_f32 v41, v18, v19
    v_lshlrev_b32 v18, 16, v41
    v_and_b32 v19, 0xffff0000, v41
    v_cvt_pk_bf16_f32 v40, v20, v21
    v_lshlrev_b32 v20, 16, v40
    v_and_b32 v21, 0xffff0000, v40
    v_cvt_pk_bf16_f32 v41, v22, v23
    v_lshlrev_b32 v22, 16, v41
    v_and_b32 v23, 0xffff0000, v41
    v_cvt_pk_bf16_f32 v40, v24, v25
    v_lshlrev_b32 v24, 16, v40
    v_and_b32 v25, 0xffff0000, v40
    v_cvt_pk_bf16_f32 v42, v26, v26
    v_lshlrev_b32 v26, 16, v42
    v_add_f32 v26, 0x358637bd, v26
    v_cvt_pk_bf16_f32 v42, v26, v26
    v_lshlrev_b32 v26, 16, v42
    v_rcp_f32 v26, v26
    s_nop 0
    v_mul_f32 v16, v16, v26
    v_mul_f32 v17, v17, v26
    v_mul_f32 v18, v18, v26
    v_mul_f32 v19, v19, v26
    v_mul_f32 v20, v20, v26
    v_mul_f32 v21, v21, v26
    v_mul_f32 v22, v22, v26
    v_mul_f32 v23, v23, v26
    v_mul_f32 v24, v24, v26
    v_mul_f32 v25, v25, v26
    v_cvt_pk_bf16_f32 v32, v16, v17
    v_cvt_pk_bf16_f32 v33, v18, v19
    v_cvt_pk_bf16_f32 v34, v20, v21
    v_cvt_pk_bf16_f32 v35, v22, v23
    v_cvt_pk_bf16_f32 v38, v24, v25
    s_waitcnt lgkmcnt(0)
    v_mfma_f32_32x32x16_bf16 v[44:59], v[88:91], v[32:35], v[44:59]
    v_mfma_f32_32x32x16_bf16 v[60:75], v[92:95], v[32:35], v[60:75]
    ds_read_b128 v[76:79], v9 offset:21120
    ds_read_b128 v[80:83], v9 offset:21152
    ds_read_b128 v[84:87], v9 offset:21184
    ds_read_b64_tr_b16 v[88:89], v10 offset:12672
    ds_read_b64_tr_b16 v[90:91], v10 offset:13184
    ds_read_b64_tr_b16 v[92:93], v11 offset:12672
    ds_read_b64_tr_b16 v[94:95], v11 offset:13184
    s_waitcnt vmcnt(12) lgkmcnt(4)
    v_mfma_f32_32x32x16_bf16 v[16:31], v[76:79], v[136:139], 0
    v_mfma_f32_32x32x16_bf16 v[16:31], v[80:83], v[140:143], v[16:31]
    v_mfma_f32_32x32x16_bf16 v[16:31], v[84:87], v[144:147], v[16:31]
    s_nop 11
    v_cvt_pk_bf16_f32 v40, v16, v17
    v_lshlrev_b32 v16, 16, v40
    v_and_b32 v17, 0xffff0000, v40
    v_cvt_pk_bf16_f32 v41, v18, v19
    v_lshlrev_b32 v18, 16, v41
    v_and_b32 v19, 0xffff0000, v41
    v_cvt_pk_bf16_f32 v40, v20, v21
    v_lshlrev_b32 v20, 16, v40
    v_and_b32 v21, 0xffff0000, v40
    v_cvt_pk_bf16_f32 v41, v22, v23
    v_lshlrev_b32 v22, 16, v41
    v_and_b32 v23, 0xffff0000, v41
    v_cvt_pk_bf16_f32 v40, v24, v25
    v_lshlrev_b32 v24, 16, v40
    v_and_b32 v25, 0xffff0000, v40
    v_cvt_pk_bf16_f32 v42, v26, v26
    v_lshlrev_b32 v26, 16, v42
    v_add_f32 v26, 0x358637bd, v26
    v_cvt_pk_bf16_f32 v42, v26, v26
    v_lshlrev_b32 v26, 16, v42
    v_rcp_f32 v26, v26
    s_nop 0
    v_mul_f32 v16, v16, v26
    v_mul_f32 v17, v17, v26
    v_mul_f32 v18, v18, v26
    v_mul_f32 v19, v19, v26
    v_mul_f32 v20, v20, v26
    v_mul_f32 v21, v21, v26
    v_mul_f32 v22, v22, v26
    v_mul_f32 v23, v23, v26
    v_mul_f32 v24, v24, v26
    v_mul_f32 v25, v25, v26
    v_cvt_pk_bf16_f32 v32, v16, v17
    v_cvt_pk_bf16_f32 v33, v18, v19
    v_cvt_pk_bf16_f32 v34, v20, v21
    v_cvt_pk_bf16_f32 v35, v22, v23
    v_cvt_pk_bf16_f32 v39, v24, v25
    s_waitcnt lgkmcnt(0)
    v_mfma_f32_32x32x16_bf16 v[44:59], v[88:91], v[32:35], v[44:59]
    v_mfma_f32_32x32x16_bf16 v[60:75], v[92:95], v[32:35], v[60:75]
    ds_read_b64_tr_b16 v[88:89], v12 offset:10240
    ds_read_b64_tr_b16 v[90:91], v12 offset:12544
    ds_read_b64_tr_b16 v[92:93], v14 offset:10240
    ds_read_b64_tr_b16 v[94:95], v14 offset:12544
    s_waitcnt lgkmcnt(0)
    v_mfma_f32_32x32x16_bf16 v[44:59], v[88:91], v[36:39], v[44:59]
    v_mfma_f32_32x32x16_bf16 v[60:75], v[92:95], v[36:39], v[60:75]
    ds_read_b128 v[76:79], v9 offset:23040
    ds_read_b128 v[80:83], v9 offset:23072
    ds_read_b128 v[84:87], v9 offset:23104
    ds_read_b64_tr_b16 v[88:89], v10 offset:13824
    ds_read_b64_tr_b16 v[90:91], v10 offset:14336
    ds_read_b64_tr_b16 v[92:93], v11 offset:13824
    ds_read_b64_tr_b16 v[94:95], v11 offset:14336
    s_waitcnt vmcnt(9) lgkmcnt(4)
    v_mfma_f32_32x32x16_bf16 v[16:31], v[76:79], v[148:151], 0
    v_mfma_f32_32x32x16_bf16 v[16:31], v[80:83], v[152:155], v[16:31]
    v_mfma_f32_32x32x16_bf16 v[16:31], v[84:87], v[156:159], v[16:31]
    s_nop 11
    v_cvt_pk_bf16_f32 v40, v16, v17
    v_lshlrev_b32 v16, 16, v40
    v_and_b32 v17, 0xffff0000, v40
    v_cvt_pk_bf16_f32 v41, v18, v19
    v_lshlrev_b32 v18, 16, v41
    v_and_b32 v19, 0xffff0000, v41
    v_cvt_pk_bf16_f32 v40, v20, v21
    v_lshlrev_b32 v20, 16, v40
    v_and_b32 v21, 0xffff0000, v40
    v_cvt_pk_bf16_f32 v41, v22, v23
    v_lshlrev_b32 v22, 16, v41
    v_and_b32 v23, 0xffff0000, v41
    v_cvt_pk_bf16_f32 v40, v24, v25
    v_lshlrev_b32 v24, 16, v40
    v_and_b32 v25, 0xffff0000, v40
    v_cvt_pk_bf16_f32 v42, v26, v26
    v_lshlrev_b32 v26, 16, v42
    v_add_f32 v26, 0x358637bd, v26
    v_cvt_pk_bf16_f32 v42, v26, v26
    v_lshlrev_b32 v26, 16, v42
    v_rcp_f32 v26, v26
    s_nop 0
    v_mul_f32 v16, v16, v26
    v_mul_f32 v17, v17, v26
    v_mul_f32 v18, v18, v26
    v_mul_f32 v19, v19, v26
    v_mul_f32 v20, v20, v26
    v_mul_f32 v21, v21, v26
    v_mul_f32 v22, v22, v26
    v_mul_f32 v23, v23, v26
    v_mul_f32 v24, v24, v26
    v_mul_f32 v25, v25, v26
    v_cvt_pk_bf16_f32 v32, v16, v17
    v_cvt_pk_bf16_f32 v33, v18, v19
    v_cvt_pk_bf16_f32 v34, v20, v21
    v_cvt_pk_bf16_f32 v35, v22, v23
    v_cvt_pk_bf16_f32 v36, v24, v25
    s_waitcnt lgkmcnt(0)
    v_mfma_f32_32x32x16_bf16 v[44:59], v[88:91], v[32:35], v[44:59]
    v_mfma_f32_32x32x16_bf16 v[60:75], v[92:95], v[32:35], v[60:75]
    ds_read_b128 v[76:79], v9 offset:24960
    ds_read_b128 v[80:83], v9 offset:24992
    ds_read_b128 v[84:87], v9 offset:25024
    ds_read_b64_tr_b16 v[88:89], v10 offset:14976
    ds_read_b64_tr_b16 v[90:91], v10 offset:15488
    ds_read_b64_tr_b16 v[92:93], v11 offset:14976
    ds_read_b64_tr_b16 v[94:95], v11 offset:15488
    s_waitcnt vmcnt(6) lgkmcnt(4)
    v_mfma_f32_32x32x16_bf16 v[16:31], v[76:79], v[160:163], 0
    v_mfma_f32_32x32x16_bf16 v[16:31], v[80:83], v[164:167], v[16:31]
    v_mfma_f32_32x32x16_bf16 v[16:31], v[84:87], v[168:171], v[16:31]
    s_nop 11
    v_cvt_pk_bf16_f32 v40, v16, v17
    v_lshlrev_b32 v16, 16, v40
    v_and_b32 v17, 0xffff0000, v40
    v_cvt_pk_bf16_f32 v41, v18, v19
    v_lshlrev_b32 v18, 16, v41
    v_and_b32 v19, 0xffff0000, v41
    v_cvt_pk_bf16_f32 v40, v20, v21
    v_lshlrev_b32 v20, 16, v40
    v_and_b32 v21, 0xffff0000, v40
    v_cvt_pk_bf16_f32 v41, v22, v23
    v_lshlrev_b32 v22, 16, v41
    v_and_b32 v23, 0xffff0000, v41
    v_cvt_pk_bf16_f32 v40, v24, v25
    v_lshlrev_b32 v24, 16, v40
    v_and_b32 v25, 0xffff0000, v40
    v_cvt_pk_bf16_f32 v42, v26, v26
    v_lshlrev_b32 v26, 16, v42
    v_add_f32 v26, 0x358637bd, v26
    v_cvt_pk_bf16_f32 v42, v26, v26
    v_lshlrev_b32 v26, 16, v42
    v_rcp_f32 v26, v26
    s_nop 0
    v_mul_f32 v16, v16, v26
    v_mul_f32 v17, v17, v26
    v_mul_f32 v18, v18, v26
    v_mul_f32 v19, v19, v26
    v_mul_f32 v20, v20, v26
    v_mul_f32 v21, v21, v26
    v_mul_f32 v22, v22, v26
    v_mul_f32 v23, v23, v26
    v_mul_f32 v24, v24, v26
    v_mul_f32 v25, v25, v26
    v_cvt_pk_bf16_f32 v32, v16, v17
    v_cvt_pk_bf16_f32 v33, v18, v19
    v_cvt_pk_bf16_f32 v34, v20, v21
    v_cvt_pk_bf16_f32 v35, v22, v23
    v_cvt_pk_bf16_f32 v37, v24, v25
    s_waitcnt lgkmcnt(0)
    v_mfma_f32_32x32x16_bf16 v[44:59], v[88:91], v[32:35], v[44:59]
    v_mfma_f32_32x32x16_bf16 v[60:75], v[92:95], v[32:35], v[60:75]
    ds_read_b128 v[76:79], v9 offset:26880
    ds_read_b128 v[80:83], v9 offset:26912
    ds_read_b128 v[84:87], v9 offset:26944
    ds_read_b64_tr_b16 v[88:89], v10 offset:16128
    ds_read_b64_tr_b16 v[90:91], v10 offset:16640
    ds_read_b64_tr_b16 v[92:93], v11 offset:16128
    ds_read_b64_tr_b16 v[94:95], v11 offset:16640
    s_waitcnt vmcnt(3) lgkmcnt(4)
    v_mfma_f32_32x32x16_bf16 v[16:31], v[76:79], v[172:175], 0
    v_mfma_f32_32x32x16_bf16 v[16:31], v[80:83], v[176:179], v[16:31]
    v_mfma_f32_32x32x16_bf16 v[16:31], v[84:87], v[180:183], v[16:31]
    s_nop 11
    v_cvt_pk_bf16_f32 v40, v16, v17
    v_lshlrev_b32 v16, 16, v40
    v_and_b32 v17, 0xffff0000, v40
    v_cvt_pk_bf16_f32 v41, v18, v19
    v_lshlrev_b32 v18, 16, v41
    v_and_b32 v19, 0xffff0000, v41
    v_cvt_pk_bf16_f32 v40, v20, v21
    v_lshlrev_b32 v20, 16, v40
    v_and_b32 v21, 0xffff0000, v40
    v_cvt_pk_bf16_f32 v41, v22, v23
    v_lshlrev_b32 v22, 16, v41
    v_and_b32 v23, 0xffff0000, v41
    v_cvt_pk_bf16_f32 v40, v24, v25
    v_lshlrev_b32 v24, 16, v40
    v_and_b32 v25, 0xffff0000, v40
    v_cvt_pk_bf16_f32 v42, v26, v26
    v_lshlrev_b32 v26, 16, v42
    v_add_f32 v26, 0x358637bd, v26
    v_cvt_pk_bf16_f32 v42, v26, v26
    v_lshlrev_b32 v26, 16, v42
    v_rcp_f32 v26, v26
    s_nop 0
    v_mul_f32 v16, v16, v26
    v_mul_f32 v17, v17, v26
    v_mul_f32 v18, v18, v26
    v_mul_f32 v19, v19, v26
    v_mul_f32 v20, v20, v26
    v_mul_f32 v21, v21, v26
    v_mul_f32 v22, v22, v26
    v_mul_f32 v23, v23, v26
    v_mul_f32 v24, v24, v26
    v_mul_f32 v25, v25, v26
    v_cvt_pk_bf16_f32 v32, v16, v17
    v_cvt_pk_bf16_f32 v33, v18, v19
    v_cvt_pk_bf16_f32 v34, v20, v21
    v_cvt_pk_bf16_f32 v35, v22, v23
    v_cvt_pk_bf16_f32 v38, v24, v25
    s_waitcnt lgkmcnt(0)
    v_mfma_f32_32x32x16_bf16 v[44:59], v[88:91], v[32:35], v[44:59]
    v_mfma_f32_32x32x16_bf16 v[60:75], v[92:95], v[32:35], v[60:75]
    ds_read_b128 v[76:79], v9 offset:28800
    ds_read_b128 v[80:83], v9 offset:28832
    ds_read_b128 v[84:87], v9 offset:28864
    ds_read_b64_tr_b16 v[88:89], v10 offset:17280
    ds_read_b64_tr_b16 v[90:91], v10 offset:17792
    ds_read_b64_tr_b16 v[92:93], v11 offset:17280
    ds_read_b64_tr_b16 v[94:95], v11 offset:17792
    s_waitcnt vmcnt(0) lgkmcnt(4)
    v_mfma_f32_32x32x16_bf16 v[16:31], v[76:79], v[184:187], 0
    v_mfma_f32_32x32x16_bf16 v[16:31], v[80:83], v[188:191], v[16:31]
    v_mfma_f32_32x32x16_bf16 v[16:31], v[84:87], v[192:195], v[16:31]
    s_nop 11
    v_cvt_pk_bf16_f32 v40, v16, v17
    v_lshlrev_b32 v16, 16, v40
    v_and_b32 v17, 0xffff0000, v40
    v_cvt_pk_bf16_f32 v41, v18, v19
    v_lshlrev_b32 v18, 16, v41
    v_and_b32 v19, 0xffff0000, v41
    v_cvt_pk_bf16_f32 v40, v20, v21
    v_lshlrev_b32 v20, 16, v40
    v_and_b32 v21, 0xffff0000, v40
    v_cvt_pk_bf16_f32 v41, v22, v23
    v_lshlrev_b32 v22, 16, v41
    v_and_b32 v23, 0xffff0000, v41
    v_cvt_pk_bf16_f32 v40, v24, v25
    v_lshlrev_b32 v24, 16, v40
    v_and_b32 v25, 0xffff0000, v40
    v_cvt_pk_bf16_f32 v42, v26, v26
    v_lshlrev_b32 v26, 16, v42
    v_add_f32 v26, 0x358637bd, v26
    v_cvt_pk_bf16_f32 v42, v26, v26
    v_lshlrev_b32 v26, 16, v42
    v_rcp_f32 v26, v26
    s_nop 0
    v_mul_f32 v16, v16, v26
    v_mul_f32 v17, v17, v26
    v_mul_f32 v18, v18, v26
    v_mul_f32 v19, v19, v26
    v_mul_f32 v20, v20, v26
    v_mul_f32 v21, v21, v26
    v_mul_f32 v22, v22, v26
    v_mul_f32 v23, v23, v26
    v_mul_f32 v24, v24, v26
    v_mul_f32 v25, v25, v26
    v_cvt_pk_bf16_f32 v32, v16, v17
    v_cvt_pk_bf16_f32 v33, v18, v19
    v_cvt_pk_bf16_f32 v34, v20, v21
    v_cvt_pk_bf16_f32 v35, v22, v23
    v_cvt_pk_bf16_f32 v39, v24, v25
    s_waitcnt lgkmcnt(0)
    v_mfma_f32_32x32x16_bf16 v[44:59], v[88:91], v[32:35], v[44:59]
    v_mfma_f32_32x32x16_bf16 v[60:75], v[92:95], v[32:35], v[60:75]
    ds_read_b64_tr_b16 v[88:89], v12 offset:14848
    ds_read_b64_tr_b16 v[90:91], v12 offset:17152
    ds_read_b64_tr_b16 v[92:93], v14 offset:14848
    ds_read_b64_tr_b16 v[94:95], v14 offset:17152
    s_waitcnt lgkmcnt(0)
    v_mfma_f32_32x32x16_bf16 v[44:59], v[88:91], v[36:39], v[44:59]
    v_mfma_f32_32x32x16_bf16 v[60:75], v[92:95], v[36:39], v[60:75]
    s_lshl_b32 s38, s36, 5
    v_add_u32 v3, s38, v4
    v_mul_u32_u24 v3, 1152, v3
    v_lshlrev_b32 v6, 3, v5
    v_add_u32 v3, v3, v6
    s_lshl_b32 s39, s24, 7
    s_lshl_b32 s27, s32, 6
    s_add_u32 s39, s39, s27
    v_add_u32 v3, s39, v3
    v_lshlrev_b32 v6, 4, v5
    s_lshl_b32 s39, s39, 1
    s_add_u32 s39, s39, 4608
    s_mov_b32 s40, 8912896
    buffer_load_dwordx4 v[100:103], v6, s[20:23], s39 offen offset:0
    buffer_load_dwordx2 v[116:117], v3, s[16:19], 0 offen offset:0
    buffer_load_dwordx4 v[104:107], v6, s[20:23], s39 offen offset:32
    buffer_load_dwordx2 v[118:119], v3, s[16:19], 0 offen offset:16
    buffer_load_dwordx4 v[108:111], v6, s[20:23], s39 offen offset:64
    buffer_load_dwordx2 v[120:121], v3, s[16:19], 0 offen offset:32
    buffer_load_dwordx4 v[112:115], v6, s[20:23], s39 offen offset:96
    buffer_load_dwordx2 v[122:123], v3, s[16:19], 0 offen offset:48
    s_barrier
    s_lshl_b32 s27, s26, 12
    v_add_u32 v7, s27, v13
    s_xor_b32 s27, s26, 4
    s_lshl_b32 s27, s27, 12
    v_add_u32 v8, s27, v13
    s_cmp_eq_u32 s32, 0
    s_cbranch_scc1 kh0_k2_attn_kernel_2
    ds_write_b128 v7, v[44:47] offset:0
    ds_write_b128 v7, v[48:51] offset:1024
    ds_write_b128 v7, v[52:55] offset:2048
    ds_write_b128 v7, v[56:59] offset:3072
    v_mov_b32 v44, v60
    v_mov_b32 v45, v61
    v_mov_b32 v46, v62
    v_mov_b32 v47, v63
    v_mov_b32 v48, v64
    v_mov_b32 v49, v65
    v_mov_b32 v50, v66
    v_mov_b32 v51, v67
    v_mov_b32 v52, v68
    v_mov_b32 v53, v69
    v_mov_b32 v54, v70
    v_mov_b32 v55, v71
    v_mov_b32 v56, v72
    v_mov_b32 v57, v73
    v_mov_b32 v58, v74
    v_mov_b32 v59, v75
    s_branch join_k2_attn_kernel_3
kh0_k2_attn_kernel_2:
    ds_write_b128 v7, v[60:63] offset:0
    ds_write_b128 v7, v[64:67] offset:1024
    ds_write_b128 v7, v[68:71] offset:2048
    ds_write_b128 v7, v[72:75] offset:3072
join_k2_attn_kernel_3:
    s_waitcnt lgkmcnt(0)
    s_barrier
    ds_read_b128 v[16:19], v8 offset:0
    ds_read_b128 v[20:23], v8 offset:1024
    ds_read_b128 v[24:27], v8 offset:2048
    ds_read_b128 v[28:31], v8 offset:3072
    s_waitcnt vmcnt(0) lgkmcnt(0)
    v_add_f32 v44, v44, v16
    v_add_f32 v45, v45, v17
    v_add_f32 v46, v46, v18
    v_add_f32 v47, v47, v19
    v_cvt_pk_bf16_f32 v40, v44, v45
    v_lshlrev_b32 v44, 16, v40
    v_and_b32 v45, 0xffff0000, v40
    v_cvt_pk_bf16_f32 v41, v46, v47
    v_lshlrev_b32 v46, 16, v41
    v_and_b32 v47, 0xffff0000, v41
    v_mul_f32 v44, v44, v100
    v_mul_f32 v45, v45, v101
    v_mul_f32 v46, v46, v102
    v_mul_f32 v47, v47, v103
    v_cvt_pk_bf16_f32 v40, v44, v45
    v_lshlrev_b32 v44, 16, v40
    v_and_b32 v45, 0xffff0000, v40
    v_cvt_pk_bf16_f32 v41, v46, v47
    v_lshlrev_b32 v46, 16, v41
    v_and_b32 v47, 0xffff0000, v41
    v_lshlrev_b32 v40, 16, v116
    v_and_b32 v41, 0xffff0000, v116
    v_lshlrev_b32 v42, 16, v117
    v_and_b32 v43, 0xffff0000, v117
    v_add_f32 v44, v44, v40
    v_add_f32 v45, v45, v41
    v_add_f32 v46, v46, v42
    v_add_f32 v47, v47, v43
    v_cvt_pk_bf16_f32 v116, v44, v45
    v_cvt_pk_bf16_f32 v117, v46, v47
    buffer_store_dwordx2 v[116:117], v3, s[20:23], s40 offen offset:0
    v_add_f32 v48, v48, v20
    v_add_f32 v49, v49, v21
    v_add_f32 v50, v50, v22
    v_add_f32 v51, v51, v23
    v_cvt_pk_bf16_f32 v40, v48, v49
    v_lshlrev_b32 v48, 16, v40
    v_and_b32 v49, 0xffff0000, v40
    v_cvt_pk_bf16_f32 v41, v50, v51
    v_lshlrev_b32 v50, 16, v41
    v_and_b32 v51, 0xffff0000, v41
    v_mul_f32 v48, v48, v104
    v_mul_f32 v49, v49, v105
    v_mul_f32 v50, v50, v106
    v_mul_f32 v51, v51, v107
    v_cvt_pk_bf16_f32 v40, v48, v49
    v_lshlrev_b32 v48, 16, v40
    v_and_b32 v49, 0xffff0000, v40
    v_cvt_pk_bf16_f32 v41, v50, v51
    v_lshlrev_b32 v50, 16, v41
    v_and_b32 v51, 0xffff0000, v41
    v_lshlrev_b32 v40, 16, v118
    v_and_b32 v41, 0xffff0000, v118
    v_lshlrev_b32 v42, 16, v119
    v_and_b32 v43, 0xffff0000, v119
    v_add_f32 v48, v48, v40
    v_add_f32 v49, v49, v41
    v_add_f32 v50, v50, v42
    v_add_f32 v51, v51, v43
    v_cvt_pk_bf16_f32 v118, v48, v49
    v_cvt_pk_bf16_f32 v119, v50, v51
    buffer_store_dwordx2 v[118:119], v3, s[20:23], s40 offen offset:16
    v_add_f32 v52, v52, v24
    v_add_f32 v53, v53, v25
    v_add_f32 v54, v54, v26
    v_add_f32 v55, v55, v27
    v_cvt_pk_bf16_f32 v40, v52, v53
    v_lshlrev_b32 v52, 16, v40
    v_and_b32 v53, 0xffff0000, v40
    v_cvt_pk_bf16_f32 v41, v54, v55
    v_lshlrev_b32 v54, 16, v41
    v_and_b32 v55, 0xffff0000, v41
    v_mul_f32 v52, v52, v108
    v_mul_f32 v53, v53, v109
    v_mul_f32 v54, v54, v110
    v_mul_f32 v55, v55, v111
    v_cvt_pk_bf16_f32 v40, v52, v53
    v_lshlrev_b32 v52, 16, v40
    v_and_b32 v53, 0xffff0000, v40
    v_cvt_pk_bf16_f32 v41, v54, v55
    v_lshlrev_b32 v54, 16, v41
    v_and_b32 v55, 0xffff0000, v41
    v_lshlrev_b32 v40, 16, v120
    v_and_b32 v41, 0xffff0000, v120
    v_lshlrev_b32 v42, 16, v121
    v_and_b32 v43, 0xffff0000, v121
    v_add_f32 v52, v52, v40
    v_add_f32 v53, v53, v41
    v_add_f32 v54, v54, v42
    v_add_f32 v55, v55, v43
    v_cvt_pk_bf16_f32 v120, v52, v53
    v_cvt_pk_bf16_f32 v121, v54, v55
    buffer_store_dwordx2 v[120:121], v3, s[20:23], s40 offen offset:32
    v_add_f32 v56, v56, v28
    v_add_f32 v57, v57, v29
    v_add_f32 v58, v58, v30
    v_add_f32 v59, v59, v31
    v_cvt_pk_bf16_f32 v40, v56, v57
    v_lshlrev_b32 v56, 16, v40
    v_and_b32 v57, 0xffff0000, v40
    v_cvt_pk_bf16_f32 v41, v58, v59
    v_lshlrev_b32 v58, 16, v41
    v_and_b32 v59, 0xffff0000, v41
    v_mul_f32 v56, v56, v112
    v_mul_f32 v57, v57, v113
    v_mul_f32 v58, v58, v114
    v_mul_f32 v59, v59, v115
    v_cvt_pk_bf16_f32 v40, v56, v57
    v_lshlrev_b32 v56, 16, v40
    v_and_b32 v57, 0xffff0000, v40
    v_cvt_pk_bf16_f32 v41, v58, v59
    v_lshlrev_b32 v58, 16, v41
    v_and_b32 v59, 0xffff0000, v41
    v_lshlrev_b32 v40, 16, v122
    v_and_b32 v41, 0xffff0000, v122
    v_lshlrev_b32 v42, 16, v123
    v_and_b32 v43, 0xffff0000, v123
    v_add_f32 v56, v56, v40
    v_add_f32 v57, v57, v41
    v_add_f32 v58, v58, v42
    v_add_f32 v59, v59, v43
    v_cvt_pk_bf16_f32 v122, v56, v57
    v_cvt_pk_bf16_f32 v123, v58, v59
    buffer_store_dwordx2 v[122:123], v3, s[20:23], s40 offen offset:48
end_k2_attn_kernel_1:
    s_endpgm
.globl ln2_kernel
.p2align 8
.type ln2_kernel,@function
ln2_kernel:
    s_load_dwordx2 s[4:5], s[0:1], 0
    s_load_dwordx2 s[8:9], s[0:1], 96
    s_waitcnt lgkmcnt(0)
    s_add_u32 s4, s8, 8912896
    s_addc_u32 s5, s9, 0
    s_mov_b32 s12, s4
    s_and_b32 s13, s5, 0xffff
    s_mov_b32 s14, 2359296
    s_mov_b32 s15, 0x00020000
    s_mov_b32 s20, s8
    s_and_b32 s21, s9, 0xffff
    s_mov_b32 s22, 268435456
    s_mov_b32 s23, 0x00020000
    s_cmp_ge_u32 s2, 256
    s_cbranch_scc1 end_ln2_kernel_1
    v_lshrrev_b32 v1, 3, v0
    v_and_b32 v2, 7, v0
    s_lshl_b32 s24, s2, 3
    v_add_u32 v1, s24, v1
    v_mul_u32_u24 v3, 1152, v1
    v_lshlrev_b32 v4, 4, v2
    v_add_u32 v3, v3, v4
    s_mov_b32 s26, 201216
    s_mov_b32 s27, 200064
    buffer_load_dwordx4 v[8:11], v3, s[12:15], 0 offen offset:0
    buffer_load_dwordx4 v[12:15], v3, s[12:15], 0 offen offset:128
    buffer_load_dwordx4 v[16:19], v3, s[12:15], 0 offen offset:256
    buffer_load_dwordx4 v[20:23], v3, s[12:15], 0 offen offset:384
    buffer_load_dwordx4 v[24:27], v3, s[12:15], 0 offen offset:512
    buffer_load_dwordx4 v[28:31], v3, s[12:15], 0 offen offset:640
    buffer_load_dwordx4 v[32:35], v3, s[12:15], 0 offen offset:768
    buffer_load_dwordx4 v[36:39], v3, s[12:15], 0 offen offset:896
    buffer_load_dwordx4 v[40:43], v3, s[12:15], 0 offen offset:1024
    buffer_load_dwordx4 v[44:47], v4, s[20:23], s26 offen offset:0
    buffer_load_dwordx4 v[80:83], v4, s[20:23], s27 offen offset:0
    buffer_load_dwordx4 v[48:51], v4, s[20:23], s26 offen offset:128
    buffer_load_dwordx4 v[84:87], v4, s[20:23], s27 offen offset:128
    buffer_load_dwordx4 v[52:55], v4, s[20:23], s26 offen offset:256
    buffer_load_dwordx4 v[88:91], v4, s[20:23], s27 offen offset:256
    buffer_load_dwordx4 v[56:59], v4, s[20:23], s26 offen offset:384
    buffer_load_dwordx4 v[92:95], v4, s[20:23], s27 offen offset:384
    buffer_load_dwordx4 v[60:63], v4, s[20:23], s26 offen offset:512
    buffer_load_dwordx4 v[96:99], v4, s[20:23], s27 offen offset:512
    buffer_load_dwordx4 v[64:67], v4, s[20:23], s26 offen offset:640
    buffer_load_dwordx4 v[100:103], v4, s[20:23], s27 offen offset:640
    buffer_load_dwordx4 v[68:71], v4, s[20:23], s26 offen offset:768
    buffer_load_dwordx4 v[104:107], v4, s[20:23], s27 offen offset:768
    buffer_load_dwordx4 v[72:75], v4, s[20:23], s26 offen offset:896
    buffer_load_dwordx4 v[108:111], v4, s[20:23], s27 offen offset:896
    buffer_load_dwordx4 v[76:79], v4, s[20:23], s26 offen offset:1024
    buffer_load_dwordx4 v[112:115], v4, s[20:23], s27 offen offset:1024
    v_lshrrev_b32 v120, 5, v1
    v_mul_u32_u24 v120, 36864, v120
    v_lshrrev_b32 v121, 1, v2
    v_lshlrev_b32 v121, 10, v121
    v_add_u32 v120, v120, v121
    v_and_b32 v121, 1, v2
    v_lshlrev_b32 v121, 9, v121
    v_add_u32 v120, v120, v121
    v_and_b32 v121, 31, v1
    v_lshlrev_b32 v121, 4, v121
    v_add_u32 v120, v120, v121
    v_add_u32 v120, 11272192, v120
    s_load_dwordx2 s[32:33], s[0:1], 40
    s_load_dwordx2 s[34:35], s[0:1], 48
    s_waitcnt lgkmcnt(0)
    s_mul_i32 s29, s2, 20736
    v_lshlrev_b32 v126, 4, v0
    s_mov_b32 s36, s32
    s_and_b32 s37, s33, 0xffff
    s_mov_b32 s38, 5308416
    s_mov_b32 s39, 0x00020000
    s_mov_b32 s40, s34
    s_and_b32 s41, s35, 0xffff
    s_mov_b32 s42, 5308416
    s_mov_b32 s43, 0x00020000
    s_add_u32 s30, s29, 0
    buffer_load_dwordx4 v[200:203], v126, s[36:39], s30 offen
    buffer_load_dwordx4 v[204:207], v126, s[40:43], s30 offen
    s_add_u32 s30, s29, 1024
    buffer_load_dwordx4 v[200:203], v126, s[36:39], s30 offen
    buffer_load_dwordx4 v[204:207], v126, s[40:43], s30 offen
    s_add_u32 s30, s29, 2048
    buffer_load_dwordx4 v[200:203], v126, s[36:39], s30 offen
    buffer_load_dwordx4 v[204:207], v126, s[40:43], s30 offen
    s_add_u32 s30, s29, 3072
    buffer_load_dwordx4 v[200:203], v126, s[36:39], s30 offen
    buffer_load_dwordx4 v[204:207], v126, s[40:43], s30 offen
    s_add_u32 s30, s29, 4096
    buffer_load_dwordx4 v[200:203], v126, s[36:39], s30 offen
    buffer_load_dwordx4 v[204:207], v126, s[40:43], s30 offen
    s_add_u32 s30, s29, 5120
    buffer_load_dwordx4 v[200:203], v126, s[36:39], s30 offen
    buffer_load_dwordx4 v[204:207], v126, s[40:43], s30 offen
    s_add_u32 s30, s29, 6144
    buffer_load_dwordx4 v[200:203], v126, s[36:39], s30 offen
    buffer_load_dwordx4 v[204:207], v126, s[40:43], s30 offen
    s_add_u32 s30, s29, 7168
    buffer_load_dwordx4 v[200:203], v126, s[36:39], s30 offen
    buffer_load_dwordx4 v[204:207], v126, s[40:43], s30 offen
    s_add_u32 s30, s29, 8192
    buffer_load_dwordx4 v[200:203], v126, s[36:39], s30 offen
    buffer_load_dwordx4 v[204:207], v126, s[40:43], s30 offen
    s_add_u32 s30, s29, 9216
    buffer_load_dwordx4 v[200:203], v126, s[36:39], s30 offen
    buffer_load_dwordx4 v[204:207], v126, s[40:43], s30 offen
    s_add_u32 s30, s29, 10240
    buffer_load_dwordx4 v[200:203], v126, s[36:39], s30 offen
    buffer_load_dwordx4 v[204:207], v126, s[40:43], s30 offen
    s_add_u32 s30, s29, 11264
    buffer_load_dwordx4 v[200:203], v126, s[36:39], s30 offen
    buffer_load_dwordx4 v[204:207], v126, s[40:43], s30 offen
    s_add_u32 s30, s29, 12288
    buffer_load_dwordx4 v[200:203], v126, s[36:39], s30 offen
    buffer_load_dwordx4 v[204:207], v126, s[40:43], s30 offen
    s_add_u32 s30, s29, 13312
    buffer_load_dwordx4 v[200:203], v126, s[36:39], s30 offen
    buffer_load_dwordx4 v[204:207], v126, s[40:43], s30 offen
    s_add_u32 s30, s29, 14336
    buffer_load_dwordx4 v[200:203], v126, s[36:39], s30 offen
    buffer_load_dwordx4 v[204:207], v126, s[40:43], s30 offen
    s_add_u32 s30, s29, 15360
    buffer_load_dwordx4 v[200:203], v126, s[36:39], s30 offen
    buffer_load_dwordx4 v[204:207], v126, s[40:43], s30 offen
    s_add_u32 s30, s29, 16384
    buffer_load_dwordx4 v[200:203], v126, s[36:39], s30 offen
    buffer_load_dwordx4 v[204:207], v126, s[40:43], s30 offen
    s_add_u32 s30, s29, 17408
    buffer_load_dwordx4 v[200:203], v126, s[36:39], s30 offen
    buffer_load_dwordx4 v[204:207], v126, s[40:43], s30 offen
    s_add_u32 s30, s29, 18432
    buffer_load_dwordx4 v[200:203], v126, s[36:39], s30 offen
    buffer_load_dwordx4 v[204:207], v126, s[40:43], s30 offen
    s_add_u32 s30, s29, 19456
    buffer_load_dwordx4 v[200:203], v126, s[36:39], s30 offen
    buffer_load_dwordx4 v[204:207], v126, s[40:43], s30 offen
    s_add_u32 s30, s29, 20480
    buffer_load_dwordx4 v[200:203], v126, s[36:39], s30 offen
    buffer_load_dwordx4 v[204:207], v126, s[40:43], s30 offen
    s_waitcnt vmcnt(60)
    v_lshlrev_b32 v128, 16, v8
    v_and_b32 v129, 0xffff0000, v8
    v_lshlrev_b32 v130, 16, v9
    v_and_b32 v131, 0xffff0000, v9
    v_lshlrev_b32 v132, 16, v10
    v_and_b32 v133, 0xffff0000, v10
    v_lshlrev_b32 v134, 16, v11
    v_and_b32 v135, 0xffff0000, v11
    v_lshlrev_b32 v136, 16, v12
    v_and_b32 v137, 0xffff0000, v12
    v_lshlrev_b32 v138, 16, v13
    v_and_b32 v139, 0xffff0000, v13
    v_lshlrev_b32 v140, 16, v14
    v_and_b32 v141, 0xffff0000, v14
    v_lshlrev_b32 v142, 16, v15
    v_and_b32 v143, 0xffff0000, v15
    v_lshlrev_b32 v144, 16, v16
    v_and_b32 v145, 0xffff0000, v16
    v_lshlrev_b32 v146, 16, v17
    v_and_b32 v147, 0xffff0000, v17
    v_lshlrev_b32 v148, 16, v18
    v_and_b32 v149, 0xffff0000, v18
    v_lshlrev_b32 v150, 16, v19
    v_and_b32 v151, 0xffff0000, v19
    v_lshlrev_b32 v152, 16, v20
    v_and_b32 v153, 0xffff0000, v20
    v_lshlrev_b32 v154, 16, v21
    v_and_b32 v155, 0xffff0000, v21
    v_lshlrev_b32 v156, 16, v22
    v_and_b32 v157, 0xffff0000, v22
    v_lshlrev_b32 v158, 16, v23
    v_and_b32 v159, 0xffff0000, v23
    v_lshlrev_b32 v160, 16, v24
    v_and_b32 v161, 0xffff0000, v24
    v_lshlrev_b32 v162, 16, v25
    v_and_b32 v163, 0xffff0000, v25
    v_lshlrev_b32 v164, 16, v26
    v_and_b32 v165, 0xffff0000, v26
    v_lshlrev_b32 v166, 16, v27
    v_and_b32 v167, 0xffff0000, v27
    v_lshlrev_b32 v168, 16, v28
    v_and_b32 v169, 0xffff0000, v28
    v_lshlrev_b32 v170, 16, v29
    v_and_b32 v171, 0xffff0000, v29
    v_lshlrev_b32 v172, 16, v30
    v_and_b32 v173, 0xffff0000, v30
    v_lshlrev_b32 v174, 16, v31
    v_and_b32 v175, 0xffff0000, v31
    v_lshlrev_b32 v176, 16, v32
    v_and_b32 v177, 0xffff0000, v32
    v_lshlrev_b32 v178, 16, v33
    v_and_b32 v179, 0xffff0000, v33
    v_lshlrev_b32 v180, 16, v34
    v_and_b32 v181, 0xffff0000, v34
    v_lshlrev_b32 v182, 16, v35
    v_and_b32 v183, 0xffff0000, v35
    v_lshlrev_b32 v184, 16, v36
    v_and_b32 v185, 0xffff0000, v36
    v_lshlrev_b32 v186, 16, v37
    v_and_b32 v187, 0xffff0000, v37
    v_lshlrev_b32 v188, 16, v38
    v_and_b32 v189, 0xffff0000, v38
    v_lshlrev_b32 v190, 16, v39
    v_and_b32 v191, 0xffff0000, v39
    v_lshlrev_b32 v192, 16, v40
    v_and_b32 v193, 0xffff0000, v40
    v_lshlrev_b32 v194, 16, v41
    v_and_b32 v195, 0xffff0000, v41
    v_lshlrev_b32 v196, 16, v42
    v_and_b32 v197, 0xffff0000, v42
    v_lshlrev_b32 v198, 16, v43
    v_and_b32 v199, 0xffff0000, v43
    v_pk_add_f32 v[122:123], v[128:129], v[130:131]
    v_pk_add_f32 v[122:123], v[122:123], v[132:133]
    v_pk_add_f32 v[122:123], v[122:123], v[134:135]
    v_pk_add_f32 v[122:123], v[122:123], v[136:137]
    v_pk_add_f32 v[122:123], v[122:123], v[138:139]
    v_pk_add_f32 v[122:123], v[122:123], v[140:141]
    v_pk_add_f32 v[122:123], v[122:123], v[142:143]
    v_pk_add_f32 v[122:123], v[122:123], v[144:145]
    v_pk_add_f32 v[122:123], v[122:123], v[146:147]
    v_pk_add_f32 v[122:123], v[122:123], v[148:149]
    v_pk_add_f32 v[122:123], v[122:123], v[150:151]
    v_pk_add_f32 v[122:123], v[122:123], v[152:153]
    v_pk_add_f32 v[122:123], v[122:123], v[154:155]
    v_pk_add_f32 v[122:123], v[122:123], v[156:157]
    v_pk_add_f32 v[122:123], v[122:123], v[158:159]
    v_pk_add_f32 v[122:123], v[122:123], v[160:161]
    v_pk_add_f32 v[122:123], v[122:123], v[162:163]
    v_pk_add_f32 v[122:123], v[122:123], v[164:165]
    v_pk_add_f32 v[122:123], v[122:123], v[166:167]
    v_pk_add_f32 v[122:123], v[122:123], v[168:169]
    v_pk_add_f32 v[122:123], v[122:123], v[170:171]
    v_pk_add_f32 v[122:123], v[122:123], v[172:173]
    v_pk_add_f32 v[122:123], v[122:123], v[174:175]
    v_pk_add_f32 v[122:123], v[122:123], v[176:177]
    v_pk_add_f32 v[122:123], v[122:123], v[178:179]
    v_pk_add_f32 v[122:123], v[122:123], v[180:181]
    v_pk_add_f32 v[122:123], v[122:123], v[182:183]
    v_pk_add_f32 v[122:123], v[122:123], v[184:185]
    v_pk_add_f32 v[122:123], v[122:123], v[186:187]
    v_pk_add_f32 v[122:123], v[122:123], v[188:189]
    v_pk_add_f32 v[122:123], v[122:123], v[190:191]
    v_pk_add_f32 v[122:123], v[122:123], v[192:193]
    v_pk_add_f32 v[122:123], v[122:123], v[194:195]
    v_pk_add_f32 v[122:123], v[122:123], v[196:197]
    v_pk_add_f32 v[122:123], v[122:123], v[198:199]
    v_add_f32 v5, v122, v123
    s_nop 1
    v_add_f32_dpp v5, v5, v5 quad_perm:[1,0,3,2] row_mask:0xf bank_mask:0xf
    s_nop 1
    v_add_f32_dpp v5, v5, v5 quad_perm:[2,3,0,1] row_mask:0xf bank_mask:0xf
    s_nop 1
    v_add_f32_dpp v5, v5, v5 row_half_mirror row_mask:0xf bank_mask:0xf
    v_mul_f32 v5, 0x3ae38e39, v5
    v_mov_b32 v6, 0
    v_mov_b32 v124, 0
    v_sub_f32 v7, v128, v5
    v_sub_f32 v125, v129, v5
    v_fmac_f32 v6, v7, v7
    v_fmac_f32 v124, v125, v125
    v_sub_f32 v7, v130, v5
    v_sub_f32 v125, v131, v5
    v_fmac_f32 v6, v7, v7
    v_fmac_f32 v124, v125, v125
    v_sub_f32 v7, v132, v5
    v_sub_f32 v125, v133, v5
    v_fmac_f32 v6, v7, v7
    v_fmac_f32 v124, v125, v125
    v_sub_f32 v7, v134, v5
    v_sub_f32 v125, v135, v5
    v_fmac_f32 v6, v7, v7
    v_fmac_f32 v124, v125, v125
    v_sub_f32 v7, v136, v5
    v_sub_f32 v125, v137, v5
    v_fmac_f32 v6, v7, v7
    v_fmac_f32 v124, v125, v125
    v_sub_f32 v7, v138, v5
    v_sub_f32 v125, v139, v5
    v_fmac_f32 v6, v7, v7
    v_fmac_f32 v124, v125, v125
    v_sub_f32 v7, v140, v5
    v_sub_f32 v125, v141, v5
    v_fmac_f32 v6, v7, v7
    v_fmac_f32 v124, v125, v125
    v_sub_f32 v7, v142, v5
    v_sub_f32 v125, v143, v5
    v_fmac_f32 v6, v7, v7
    v_fmac_f32 v124, v125, v125
    v_sub_f32 v7, v144, v5
    v_sub_f32 v125, v145, v5
    v_fmac_f32 v6, v7, v7
    v_fmac_f32 v124, v125, v125
    v_sub_f32 v7, v146, v5
    v_sub_f32 v125, v147, v5
    v_fmac_f32 v6, v7, v7
    v_fmac_f32 v124, v125, v125
    v_sub_f32 v7, v148, v5
    v_sub_f32 v125, v149, v5
    v_fmac_f32 v6, v7, v7
    v_fmac_f32 v124, v125, v125
    v_sub_f32 v7, v150, v5
    v_sub_f32 v125, v151, v5
    v_fmac_f32 v6, v7, v7
    v_fmac_f32 v124, v125, v125
    v_sub_f32 v7, v152, v5
    v_sub_f32 v125, v153, v5
    v_fmac_f32 v6, v7, v7
    v_fmac_f32 v124, v125, v125
    v_sub_f32 v7, v154, v5
    v_sub_f32 v125, v155, v5
    v_fmac_f32 v6, v7, v7
    v_fmac_f32 v124, v125, v125
    v_sub_f32 v7, v156, v5
    v_sub_f32 v125, v157, v5
    v_fmac_f32 v6, v7, v7
    v_fmac_f32 v124, v125, v125
    v_sub_f32 v7, v158, v5
    v_sub_f32 v125, v159, v5
    v_fmac_f32 v6, v7, v7
    v_fmac_f32 v124, v125, v125
    v_sub_f32 v7, v160, v5
    v_sub_f32 v125, v161, v5
    v_fmac_f32 v6, v7, v7
    v_fmac_f32 v124, v125, v125
    v_sub_f32 v7, v162, v5
    v_sub_f32 v125, v163, v5
    v_fmac_f32 v6, v7, v7
    v_fmac_f32 v124, v125, v125
    v_sub_f32 v7, v164, v5
    v_sub_f32 v125, v165, v5
    v_fmac_f32 v6, v7, v7
    v_fmac_f32 v124, v125, v125
    v_sub_f32 v7, v166, v5
    v_sub_f32 v125, v167, v5
    v_fmac_f32 v6, v7, v7
    v_fmac_f32 v124, v125, v125
    v_sub_f32 v7, v168, v5
    v_sub_f32 v125, v169, v5
    v_fmac_f32 v6, v7, v7
    v_fmac_f32 v124, v125, v125
    v_sub_f32 v7, v170, v5
    v_sub_f32 v125, v171, v5
    v_fmac_f32 v6, v7, v7
    v_fmac_f32 v124, v125, v125
    v_sub_f32 v7, v172, v5
    v_sub_f32 v125, v173, v5
    v_fmac_f32 v6, v7, v7
    v_fmac_f32 v124, v125, v125
    v_sub_f32 v7, v174, v5
    v_sub_f32 v125, v175, v5
    v_fmac_f32 v6, v7, v7
    v_fmac_f32 v124, v125, v125
    v_sub_f32 v7, v176, v5
    v_sub_f32 v125, v177, v5
    v_fmac_f32 v6, v7, v7
    v_fmac_f32 v124, v125, v125
    v_sub_f32 v7, v178, v5
    v_sub_f32 v125, v179, v5
    v_fmac_f32 v6, v7, v7
    v_fmac_f32 v124, v125, v125
    v_sub_f32 v7, v180, v5
    v_sub_f32 v125, v181, v5
    v_fmac_f32 v6, v7, v7
    v_fmac_f32 v124, v125, v125
    v_sub_f32 v7, v182, v5
    v_sub_f32 v125, v183, v5
    v_fmac_f32 v6, v7, v7
    v_fmac_f32 v124, v125, v125
    v_sub_f32 v7, v184, v5
    v_sub_f32 v125, v185, v5
    v_fmac_f32 v6, v7, v7
    v_fmac_f32 v124, v125, v125
    v_sub_f32 v7, v186, v5
    v_sub_f32 v125, v187, v5
    v_fmac_f32 v6, v7, v7
    v_fmac_f32 v124, v125, v125
    v_sub_f32 v7, v188, v5
    v_sub_f32 v125, v189, v5
    v_fmac_f32 v6, v7, v7
    v_fmac_f32 v124, v125, v125
    v_sub_f32 v7, v190, v5
    v_sub_f32 v125, v191, v5
    v_fmac_f32 v6, v7, v7
    v_fmac_f32 v124, v125, v125
    v_sub_f32 v7, v192, v5
    v_sub_f32 v125, v193, v5
    v_fmac_f32 v6, v7, v7
    v_fmac_f32 v124, v125, v125
    v_sub_f32 v7, v194, v5
    v_sub_f32 v125, v195, v5
    v_fmac_f32 v6, v7, v7
    v_fmac_f32 v124, v125, v125
    v_sub_f32 v7, v196, v5
    v_sub_f32 v125, v197, v5
    v_fmac_f32 v6, v7, v7
    v_fmac_f32 v124, v125, v125
    v_sub_f32 v7, v198, v5
    v_sub_f32 v125, v199, v5
    v_fmac_f32 v6, v7, v7
    v_fmac_f32 v124, v125, v125
    v_add_f32 v6, v6, v124
    s_nop 1
    v_add_f32_dpp v6, v6, v6 quad_perm:[1,0,3,2] row_mask:0xf bank_mask:0xf
    s_nop 1
    v_add_f32_dpp v6, v6, v6 quad_perm:[2,3,0,1] row_mask:0xf bank_mask:0xf
    s_nop 1
    v_add_f32_dpp v6, v6, v6 row_half_mirror row_mask:0xf bank_mask:0xf
    v_mul_f32 v6, 0x3ae38e39, v6
    v_cvt_pk_bf16_f32 v7, v5, v6
    v_lshlrev_b32 v5, 16, v7
    v_and_b32 v6, 0xffff0000, v7
    v_add_f32 v6, 0x3727c5ac, v6
    v_cvt_pk_bf16_f32 v7, v6, v6
    v_lshlrev_b32 v6, 16, v7
    v_sqrt_f32 v6, v6
    s_nop 0
    v_cvt_pk_bf16_f32 v7, v6, v6
    v_lshlrev_b32 v6, 16, v7
    v_rcp_f32 v6, v6
    v_sub_f32 v128, v128, v5
    v_sub_f32 v129, v129, v5
    v_cvt_pk_bf16_f32 v122, v128, v129
    v_lshlrev_b32 v128, 16, v122
    v_and_b32 v129, 0xffff0000, v122
    v_mul_f32 v128, v128, v6
    v_mul_f32 v129, v129, v6
    v_cvt_pk_bf16_f32 v124, v128, v129
    v_lshlrev_b32 v128, 16, v124
    v_and_b32 v129, 0xffff0000, v124
    v_sub_f32 v130, v130, v5
    v_sub_f32 v131, v131, v5
    v_cvt_pk_bf16_f32 v7, v130, v131
    v_lshlrev_b32 v130, 16, v7
    v_and_b32 v131, 0xffff0000, v7
    v_mul_f32 v130, v130, v6
    v_mul_f32 v131, v131, v6
    v_cvt_pk_bf16_f32 v123, v130, v131
    v_lshlrev_b32 v130, 16, v123
    v_and_b32 v131, 0xffff0000, v123
    v_sub_f32 v132, v132, v5
    v_sub_f32 v133, v133, v5
    v_cvt_pk_bf16_f32 v122, v132, v133
    v_lshlrev_b32 v132, 16, v122
    v_and_b32 v133, 0xffff0000, v122
    v_mul_f32 v132, v132, v6
    v_mul_f32 v133, v133, v6
    v_cvt_pk_bf16_f32 v124, v132, v133
    v_lshlrev_b32 v132, 16, v124
    v_and_b32 v133, 0xffff0000, v124
    v_sub_f32 v134, v134, v5
    v_sub_f32 v135, v135, v5
    v_cvt_pk_bf16_f32 v7, v134, v135
    v_lshlrev_b32 v134, 16, v7
    v_and_b32 v135, 0xffff0000, v7
    v_mul_f32 v134, v134, v6
    v_mul_f32 v135, v135, v6
    v_cvt_pk_bf16_f32 v123, v134, v135
    v_lshlrev_b32 v134, 16, v123
    v_and_b32 v135, 0xffff0000, v123
    v_sub_f32 v136, v136, v5
    v_sub_f32 v137, v137, v5
    v_cvt_pk_bf16_f32 v122, v136, v137
    v_lshlrev_b32 v136, 16, v122
    v_and_b32 v137, 0xffff0000, v122
    v_mul_f32 v136, v136, v6
    v_mul_f32 v137, v137, v6
    v_cvt_pk_bf16_f32 v124, v136, v137
    v_lshlrev_b32 v136, 16, v124
    v_and_b32 v137, 0xffff0000, v124
    v_sub_f32 v138, v138, v5
    v_sub_f32 v139, v139, v5
    v_cvt_pk_bf16_f32 v7, v138, v139
    v_lshlrev_b32 v138, 16, v7
    v_and_b32 v139, 0xffff0000, v7
    v_mul_f32 v138, v138, v6
    v_mul_f32 v139, v139, v6
    v_cvt_pk_bf16_f32 v123, v138, v139
    v_lshlrev_b32 v138, 16, v123
    v_and_b32 v139, 0xffff0000, v123
    v_sub_f32 v140, v140, v5
    v_sub_f32 v141, v141, v5
    v_cvt_pk_bf16_f32 v122, v140, v141
    v_lshlrev_b32 v140, 16, v122
    v_and_b32 v141, 0xffff0000, v122
    v_mul_f32 v140, v140, v6
    v_mul_f32 v141, v141, v6
    v_cvt_pk_bf16_f32 v124, v140, v141
    v_lshlrev_b32 v140, 16, v124
    v_and_b32 v141, 0xffff0000, v124
    v_sub_f32 v142, v142, v5
    v_sub_f32 v143, v143, v5
    v_cvt_pk_bf16_f32 v7, v142, v143
    v_lshlrev_b32 v142, 16, v7
    v_and_b32 v143, 0xffff0000, v7
    v_mul_f32 v142, v142, v6
    v_mul_f32 v143, v143, v6
    v_cvt_pk_bf16_f32 v123, v142, v143
    v_lshlrev_b32 v142, 16, v123
    v_and_b32 v143, 0xffff0000, v123
    v_sub_f32 v144, v144, v5
    v_sub_f32 v145, v145, v5
    v_cvt_pk_bf16_f32 v122, v144, v145
    v_lshlrev_b32 v144, 16, v122
    v_and_b32 v145, 0xffff0000, v122
    v_mul_f32 v144, v144, v6
    v_mul_f32 v145, v145, v6
    v_cvt_pk_bf16_f32 v124, v144, v145
    v_lshlrev_b32 v144, 16, v124
    v_and_b32 v145, 0xffff0000, v124
    v_sub_f32 v146, v146, v5
    v_sub_f32 v147, v147, v5
    v_cvt_pk_bf16_f32 v7, v146, v147
    v_lshlrev_b32 v146, 16, v7
    v_and_b32 v147, 0xffff0000, v7
    v_mul_f32 v146, v146, v6
    v_mul_f32 v147, v147, v6
    v_cvt_pk_bf16_f32 v123, v146, v147
    v_lshlrev_b32 v146, 16, v123
    v_and_b32 v147, 0xffff0000, v123
    v_sub_f32 v148, v148, v5
    v_sub_f32 v149, v149, v5
    v_cvt_pk_bf16_f32 v122, v148, v149
    v_lshlrev_b32 v148, 16, v122
    v_and_b32 v149, 0xffff0000, v122
    v_mul_f32 v148, v148, v6
    v_mul_f32 v149, v149, v6
    v_cvt_pk_bf16_f32 v124, v148, v149
    v_lshlrev_b32 v148, 16, v124
    v_and_b32 v149, 0xffff0000, v124
    v_sub_f32 v150, v150, v5
    v_sub_f32 v151, v151, v5
    v_cvt_pk_bf16_f32 v7, v150, v151
    v_lshlrev_b32 v150, 16, v7
    v_and_b32 v151, 0xffff0000, v7
    v_mul_f32 v150, v150, v6
    v_mul_f32 v151, v151, v6
    v_cvt_pk_bf16_f32 v123, v150, v151
    v_lshlrev_b32 v150, 16, v123
    v_and_b32 v151, 0xffff0000, v123
    v_sub_f32 v152, v152, v5
    v_sub_f32 v153, v153, v5
    v_cvt_pk_bf16_f32 v122, v152, v153
    v_lshlrev_b32 v152, 16, v122
    v_and_b32 v153, 0xffff0000, v122
    v_mul_f32 v152, v152, v6
    v_mul_f32 v153, v153, v6
    v_cvt_pk_bf16_f32 v124, v152, v153
    v_lshlrev_b32 v152, 16, v124
    v_and_b32 v153, 0xffff0000, v124
    v_sub_f32 v154, v154, v5
    v_sub_f32 v155, v155, v5
    v_cvt_pk_bf16_f32 v7, v154, v155
    v_lshlrev_b32 v154, 16, v7
    v_and_b32 v155, 0xffff0000, v7
    v_mul_f32 v154, v154, v6
    v_mul_f32 v155, v155, v6
    v_cvt_pk_bf16_f32 v123, v154, v155
    v_lshlrev_b32 v154, 16, v123
    v_and_b32 v155, 0xffff0000, v123
    v_sub_f32 v156, v156, v5
    v_sub_f32 v157, v157, v5
    v_cvt_pk_bf16_f32 v122, v156, v157
    v_lshlrev_b32 v156, 16, v122
    v_and_b32 v157, 0xffff0000, v122
    v_mul_f32 v156, v156, v6
    v_mul_f32 v157, v157, v6
    v_cvt_pk_bf16_f32 v124, v156, v157
    v_lshlrev_b32 v156, 16, v124
    v_and_b32 v157, 0xffff0000, v124
    v_sub_f32 v158, v158, v5
    v_sub_f32 v159, v159, v5
    v_cvt_pk_bf16_f32 v7, v158, v159
    v_lshlrev_b32 v158, 16, v7
    v_and_b32 v159, 0xffff0000, v7
    v_mul_f32 v158, v158, v6
    v_mul_f32 v159, v159, v6
    v_cvt_pk_bf16_f32 v123, v158, v159
    v_lshlrev_b32 v158, 16, v123
    v_and_b32 v159, 0xffff0000, v123
    v_sub_f32 v160, v160, v5
    v_sub_f32 v161, v161, v5
    v_cvt_pk_bf16_f32 v122, v160, v161
    v_lshlrev_b32 v160, 16, v122
    v_and_b32 v161, 0xffff0000, v122
    v_mul_f32 v160, v160, v6
    v_mul_f32 v161, v161, v6
    v_cvt_pk_bf16_f32 v124, v160, v161
    v_lshlrev_b32 v160, 16, v124
    v_and_b32 v161, 0xffff0000, v124
    v_sub_f32 v162, v162, v5
    v_sub_f32 v163, v163, v5
    v_cvt_pk_bf16_f32 v7, v162, v163
    v_lshlrev_b32 v162, 16, v7
    v_and_b32 v163, 0xffff0000, v7
    v_mul_f32 v162, v162, v6
    v_mul_f32 v163, v163, v6
    v_cvt_pk_bf16_f32 v123, v162, v163
    v_lshlrev_b32 v162, 16, v123
    v_and_b32 v163, 0xffff0000, v123
    v_sub_f32 v164, v164, v5
    v_sub_f32 v165, v165, v5
    v_cvt_pk_bf16_f32 v122, v164, v165
    v_lshlrev_b32 v164, 16, v122
    v_and_b32 v165, 0xffff0000, v122
    v_mul_f32 v164, v164, v6
    v_mul_f32 v165, v165, v6
    v_cvt_pk_bf16_f32 v124, v164, v165
    v_lshlrev_b32 v164, 16, v124
    v_and_b32 v165, 0xffff0000, v124
    v_sub_f32 v166, v166, v5
    v_sub_f32 v167, v167, v5
    v_cvt_pk_bf16_f32 v7, v166, v167
    v_lshlrev_b32 v166, 16, v7
    v_and_b32 v167, 0xffff0000, v7
    v_mul_f32 v166, v166, v6
    v_mul_f32 v167, v167, v6
    v_cvt_pk_bf16_f32 v123, v166, v167
    v_lshlrev_b32 v166, 16, v123
    v_and_b32 v167, 0xffff0000, v123
    v_sub_f32 v168, v168, v5
    v_sub_f32 v169, v169, v5
    v_cvt_pk_bf16_f32 v122, v168, v169
    v_lshlrev_b32 v168, 16, v122
    v_and_b32 v169, 0xffff0000, v122
    v_mul_f32 v168, v168, v6
    v_mul_f32 v169, v169, v6
    v_cvt_pk_bf16_f32 v124, v168, v169
    v_lshlrev_b32 v168, 16, v124
    v_and_b32 v169, 0xffff0000, v124
    v_sub_f32 v170, v170, v5
    v_sub_f32 v171, v171, v5
    v_cvt_pk_bf16_f32 v7, v170, v171
    v_lshlrev_b32 v170, 16, v7
    v_and_b32 v171, 0xffff0000, v7
    v_mul_f32 v170, v170, v6
    v_mul_f32 v171, v171, v6
    v_cvt_pk_bf16_f32 v123, v170, v171
    v_lshlrev_b32 v170, 16, v123
    v_and_b32 v171, 0xffff0000, v123
    v_sub_f32 v172, v172, v5
    v_sub_f32 v173, v173, v5
    v_cvt_pk_bf16_f32 v122, v172, v173
    v_lshlrev_b32 v172, 16, v122
    v_and_b32 v173, 0xffff0000, v122
    v_mul_f32 v172, v172, v6
    v_mul_f32 v173, v173, v6
    v_cvt_pk_bf16_f32 v124, v172, v173
    v_lshlrev_b32 v172, 16, v124
    v_and_b32 v173, 0xffff0000, v124
    v_sub_f32 v174, v174, v5
    v_sub_f32 v175, v175, v5
    v_cvt_pk_bf16_f32 v7, v174, v175
    v_lshlrev_b32 v174, 16, v7
    v_and_b32 v175, 0xffff0000, v7
    v_mul_f32 v174, v174, v6
    v_mul_f32 v175, v175, v6
    v_cvt_pk_bf16_f32 v123, v174, v175
    v_lshlrev_b32 v174, 16, v123
    v_and_b32 v175, 0xffff0000, v123
    v_sub_f32 v176, v176, v5
    v_sub_f32 v177, v177, v5
    v_cvt_pk_bf16_f32 v122, v176, v177
    v_lshlrev_b32 v176, 16, v122
    v_and_b32 v177, 0xffff0000, v122
    v_mul_f32 v176, v176, v6
    v_mul_f32 v177, v177, v6
    v_cvt_pk_bf16_f32 v124, v176, v177
    v_lshlrev_b32 v176, 16, v124
    v_and_b32 v177, 0xffff0000, v124
    v_sub_f32 v178, v178, v5
    v_sub_f32 v179, v179, v5
    v_cvt_pk_bf16_f32 v7, v178, v179
    v_lshlrev_b32 v178, 16, v7
    v_and_b32 v179, 0xffff0000, v7
    v_mul_f32 v178, v178, v6
    v_mul_f32 v179, v179, v6
    v_cvt_pk_bf16_f32 v123, v178, v179
    v_lshlrev_b32 v178, 16, v123
    v_and_b32 v179, 0xffff0000, v123
    v_sub_f32 v180, v180, v5
    v_sub_f32 v181, v181, v5
    v_cvt_pk_bf16_f32 v122, v180, v181
    v_lshlrev_b32 v180, 16, v122
    v_and_b32 v181, 0xffff0000, v122
    v_mul_f32 v180, v180, v6
    v_mul_f32 v181, v181, v6
    v_cvt_pk_bf16_f32 v124, v180, v181
    v_lshlrev_b32 v180, 16, v124
    v_and_b32 v181, 0xffff0000, v124
    v_sub_f32 v182, v182, v5
    v_sub_f32 v183, v183, v5
    v_cvt_pk_bf16_f32 v7, v182, v183
    v_lshlrev_b32 v182, 16, v7
    v_and_b32 v183, 0xffff0000, v7
    v_mul_f32 v182, v182, v6
    v_mul_f32 v183, v183, v6
    v_cvt_pk_bf16_f32 v123, v182, v183
    v_lshlrev_b32 v182, 16, v123
    v_and_b32 v183, 0xffff0000, v123
    v_sub_f32 v184, v184, v5
    v_sub_f32 v185, v185, v5
    v_cvt_pk_bf16_f32 v122, v184, v185
    v_lshlrev_b32 v184, 16, v122
    v_and_b32 v185, 0xffff0000, v122
    v_mul_f32 v184, v184, v6
    v_mul_f32 v185, v185, v6
    v_cvt_pk_bf16_f32 v124, v184, v185
    v_lshlrev_b32 v184, 16, v124
    v_and_b32 v185, 0xffff0000, v124
    v_sub_f32 v186, v186, v5
    v_sub_f32 v187, v187, v5
    v_cvt_pk_bf16_f32 v7, v186, v187
    v_lshlrev_b32 v186, 16, v7
    v_and_b32 v187, 0xffff0000, v7
    v_mul_f32 v186, v186, v6
    v_mul_f32 v187, v187, v6
    v_cvt_pk_bf16_f32 v123, v186, v187
    v_lshlrev_b32 v186, 16, v123
    v_and_b32 v187, 0xffff0000, v123
    v_sub_f32 v188, v188, v5
    v_sub_f32 v189, v189, v5
    v_cvt_pk_bf16_f32 v122, v188, v189
    v_lshlrev_b32 v188, 16, v122
    v_and_b32 v189, 0xffff0000, v122
    v_mul_f32 v188, v188, v6
    v_mul_f32 v189, v189, v6
    v_cvt_pk_bf16_f32 v124, v188, v189
    v_lshlrev_b32 v188, 16, v124
    v_and_b32 v189, 0xffff0000, v124
    v_sub_f32 v190, v190, v5
    v_sub_f32 v191, v191, v5
    v_cvt_pk_bf16_f32 v7, v190, v191
    v_lshlrev_b32 v190, 16, v7
    v_and_b32 v191, 0xffff0000, v7
    v_mul_f32 v190, v190, v6
    v_mul_f32 v191, v191, v6
    v_cvt_pk_bf16_f32 v123, v190, v191
    v_lshlrev_b32 v190, 16, v123
    v_and_b32 v191, 0xffff0000, v123
    v_sub_f32 v192, v192, v5
    v_sub_f32 v193, v193, v5
    v_cvt_pk_bf16_f32 v122, v192, v193
    v_lshlrev_b32 v192, 16, v122
    v_and_b32 v193, 0xffff0000, v122
    v_mul_f32 v192, v192, v6
    v_mul_f32 v193, v193, v6
    v_cvt_pk_bf16_f32 v124, v192, v193
    v_lshlrev_b32 v192, 16, v124
    v_and_b32 v193, 0xffff0000, v124
    v_sub_f32 v194, v194, v5
    v_sub_f32 v195, v195, v5
    v_cvt_pk_bf16_f32 v7, v194, v195
    v_lshlrev_b32 v194, 16, v7
    v_and_b32 v195, 0xffff0000, v7
    v_mul_f32 v194, v194, v6
    v_mul_f32 v195, v195, v6
    v_cvt_pk_bf16_f32 v123, v194, v195
    v_lshlrev_b32 v194, 16, v123
    v_and_b32 v195, 0xffff0000, v123
    v_sub_f32 v196, v196, v5
    v_sub_f32 v197, v197, v5
    v_cvt_pk_bf16_f32 v122, v196, v197
    v_lshlrev_b32 v196, 16, v122
    v_and_b32 v197, 0xffff0000, v122
    v_mul_f32 v196, v196, v6
    v_mul_f32 v197, v197, v6
    v_cvt_pk_bf16_f32 v124, v196, v197
    v_lshlrev_b32 v196, 16, v124
    v_and_b32 v197, 0xffff0000, v124
    v_sub_f32 v198, v198, v5
    v_sub_f32 v199, v199, v5
    v_cvt_pk_bf16_f32 v7, v198, v199
    v_lshlrev_b32 v198, 16, v7
    v_and_b32 v199, 0xffff0000, v7
    v_mul_f32 v198, v198, v6
    v_mul_f32 v199, v199, v6
    v_cvt_pk_bf16_f32 v123, v198, v199
    v_lshlrev_b32 v198, 16, v123
    v_and_b32 v199, 0xffff0000, v123
    s_waitcnt vmcnt(42)
    v_lshlrev_b32 v122, 16, v44
    v_and_b32 v123, 0xffff0000, v44
    v_lshlrev_b32 v124, 16, v80
    v_and_b32 v125, 0xffff0000, v80
    v_mul_f32 v128, v128, v122
    v_mul_f32 v129, v129, v123
    v_cvt_pk_bf16_f32 v7, v128, v129
    v_lshlrev_b32 v128, 16, v7
    v_and_b32 v129, 0xffff0000, v7
    v_add_f32 v128, v128, v124
    v_add_f32 v129, v129, v125
    v_cvt_pk_bf16_f32 v8, v128, v129
    v_lshlrev_b32 v122, 16, v45
    v_and_b32 v123, 0xffff0000, v45
    v_lshlrev_b32 v124, 16, v81
    v_and_b32 v125, 0xffff0000, v81
    v_mul_f32 v130, v130, v122
    v_mul_f32 v131, v131, v123
    v_cvt_pk_bf16_f32 v7, v130, v131
    v_lshlrev_b32 v130, 16, v7
    v_and_b32 v131, 0xffff0000, v7
    v_add_f32 v130, v130, v124
    v_add_f32 v131, v131, v125
    v_cvt_pk_bf16_f32 v9, v130, v131
    v_lshlrev_b32 v122, 16, v46
    v_and_b32 v123, 0xffff0000, v46
    v_lshlrev_b32 v124, 16, v82
    v_and_b32 v125, 0xffff0000, v82
    v_mul_f32 v132, v132, v122
    v_mul_f32 v133, v133, v123
    v_cvt_pk_bf16_f32 v7, v132, v133
    v_lshlrev_b32 v132, 16, v7
    v_and_b32 v133, 0xffff0000, v7
    v_add_f32 v132, v132, v124
    v_add_f32 v133, v133, v125
    v_cvt_pk_bf16_f32 v10, v132, v133
    v_lshlrev_b32 v122, 16, v47
    v_and_b32 v123, 0xffff0000, v47
    v_lshlrev_b32 v124, 16, v83
    v_and_b32 v125, 0xffff0000, v83
    v_mul_f32 v134, v134, v122
    v_mul_f32 v135, v135, v123
    v_cvt_pk_bf16_f32 v7, v134, v135
    v_lshlrev_b32 v134, 16, v7
    v_and_b32 v135, 0xffff0000, v7
    v_add_f32 v134, v134, v124
    v_add_f32 v135, v135, v125
    v_cvt_pk_bf16_f32 v11, v134, v135
    s_mov_b32 s28, 0
    buffer_store_dwordx4 v[8:11], v120, s[20:23], s28 offen
    v_lshlrev_b32 v122, 16, v48
    v_and_b32 v123, 0xffff0000, v48
    v_lshlrev_b32 v124, 16, v84
    v_and_b32 v125, 0xffff0000, v84
    v_mul_f32 v136, v136, v122
    v_mul_f32 v137, v137, v123
    v_cvt_pk_bf16_f32 v7, v136, v137
    v_lshlrev_b32 v136, 16, v7
    v_and_b32 v137, 0xffff0000, v7
    v_add_f32 v136, v136, v124
    v_add_f32 v137, v137, v125
    v_cvt_pk_bf16_f32 v12, v136, v137
    v_lshlrev_b32 v122, 16, v49
    v_and_b32 v123, 0xffff0000, v49
    v_lshlrev_b32 v124, 16, v85
    v_and_b32 v125, 0xffff0000, v85
    v_mul_f32 v138, v138, v122
    v_mul_f32 v139, v139, v123
    v_cvt_pk_bf16_f32 v7, v138, v139
    v_lshlrev_b32 v138, 16, v7
    v_and_b32 v139, 0xffff0000, v7
    v_add_f32 v138, v138, v124
    v_add_f32 v139, v139, v125
    v_cvt_pk_bf16_f32 v13, v138, v139
    v_lshlrev_b32 v122, 16, v50
    v_and_b32 v123, 0xffff0000, v50
    v_lshlrev_b32 v124, 16, v86
    v_and_b32 v125, 0xffff0000, v86
    v_mul_f32 v140, v140, v122
    v_mul_f32 v141, v141, v123
    v_cvt_pk_bf16_f32 v7, v140, v141
    v_lshlrev_b32 v140, 16, v7
    v_and_b32 v141, 0xffff0000, v7
    v_add_f32 v140, v140, v124
    v_add_f32 v141, v141, v125
    v_cvt_pk_bf16_f32 v14, v140, v141
    v_lshlrev_b32 v122, 16, v51
    v_and_b32 v123, 0xffff0000, v51
    v_lshlrev_b32 v124, 16, v87
    v_and_b32 v125, 0xffff0000, v87
    v_mul_f32 v142, v142, v122
    v_mul_f32 v143, v143, v123
    v_cvt_pk_bf16_f32 v7, v142, v143
    v_lshlrev_b32 v142, 16, v7
    v_and_b32 v143, 0xffff0000, v7
    v_add_f32 v142, v142, v124
    v_add_f32 v143, v143, v125
    v_cvt_pk_bf16_f32 v15, v142, v143
    s_mov_b32 s28, 4096
    buffer_store_dwordx4 v[12:15], v120, s[20:23], s28 offen
    v_lshlrev_b32 v122, 16, v52
    v_and_b32 v123, 0xffff0000, v52
    v_lshlrev_b32 v124, 16, v88
    v_and_b32 v125, 0xffff0000, v88
    v_mul_f32 v144, v144, v122
    v_mul_f32 v145, v145, v123
    v_cvt_pk_bf16_f32 v7, v144, v145
    v_lshlrev_b32 v144, 16, v7
    v_and_b32 v145, 0xffff0000, v7
    v_add_f32 v144, v144, v124
    v_add_f32 v145, v145, v125
    v_cvt_pk_bf16_f32 v16, v144, v145
    v_lshlrev_b32 v122, 16, v53
    v_and_b32 v123, 0xffff0000, v53
    v_lshlrev_b32 v124, 16, v89
    v_and_b32 v125, 0xffff0000, v89
    v_mul_f32 v146, v146, v122
    v_mul_f32 v147, v147, v123
    v_cvt_pk_bf16_f32 v7, v146, v147
    v_lshlrev_b32 v146, 16, v7
    v_and_b32 v147, 0xffff0000, v7
    v_add_f32 v146, v146, v124
    v_add_f32 v147, v147, v125
    v_cvt_pk_bf16_f32 v17, v146, v147
    v_lshlrev_b32 v122, 16, v54
    v_and_b32 v123, 0xffff0000, v54
    v_lshlrev_b32 v124, 16, v90
    v_and_b32 v125, 0xffff0000, v90
    v_mul_f32 v148, v148, v122
    v_mul_f32 v149, v149, v123
    v_cvt_pk_bf16_f32 v7, v148, v149
    v_lshlrev_b32 v148, 16, v7
    v_and_b32 v149, 0xffff0000, v7
    v_add_f32 v148, v148, v124
    v_add_f32 v149, v149, v125
    v_cvt_pk_bf16_f32 v18, v148, v149
    v_lshlrev_b32 v122, 16, v55
    v_and_b32 v123, 0xffff0000, v55
    v_lshlrev_b32 v124, 16, v91
    v_and_b32 v125, 0xffff0000, v91
    v_mul_f32 v150, v150, v122
    v_mul_f32 v151, v151, v123
    v_cvt_pk_bf16_f32 v7, v150, v151
    v_lshlrev_b32 v150, 16, v7
    v_and_b32 v151, 0xffff0000, v7
    v_add_f32 v150, v150, v124
    v_add_f32 v151, v151, v125
    v_cvt_pk_bf16_f32 v19, v150, v151
    s_mov_b32 s28, 8192
    buffer_store_dwordx4 v[16:19], v120, s[20:23], s28 offen
    v_lshlrev_b32 v122, 16, v56
    v_and_b32 v123, 0xffff0000, v56
    v_lshlrev_b32 v124, 16, v92
    v_and_b32 v125, 0xffff0000, v92
    v_mul_f32 v152, v152, v122
    v_mul_f32 v153, v153, v123
    v_cvt_pk_bf16_f32 v7, v152, v153
    v_lshlrev_b32 v152, 16, v7
    v_and_b32 v153, 0xffff0000, v7
    v_add_f32 v152, v152, v124
    v_add_f32 v153, v153, v125
    v_cvt_pk_bf16_f32 v20, v152, v153
    v_lshlrev_b32 v122, 16, v57
    v_and_b32 v123, 0xffff0000, v57
    v_lshlrev_b32 v124, 16, v93
    v_and_b32 v125, 0xffff0000, v93
    v_mul_f32 v154, v154, v122
    v_mul_f32 v155, v155, v123
    v_cvt_pk_bf16_f32 v7, v154, v155
    v_lshlrev_b32 v154, 16, v7
    v_and_b32 v155, 0xffff0000, v7
    v_add_f32 v154, v154, v124
    v_add_f32 v155, v155, v125
    v_cvt_pk_bf16_f32 v21, v154, v155
    v_lshlrev_b32 v122, 16, v58
    v_and_b32 v123, 0xffff0000, v58
    v_lshlrev_b32 v124, 16, v94
    v_and_b32 v125, 0xffff0000, v94
    v_mul_f32 v156, v156, v122
    v_mul_f32 v157, v157, v123
    v_cvt_pk_bf16_f32 v7, v156, v157
    v_lshlrev_b32 v156, 16, v7
    v_and_b32 v157, 0xffff0000, v7
    v_add_f32 v156, v156, v124
    v_add_f32 v157, v157, v125
    v_cvt_pk_bf16_f32 v22, v156, v157
    v_lshlrev_b32 v122, 16, v59
    v_and_b32 v123, 0xffff0000, v59
    v_lshlrev_b32 v124, 16, v95
    v_and_b32 v125, 0xffff0000, v95
    v_mul_f32 v158, v158, v122
    v_mul_f32 v159, v159, v123
    v_cvt_pk_bf16_f32 v7, v158, v159
    v_lshlrev_b32 v158, 16, v7
    v_and_b32 v159, 0xffff0000, v7
    v_add_f32 v158, v158, v124
    v_add_f32 v159, v159, v125
    v_cvt_pk_bf16_f32 v23, v158, v159
    s_mov_b32 s28, 12288
    buffer_store_dwordx4 v[20:23], v120, s[20:23], s28 offen
    v_lshlrev_b32 v122, 16, v60
    v_and_b32 v123, 0xffff0000, v60
    v_lshlrev_b32 v124, 16, v96
    v_and_b32 v125, 0xffff0000, v96
    v_mul_f32 v160, v160, v122
    v_mul_f32 v161, v161, v123
    v_cvt_pk_bf16_f32 v7, v160, v161
    v_lshlrev_b32 v160, 16, v7
    v_and_b32 v161, 0xffff0000, v7
    v_add_f32 v160, v160, v124
    v_add_f32 v161, v161, v125
    v_cvt_pk_bf16_f32 v24, v160, v161
    v_lshlrev_b32 v122, 16, v61
    v_and_b32 v123, 0xffff0000, v61
    v_lshlrev_b32 v124, 16, v97
    v_and_b32 v125, 0xffff0000, v97
    v_mul_f32 v162, v162, v122
    v_mul_f32 v163, v163, v123
    v_cvt_pk_bf16_f32 v7, v162, v163
    v_lshlrev_b32 v162, 16, v7
    v_and_b32 v163, 0xffff0000, v7
    v_add_f32 v162, v162, v124
    v_add_f32 v163, v163, v125
    v_cvt_pk_bf16_f32 v25, v162, v163
    v_lshlrev_b32 v122, 16, v62
    v_and_b32 v123, 0xffff0000, v62
    v_lshlrev_b32 v124, 16, v98
    v_and_b32 v125, 0xffff0000, v98
    v_mul_f32 v164, v164, v122
    v_mul_f32 v165, v165, v123
    v_cvt_pk_bf16_f32 v7, v164, v165
    v_lshlrev_b32 v164, 16, v7
    v_and_b32 v165, 0xffff0000, v7
    v_add_f32 v164, v164, v124
    v_add_f32 v165, v165, v125
    v_cvt_pk_bf16_f32 v26, v164, v165
    v_lshlrev_b32 v122, 16, v63
    v_and_b32 v123, 0xffff0000, v63
    v_lshlrev_b32 v124, 16, v99
    v_and_b32 v125, 0xffff0000, v99
    v_mul_f32 v166, v166, v122
    v_mul_f32 v167, v167, v123
    v_cvt_pk_bf16_f32 v7, v166, v167
    v_lshlrev_b32 v166, 16, v7
    v_and_b32 v167, 0xffff0000, v7
    v_add_f32 v166, v166, v124
    v_add_f32 v167, v167, v125
    v_cvt_pk_bf16_f32 v27, v166, v167
    s_mov_b32 s28, 16384
    buffer_store_dwordx4 v[24:27], v120, s[20:23], s28 offen
    v_lshlrev_b32 v122, 16, v64
    v_and_b32 v123, 0xffff0000, v64
    v_lshlrev_b32 v124, 16, v100
    v_and_b32 v125, 0xffff0000, v100
    v_mul_f32 v168, v168, v122
    v_mul_f32 v169, v169, v123
    v_cvt_pk_bf16_f32 v7, v168, v169
    v_lshlrev_b32 v168, 16, v7
    v_and_b32 v169, 0xffff0000, v7
    v_add_f32 v168, v168, v124
    v_add_f32 v169, v169, v125
    v_cvt_pk_bf16_f32 v28, v168, v169
    v_lshlrev_b32 v122, 16, v65
    v_and_b32 v123, 0xffff0000, v65
    v_lshlrev_b32 v124, 16, v101
    v_and_b32 v125, 0xffff0000, v101
    v_mul_f32 v170, v170, v122
    v_mul_f32 v171, v171, v123
    v_cvt_pk_bf16_f32 v7, v170, v171
    v_lshlrev_b32 v170, 16, v7
    v_and_b32 v171, 0xffff0000, v7
    v_add_f32 v170, v170, v124
    v_add_f32 v171, v171, v125
    v_cvt_pk_bf16_f32 v29, v170, v171
    v_lshlrev_b32 v122, 16, v66
    v_and_b32 v123, 0xffff0000, v66
    v_lshlrev_b32 v124, 16, v102
    v_and_b32 v125, 0xffff0000, v102
    v_mul_f32 v172, v172, v122
    v_mul_f32 v173, v173, v123
    v_cvt_pk_bf16_f32 v7, v172, v173
    v_lshlrev_b32 v172, 16, v7
    v_and_b32 v173, 0xffff0000, v7
    v_add_f32 v172, v172, v124
    v_add_f32 v173, v173, v125
    v_cvt_pk_bf16_f32 v30, v172, v173
    v_lshlrev_b32 v122, 16, v67
    v_and_b32 v123, 0xffff0000, v67
    v_lshlrev_b32 v124, 16, v103
    v_and_b32 v125, 0xffff0000, v103
    v_mul_f32 v174, v174, v122
    v_mul_f32 v175, v175, v123
    v_cvt_pk_bf16_f32 v7, v174, v175
    v_lshlrev_b32 v174, 16, v7
    v_and_b32 v175, 0xffff0000, v7
    v_add_f32 v174, v174, v124
    v_add_f32 v175, v175, v125
    v_cvt_pk_bf16_f32 v31, v174, v175
    s_mov_b32 s28, 20480
    buffer_store_dwordx4 v[28:31], v120, s[20:23], s28 offen
    v_lshlrev_b32 v122, 16, v68
    v_and_b32 v123, 0xffff0000, v68
    v_lshlrev_b32 v124, 16, v104
    v_and_b32 v125, 0xffff0000, v104
    v_mul_f32 v176, v176, v122
    v_mul_f32 v177, v177, v123
    v_cvt_pk_bf16_f32 v7, v176, v177
    v_lshlrev_b32 v176, 16, v7
    v_and_b32 v177, 0xffff0000, v7
    v_add_f32 v176, v176, v124
    v_add_f32 v177, v177, v125
    v_cvt_pk_bf16_f32 v32, v176, v177
    v_lshlrev_b32 v122, 16, v69
    v_and_b32 v123, 0xffff0000, v69
    v_lshlrev_b32 v124, 16, v105
    v_and_b32 v125, 0xffff0000, v105
    v_mul_f32 v178, v178, v122
    v_mul_f32 v179, v179, v123
    v_cvt_pk_bf16_f32 v7, v178, v179
    v_lshlrev_b32 v178, 16, v7
    v_and_b32 v179, 0xffff0000, v7
    v_add_f32 v178, v178, v124
    v_add_f32 v179, v179, v125
    v_cvt_pk_bf16_f32 v33, v178, v179
    v_lshlrev_b32 v122, 16, v70
    v_and_b32 v123, 0xffff0000, v70
    v_lshlrev_b32 v124, 16, v106
    v_and_b32 v125, 0xffff0000, v106
    v_mul_f32 v180, v180, v122
    v_mul_f32 v181, v181, v123
    v_cvt_pk_bf16_f32 v7, v180, v181
    v_lshlrev_b32 v180, 16, v7
    v_and_b32 v181, 0xffff0000, v7
    v_add_f32 v180, v180, v124
    v_add_f32 v181, v181, v125
    v_cvt_pk_bf16_f32 v34, v180, v181
    v_lshlrev_b32 v122, 16, v71
    v_and_b32 v123, 0xffff0000, v71
    v_lshlrev_b32 v124, 16, v107
    v_and_b32 v125, 0xffff0000, v107
    v_mul_f32 v182, v182, v122
    v_mul_f32 v183, v183, v123
    v_cvt_pk_bf16_f32 v7, v182, v183
    v_lshlrev_b32 v182, 16, v7
    v_and_b32 v183, 0xffff0000, v7
    v_add_f32 v182, v182, v124
    v_add_f32 v183, v183, v125
    v_cvt_pk_bf16_f32 v35, v182, v183
    s_mov_b32 s28, 24576
    buffer_store_dwordx4 v[32:35], v120, s[20:23], s28 offen
    v_lshlrev_b32 v122, 16, v72
    v_and_b32 v123, 0xffff0000, v72
    v_lshlrev_b32 v124, 16, v108
    v_and_b32 v125, 0xffff0000, v108
    v_mul_f32 v184, v184, v122
    v_mul_f32 v185, v185, v123
    v_cvt_pk_bf16_f32 v7, v184, v185
    v_lshlrev_b32 v184, 16, v7
    v_and_b32 v185, 0xffff0000, v7
    v_add_f32 v184, v184, v124
    v_add_f32 v185, v185, v125
    v_cvt_pk_bf16_f32 v36, v184, v185
    v_lshlrev_b32 v122, 16, v73
    v_and_b32 v123, 0xffff0000, v73
    v_lshlrev_b32 v124, 16, v109
    v_and_b32 v125, 0xffff0000, v109
    v_mul_f32 v186, v186, v122
    v_mul_f32 v187, v187, v123
    v_cvt_pk_bf16_f32 v7, v186, v187
    v_lshlrev_b32 v186, 16, v7
    v_and_b32 v187, 0xffff0000, v7
    v_add_f32 v186, v186, v124
    v_add_f32 v187, v187, v125
    v_cvt_pk_bf16_f32 v37, v186, v187
    v_lshlrev_b32 v122, 16, v74
    v_and_b32 v123, 0xffff0000, v74
    v_lshlrev_b32 v124, 16, v110
    v_and_b32 v125, 0xffff0000, v110
    v_mul_f32 v188, v188, v122
    v_mul_f32 v189, v189, v123
    v_cvt_pk_bf16_f32 v7, v188, v189
    v_lshlrev_b32 v188, 16, v7
    v_and_b32 v189, 0xffff0000, v7
    v_add_f32 v188, v188, v124
    v_add_f32 v189, v189, v125
    v_cvt_pk_bf16_f32 v38, v188, v189
    v_lshlrev_b32 v122, 16, v75
    v_and_b32 v123, 0xffff0000, v75
    v_lshlrev_b32 v124, 16, v111
    v_and_b32 v125, 0xffff0000, v111
    v_mul_f32 v190, v190, v122
    v_mul_f32 v191, v191, v123
    v_cvt_pk_bf16_f32 v7, v190, v191
    v_lshlrev_b32 v190, 16, v7
    v_and_b32 v191, 0xffff0000, v7
    v_add_f32 v190, v190, v124
    v_add_f32 v191, v191, v125
    v_cvt_pk_bf16_f32 v39, v190, v191
    s_mov_b32 s28, 28672
    buffer_store_dwordx4 v[36:39], v120, s[20:23], s28 offen
    v_lshlrev_b32 v122, 16, v76
    v_and_b32 v123, 0xffff0000, v76
    v_lshlrev_b32 v124, 16, v112
    v_and_b32 v125, 0xffff0000, v112
    v_mul_f32 v192, v192, v122
    v_mul_f32 v193, v193, v123
    v_cvt_pk_bf16_f32 v7, v192, v193
    v_lshlrev_b32 v192, 16, v7
    v_and_b32 v193, 0xffff0000, v7
    v_add_f32 v192, v192, v124
    v_add_f32 v193, v193, v125
    v_cvt_pk_bf16_f32 v40, v192, v193
    v_lshlrev_b32 v122, 16, v77
    v_and_b32 v123, 0xffff0000, v77
    v_lshlrev_b32 v124, 16, v113
    v_and_b32 v125, 0xffff0000, v113
    v_mul_f32 v194, v194, v122
    v_mul_f32 v195, v195, v123
    v_cvt_pk_bf16_f32 v7, v194, v195
    v_lshlrev_b32 v194, 16, v7
    v_and_b32 v195, 0xffff0000, v7
    v_add_f32 v194, v194, v124
    v_add_f32 v195, v195, v125
    v_cvt_pk_bf16_f32 v41, v194, v195
    v_lshlrev_b32 v122, 16, v78
    v_and_b32 v123, 0xffff0000, v78
    v_lshlrev_b32 v124, 16, v114
    v_and_b32 v125, 0xffff0000, v114
    v_mul_f32 v196, v196, v122
    v_mul_f32 v197, v197, v123
    v_cvt_pk_bf16_f32 v7, v196, v197
    v_lshlrev_b32 v196, 16, v7
    v_and_b32 v197, 0xffff0000, v7
    v_add_f32 v196, v196, v124
    v_add_f32 v197, v197, v125
    v_cvt_pk_bf16_f32 v42, v196, v197
    v_lshlrev_b32 v122, 16, v79
    v_and_b32 v123, 0xffff0000, v79
    v_lshlrev_b32 v124, 16, v115
    v_and_b32 v125, 0xffff0000, v115
    v_mul_f32 v198, v198, v122
    v_mul_f32 v199, v199, v123
    v_cvt_pk_bf16_f32 v7, v198, v199
    v_lshlrev_b32 v198, 16, v7
    v_and_b32 v199, 0xffff0000, v7
    v_add_f32 v198, v198, v124
    v_add_f32 v199, v199, v125
    v_cvt_pk_bf16_f32 v43, v198, v199
    s_mov_b32 s28, 32768
    buffer_store_dwordx4 v[40:43], v120, s[20:23], s28 offen
end_ln2_kernel_1:
    s_endpgm
.globl k3_gateup_kernel
.p2align 8
.type k3_gateup_kernel,@function
k3_gateup_kernel:
    s_load_dwordx2 s[4:5], s[0:1], 40
    s_load_dwordx2 s[6:7], s[0:1], 48
    s_load_dwordx2 s[8:9], s[0:1], 96
    s_load_dwordx2 s[52:53], s[0:1], 56
    s_waitcnt lgkmcnt(0)
    s_mov_b32 s20, s8
    s_and_b32 s21, s9, 0xffff
    s_mov_b32 s22, 268435456
    s_mov_b32 s23, 0x00020000
    s_mov_b32 s56, s52
    s_and_b32 s57, s53, 0xffff
    s_mov_b32 s58, 5308416
    s_mov_b32 s59, 0x00020000
    s_cmp_ge_u32 s2, 256
    s_cbranch_scc1 end_k3_gateup_kernel_1
    s_and_b32 s24, s2, 31
    s_lshr_b32 s25, s2, 5
    v_lshrrev_b32 v1, 6, v0
    v_and_b32 v2, 63, v0
    v_readfirstlane_b32 s26, v1
    v_lshrrev_b32 v5, 5, v2
    s_and_b32 s27, s26, 1
    s_cmp_eq_u32 s27, 0
    s_cselect_b32 s4, s4, s6
    s_cselect_b32 s5, s5, s7
    s_mov_b32 s12, s4
    s_and_b32 s13, s5, 0xffff
    s_mov_b32 s14, 5308416
    s_mov_b32 s15, 0x00020000
    s_lshr_b32 s32, s26, 1
    s_lshl_b32 s33, s32, 6
    s_mul_i32 s28, s24, 288
    s_mul_i32 s29, s27, 10368
    s_lshl_b32 s34, s32, 10
    s_add_u32 s29, s29, s34
    v_add_u32 v3, s33, v2
    v_mul_u32_u24 v6, 6554, v3
    v_lshrrev_b32 v6, 16, v6
    v_mul_u32_u24 v7, 10, v6
    v_sub_u32 v7, v3, v7
    v_mul_u32_u24 v6, 9216, v6
    v_lshlrev_b32 v7, 4, v7
    v_add_u32 v8, v6, v7
    v_add_u32 v3, s33, v2
    v_add_u32 v3, 256, v3
    v_mul_u32_u24 v6, 6554, v3
    v_lshrrev_b32 v6, 16, v6
    v_mul_u32_u24 v7, 10, v6
    v_sub_u32 v7, v3, v7
    v_mul_u32_u24 v6, 9216, v6
    v_lshlrev_b32 v7, 4, v7
    v_add_u32 v9, v6, v7
    v_add_u32 v3, s33, v2
    v_add_u32 v3, 512, v3
    v_mul_u32_u24 v6, 6554, v3
    v_lshrrev_b32 v6, 16, v6
    v_mul_u32_u24 v7, 10, v6
    v_sub_u32 v7, v3, v7
    v_mul_u32_u24 v6, 9216, v6
    v_lshlrev_b32 v7, 4, v7
    v_add_u32 v10, v6, v7
    v_lshlrev_b32 v13, 4, v2
    s_lshl_b32 s36, s25, 3
    s_add_u32 s36, s36, s26
    s_mul_i32 s37, s36, 36864
    s_add_u32 s37, s37, 11272192
    s_add_u32 m0, s29, 0
    s_add_u32 s30, s28, 0
    buffer_load_dwordx4 v8, s[12:15], s30 offen lds
    s_add_u32 m0, s29, 4096
    s_add_u32 s30, s28, 0
    buffer_load_dwordx4 v9, s[12:15], s30 offen lds
    s_cmp_ge_u32 s32, 2
    s_cbranch_scc1 nod_k3_gateup_kernel_2
    s_add_u32 m0, s29, 8192
    s_add_u32 s30, s28, 0
    buffer_load_dwordx4 v10, s[12:15], s30 offen lds
nod_k3_gateup_kernel_2:
    s_add_u32 s35, s37, 0
    buffer_load_dwordx4 v[16:19], v13, s[20:23], s35 offen
    s_add_u32 s35, s37, 1024
    buffer_load_dwordx4 v[20:23], v13, s[20:23], s35 offen
    s_add_u32 m0, s29, 20736
    s_add_u32 s30, s28, 589824
    buffer_load_dwordx4 v8, s[12:15], s30 offen lds
    s_add_u32 m0, s29, 24832
    s_add_u32 s30, s28, 589824
    buffer_load_dwordx4 v9, s[12:15], s30 offen lds
    s_cmp_ge_u32 s32, 2
    s_cbranch_scc1 nod_k3_gateup_kernel_3
    s_add_u32 m0, s29, 28928
    s_add_u32 s30, s28, 589824
    buffer_load_dwordx4 v10, s[12:15], s30 offen lds
nod_k3_gateup_kernel_3:
    s_add_u32 s35, s37, 2048
    buffer_load_dwordx4 v[24:27], v13, s[20:23], s35 offen
    s_add_u32 s35, s37, 3072
    buffer_load_dwordx4 v[28:31], v13, s[20:23], s35 offen
    s_add_u32 s35, s37, 4096
    buffer_load_dwordx4 v[32:35], v13, s[20:23], s35 offen
    s_add_u32 s35, s37, 5120
    buffer_load_dwordx4 v[36:39], v13, s[20:23], s35 offen
    v_and_b32 v7, 15, v2
    v_lshrrev_b32 v6, 2, v7
    v_and_b32 v7, 3, v7
    v_lshlrev_b32 v7, 3, v7
    v_lshlrev_b32 v3, 3, v5
    v_add_u32 v6, v6, v3
    v_mul_u32_u24 v6, 160, v6
    v_add_u32 v6, v6, v7
    v_lshrrev_b32 v7, 4, v2
    v_and_b32 v7, 1, v7
    v_mul_u32_u24 v7, 10368, v7
    v_add_u32 v226, v6, v7
    v_add_u32 v227, 20736, v226
    v_add_u32 v228, 41472, v226
    v_add_u32 v229, 62208, v226
    v_add_u32 v230, 82944, v226
    v_add_u32 v231, 103680, v226
    s_mul_i32 s38, s36, 294912
    s_mul_i32 s39, s24, 9216
    s_add_u32 s38, s38, s39
    s_add_u32 s38, s38, 13631488
    v_mov_b32 v220, 3222493025
    v_mov_b32 v221, 3222493025
    v_mov_b32 v222, 3184710632
    v_mov_b32 v223, 3184710632
    v_mov_b32 v224, 1.0
    v_mov_b32 v225, 1.0
    s_waitcnt vmcnt(8)
    s_barrier
    ds_read_b64_tr_b16 v[48:49], v226 offset:0
    ds_read_b64_tr_b16 v[50:51], v226 offset:640
    ds_read_b64_tr_b16 v[52:53], v226 offset:32
    ds_read_b64_tr_b16 v[54:55], v226 offset:672
    ds_read_b64_tr_b16 v[56:57], v226 offset:64
    ds_read_b64_tr_b16 v[58:59], v226 offset:704
    ds_read_b64_tr_b16 v[60:61], v226 offset:96
    ds_read_b64_tr_b16 v[62:63], v226 offset:736
    s_waitcnt vmcnt(7) lgkmcnt(6)
    v_mfma_f32_32x32x16_bf16 v[64:79], v[48:51], v[16:19], 0
    ds_read_b64_tr_b16 v[48:49], v226 offset:128
    ds_read_b64_tr_b16 v[50:51], v226 offset:768
    s_waitcnt lgkmcnt(6)
    v_mfma_f32_32x32x16_bf16 v[80:95], v[52:55], v[16:19], 0
    s_add_u32 m0, s29, 41472
    s_add_u32 s30, s28, 1179648
    buffer_load_dwordx4 v8, s[12:15], s30 offen lds
    ds_read_b64_tr_b16 v[52:53], v226 offset:2560
    ds_read_b64_tr_b16 v[54:55], v226 offset:3200
    s_waitcnt lgkmcnt(6)
    v_mfma_f32_32x32x16_bf16 v[96:111], v[56:59], v[16:19], 0
    ds_read_b64_tr_b16 v[56:57], v226 offset:2592
    ds_read_b64_tr_b16 v[58:59], v226 offset:3232
    s_waitcnt lgkmcnt(6)
    v_mfma_f32_32x32x16_bf16 v[112:127], v[60:63], v[16:19], 0
    s_add_u32 m0, s29, 45568
    s_add_u32 s30, s28, 1179648
    buffer_load_dwordx4 v9, s[12:15], s30 offen lds
    ds_read_b64_tr_b16 v[60:61], v226 offset:2624
    ds_read_b64_tr_b16 v[62:63], v226 offset:3264
    s_waitcnt lgkmcnt(6)
    v_mfma_f32_32x32x16_bf16 v[128:143], v[48:51], v[16:19], 0
    s_add_u32 s35, s37, 6144
    buffer_load_dwordx4 v[40:43], v13, s[20:23], s35 offen
    ds_read_b64_tr_b16 v[48:49], v226 offset:2656
    ds_read_b64_tr_b16 v[50:51], v226 offset:3296
    s_waitcnt vmcnt(9) lgkmcnt(6)
    v_mfma_f32_32x32x16_bf16 v[64:79], v[52:55], v[20:23], v[64:79]
    s_cmp_ge_u32 s32, 2
    s_cbranch_scc1 nod_k3_gateup_kernel_4
    s_add_u32 m0, s29, 49664
    s_add_u32 s30, s28, 1179648
    buffer_load_dwordx4 v10, s[12:15], s30 offen lds
nod_k3_gateup_kernel_4:
    ds_read_b64_tr_b16 v[52:53], v226 offset:2688
    ds_read_b64_tr_b16 v[54:55], v226 offset:3328
    s_waitcnt lgkmcnt(6)
    v_mfma_f32_32x32x16_bf16 v[80:95], v[56:59], v[20:23], v[80:95]
    ds_read_b64_tr_b16 v[56:57], v226 offset:5120
    ds_read_b64_tr_b16 v[58:59], v226 offset:5760
    s_waitcnt lgkmcnt(6)
    v_mfma_f32_32x32x16_bf16 v[96:111], v[60:63], v[20:23], v[96:111]
    s_add_u32 m0, s29, 62208
    s_add_u32 s30, s28, 1769472
    buffer_load_dwordx4 v8, s[12:15], s30 offen lds
    ds_read_b64_tr_b16 v[60:61], v226 offset:5152
    ds_read_b64_tr_b16 v[62:63], v226 offset:5792
    s_waitcnt lgkmcnt(6)
    v_mfma_f32_32x32x16_bf16 v[112:127], v[48:51], v[20:23], v[112:127]
    ds_read_b64_tr_b16 v[48:49], v226 offset:5184
    ds_read_b64_tr_b16 v[50:51], v226 offset:5824
    s_waitcnt lgkmcnt(6)
    v_mfma_f32_32x32x16_bf16 v[128:143], v[52:55], v[20:23], v[128:143]
    s_add_u32 s35, s37, 7168
    buffer_load_dwordx4 v[44:47], v13, s[20:23], s35 offen
    s_add_u32 m0, s29, 66304
    s_add_u32 s30, s28, 1769472
    buffer_load_dwordx4 v9, s[12:15], s30 offen lds
    ds_read_b64_tr_b16 v[52:53], v226 offset:5216
    ds_read_b64_tr_b16 v[54:55], v226 offset:5856
    s_waitcnt vmcnt(9) lgkmcnt(6)
    v_mfma_f32_32x32x16_bf16 v[64:79], v[56:59], v[24:27], v[64:79]
    ds_read_b64_tr_b16 v[56:57], v226 offset:5248
    ds_read_b64_tr_b16 v[58:59], v226 offset:5888
    s_waitcnt lgkmcnt(6)
    v_mfma_f32_32x32x16_bf16 v[80:95], v[60:63], v[24:27], v[80:95]
    s_cmp_ge_u32 s32, 2
    s_cbranch_scc1 nod_k3_gateup_kernel_5
    s_add_u32 m0, s29, 70400
    s_add_u32 s30, s28, 1769472
    buffer_load_dwordx4 v10, s[12:15], s30 offen lds
nod_k3_gateup_kernel_5:
    ds_read_b64_tr_b16 v[60:61], v226 offset:7680
    ds_read_b64_tr_b16 v[62:63], v226 offset:8320
    s_waitcnt lgkmcnt(6)
    v_mfma_f32_32x32x16_bf16 v[96:111], v[48:51], v[24:27], v[96:111]
    ds_read_b64_tr_b16 v[48:49], v226 offset:7712
    ds_read_b64_tr_b16 v[50:51], v226 offset:8352
    s_waitcnt lgkmcnt(6)
    v_mfma_f32_32x32x16_bf16 v[112:127], v[52:55], v[24:27], v[112:127]
    ds_read_b64_tr_b16 v[52:53], v226 offset:7744
    ds_read_b64_tr_b16 v[54:55], v226 offset:8384
    s_waitcnt lgkmcnt(6)
    v_mfma_f32_32x32x16_bf16 v[128:143], v[56:59], v[24:27], v[128:143]
    s_add_u32 s35, s37, 8192
    buffer_load_dwordx4 v[16:19], v13, s[20:23], s35 offen
    ds_read_b64_tr_b16 v[56:57], v226 offset:7776
    ds_read_b64_tr_b16 v[58:59], v226 offset:8416
    s_waitcnt vmcnt(9) lgkmcnt(6)
    v_mfma_f32_32x32x16_bf16 v[64:79], v[60:63], v[28:31], v[64:79]
    ds_read_b64_tr_b16 v[60:61], v226 offset:7808
    ds_read_b64_tr_b16 v[62:63], v226 offset:8448
    s_waitcnt lgkmcnt(6)
    v_mfma_f32_32x32x16_bf16 v[80:95], v[48:51], v[28:31], v[80:95]
    s_waitcnt lgkmcnt(4)
    v_mfma_f32_32x32x16_bf16 v[96:111], v[52:55], v[28:31], v[96:111]
    s_waitcnt lgkmcnt(2)
    v_mfma_f32_32x32x16_bf16 v[112:127], v[56:59], v[28:31], v[112:127]
    s_waitcnt lgkmcnt(0)
    v_mfma_f32_32x32x16_bf16 v[128:143], v[60:63], v[28:31], v[128:143]
    s_add_u32 s35, s37, 9216
    buffer_load_dwordx4 v[20:23], v13, s[20:23], s35 offen
    s_waitcnt vmcnt(10)
    s_barrier
    ds_read_b64_tr_b16 v[48:49], v227 offset:0
    ds_read_b64_tr_b16 v[50:51], v227 offset:640
    ds_read_b64_tr_b16 v[52:53], v227 offset:32
    ds_read_b64_tr_b16 v[54:55], v227 offset:672
    ds_read_b64_tr_b16 v[56:57], v227 offset:64
    ds_read_b64_tr_b16 v[58:59], v227 offset:704
    ds_read_b64_tr_b16 v[60:61], v227 offset:96
    ds_read_b64_tr_b16 v[62:63], v227 offset:736
    s_waitcnt vmcnt(9) lgkmcnt(6)
    v_mfma_f32_32x32x16_bf16 v[64:79], v[48:51], v[32:35], v[64:79]
    ds_read_b64_tr_b16 v[48:49], v227 offset:128
    ds_read_b64_tr_b16 v[50:51], v227 offset:768
    s_waitcnt lgkmcnt(6)
    v_mfma_f32_32x32x16_bf16 v[80:95], v[52:55], v[32:35], v[80:95]
    s_add_u32 m0, s29, 82944
    s_add_u32 s30, s28, 2359296
    buffer_load_dwordx4 v8, s[12:15], s30 offen lds
    ds_read_b64_tr_b16 v[52:53], v227 offset:2560
    ds_read_b64_tr_b16 v[54:55], v227 offset:3200
    s_waitcnt lgkmcnt(6)
    v_mfma_f32_32x32x16_bf16 v[96:111], v[56:59], v[32:35], v[96:111]
    ds_read_b64_tr_b16 v[56:57], v227 offset:2592
    ds_read_b64_tr_b16 v[58:59], v227 offset:3232
    s_waitcnt lgkmcnt(6)
    v_mfma_f32_32x32x16_bf16 v[112:127], v[60:63], v[32:35], v[112:127]
    s_add_u32 m0, s29, 87040
    s_add_u32 s30, s28, 2359296
    buffer_load_dwordx4 v9, s[12:15], s30 offen lds
    ds_read_b64_tr_b16 v[60:61], v227 offset:2624
    ds_read_b64_tr_b16 v[62:63], v227 offset:3264
    s_waitcnt lgkmcnt(6)
    v_mfma_f32_32x32x16_bf16 v[128:143], v[48:51], v[32:35], v[128:143]
    s_add_u32 s35, s37, 10240
    buffer_load_dwordx4 v[24:27], v13, s[20:23], s35 offen
    ds_read_b64_tr_b16 v[48:49], v227 offset:2656
    ds_read_b64_tr_b16 v[50:51], v227 offset:3296
    s_waitcnt vmcnt(11) lgkmcnt(6)
    v_mfma_f32_32x32x16_bf16 v[64:79], v[52:55], v[36:39], v[64:79]
    s_cmp_ge_u32 s32, 2
    s_cbranch_scc1 nod_k3_gateup_kernel_6
    s_add_u32 m0, s29, 91136
    s_add_u32 s30, s28, 2359296
    buffer_load_dwordx4 v10, s[12:15], s30 offen lds
nod_k3_gateup_kernel_6:
    ds_read_b64_tr_b16 v[52:53], v227 offset:2688
    ds_read_b64_tr_b16 v[54:55], v227 offset:3328
    s_waitcnt lgkmcnt(6)
    v_mfma_f32_32x32x16_bf16 v[80:95], v[56:59], v[36:39], v[80:95]
    ds_read_b64_tr_b16 v[56:57], v227 offset:5120
    ds_read_b64_tr_b16 v[58:59], v227 offset:5760
    s_waitcnt lgkmcnt(6)
    v_mfma_f32_32x32x16_bf16 v[96:111], v[60:63], v[36:39], v[96:111]
    s_add_u32 m0, s29, 103680
    s_add_u32 s30, s28, 2949120
    buffer_load_dwordx4 v8, s[12:15], s30 offen lds
    ds_read_b64_tr_b16 v[60:61], v227 offset:5152
    ds_read_b64_tr_b16 v[62:63], v227 offset:5792
    s_waitcnt lgkmcnt(6)
    v_mfma_f32_32x32x16_bf16 v[112:127], v[48:51], v[36:39], v[112:127]
    ds_read_b64_tr_b16 v[48:49], v227 offset:5184
    ds_read_b64_tr_b16 v[50:51], v227 offset:5824
    s_waitcnt lgkmcnt(6)
    v_mfma_f32_32x32x16_bf16 v[128:143], v[52:55], v[36:39], v[128:143]
    s_add_u32 s35, s37, 11264
    buffer_load_dwordx4 v[28:31], v13, s[20:23], s35 offen
    s_add_u32 m0, s29, 107776
    s_add_u32 s30, s28, 2949120
    buffer_load_dwordx4 v9, s[12:15], s30 offen lds
    ds_read_b64_tr_b16 v[52:53], v227 offset:5216
    ds_read_b64_tr_b16 v[54:55], v227 offset:5856
    s_waitcnt vmcnt(11) lgkmcnt(6)
    v_mfma_f32_32x32x16_bf16 v[64:79], v[56:59], v[40:43], v[64:79]
    ds_read_b64_tr_b16 v[56:57], v227 offset:5248
    ds_read_b64_tr_b16 v[58:59], v227 offset:5888
    s_waitcnt lgkmcnt(6)
    v_mfma_f32_32x32x16_bf16 v[80:95], v[60:63], v[40:43], v[80:95]
    s_cmp_ge_u32 s32, 2
    s_cbranch_scc1 nod_k3_gateup_kernel_7
    s_add_u32 m0, s29, 111872
    s_add_u32 s30, s28, 2949120
    buffer_load_dwordx4 v10, s[12:15], s30 offen lds
nod_k3_gateup_kernel_7:
    ds_read_b64_tr_b16 v[60:61], v227 offset:7680
    ds_read_b64_tr_b16 v[62:63], v227 offset:8320
    s_waitcnt lgkmcnt(6)
    v_mfma_f32_32x32x16_bf16 v[96:111], v[48:51], v[40:43], v[96:111]
    ds_read_b64_tr_b16 v[48:49], v227 offset:7712
    ds_read_b64_tr_b16 v[50:51], v227 offset:8352
    s_waitcnt lgkmcnt(6)
    v_mfma_f32_32x32x16_bf16 v[112:127], v[52:55], v[40:43], v[112:127]
    ds_read_b64_tr_b16 v[52:53], v227 offset:7744
    ds_read_b64_tr_b16 v[54:55], v227 offset:8384
    s_waitcnt lgkmcnt(6)
    v_mfma_f32_32x32x16_bf16 v[128:143], v[56:59], v[40:43], v[128:143]
    s_add_u32 s35, s37, 12288
    buffer_load_dwordx4 v[32:35], v13, s[20:23], s35 offen
    ds_read_b64_tr_b16 v[56:57], v227 offset:7776
    ds_read_b64_tr_b16 v[58:59], v227 offset:8416
    s_waitcnt vmcnt(10) lgkmcnt(6)
    v_mfma_f32_32x32x16_bf16 v[64:79], v[60:63], v[44:47], v[64:79]
    ds_read_b64_tr_b16 v[60:61], v227 offset:7808
    ds_read_b64_tr_b16 v[62:63], v227 offset:8448
    s_waitcnt lgkmcnt(6)
    v_mfma_f32_32x32x16_bf16 v[80:95], v[48:51], v[44:47], v[80:95]
    s_waitcnt lgkmcnt(4)
    v_mfma_f32_32x32x16_bf16 v[96:111], v[52:55], v[44:47], v[96:111]
    s_waitcnt lgkmcnt(2)
    v_mfma_f32_32x32x16_bf16 v[112:127], v[56:59], v[44:47], v[112:127]
    s_waitcnt lgkmcnt(0)
    v_mfma_f32_32x32x16_bf16 v[128:143], v[60:63], v[44:47], v[128:143]
    s_add_u32 s35, s37, 13312
    buffer_load_dwordx4 v[36:39], v13, s[20:23], s35 offen
    s_waitcnt vmcnt(11)
    s_barrier
    ds_read_b64_tr_b16 v[48:49], v228 offset:0
    ds_read_b64_tr_b16 v[50:51], v228 offset:640
    ds_read_b64_tr_b16 v[52:53], v228 offset:32
    ds_read_b64_tr_b16 v[54:55], v228 offset:672
    ds_read_b64_tr_b16 v[56:57], v228 offset:64
    ds_read_b64_tr_b16 v[58:59], v228 offset:704
    ds_read_b64_tr_b16 v[60:61], v228 offset:96
    ds_read_b64_tr_b16 v[62:63], v228 offset:736
    s_waitcnt vmcnt(9) lgkmcnt(6)
    v_mfma_f32_32x32x16_bf16 v[64:79], v[48:51], v[16:19], v[64:79]
    ds_read_b64_tr_b16 v[48:49], v228 offset:128
    ds_read_b64_tr_b16 v[50:51], v228 offset:768
    s_waitcnt lgkmcnt(6)
    v_mfma_f32_32x32x16_bf16 v[80:95], v[52:55], v[16:19], v[80:95]
    s_add_u32 m0, s29, 0
    s_add_u32 s30, s28, 3538944
    buffer_load_dwordx4 v8, s[12:15], s30 offen lds
    ds_read_b64_tr_b16 v[52:53], v228 offset:2560
    ds_read_b64_tr_b16 v[54:55], v228 offset:3200
    s_waitcnt lgkmcnt(6)
    v_mfma_f32_32x32x16_bf16 v[96:111], v[56:59], v[16:19], v[96:111]
    ds_read_b64_tr_b16 v[56:57], v228 offset:2592
    ds_read_b64_tr_b16 v[58:59], v228 offset:3232
    s_waitcnt lgkmcnt(6)
    v_mfma_f32_32x32x16_bf16 v[112:127], v[60:63], v[16:19], v[112:127]
    s_add_u32 m0, s29, 4096
    s_add_u32 s30, s28, 3538944
    buffer_load_dwordx4 v9, s[12:15], s30 offen lds
    ds_read_b64_tr_b16 v[60:61], v228 offset:2624
    ds_read_b64_tr_b16 v[62:63], v228 offset:3264
    s_waitcnt lgkmcnt(6)
    v_mfma_f32_32x32x16_bf16 v[128:143], v[48:51], v[16:19], v[128:143]
    s_add_u32 s35, s37, 14336
    buffer_load_dwordx4 v[40:43], v13, s[20:23], s35 offen
    ds_read_b64_tr_b16 v[48:49], v228 offset:2656
    ds_read_b64_tr_b16 v[50:51], v228 offset:3296
    s_waitcnt vmcnt(11) lgkmcnt(6)
    v_mfma_f32_32x32x16_bf16 v[64:79], v[52:55], v[20:23], v[64:79]
    s_cmp_ge_u32 s32, 2
    s_cbranch_scc1 nod_k3_gateup_kernel_8
    s_add_u32 m0, s29, 8192
    s_add_u32 s30, s28, 3538944
    buffer_load_dwordx4 v10, s[12:15], s30 offen lds
nod_k3_gateup_kernel_8:
    ds_read_b64_tr_b16 v[52:53], v228 offset:2688
    ds_read_b64_tr_b16 v[54:55], v228 offset:3328
    s_waitcnt lgkmcnt(6)
    v_mfma_f32_32x32x16_bf16 v[80:95], v[56:59], v[20:23], v[80:95]
    ds_read_b64_tr_b16 v[56:57], v228 offset:5120
    ds_read_b64_tr_b16 v[58:59], v228 offset:5760
    s_waitcnt lgkmcnt(6)
    v_mfma_f32_32x32x16_bf16 v[96:111], v[60:63], v[20:23], v[96:111]
    ds_read_b64_tr_b16 v[60:61], v228 offset:5152
    ds_read_b64_tr_b16 v[62:63], v228 offset:5792
    s_waitcnt lgkmcnt(6)
    v_mfma_f32_32x32x16_bf16 v[112:127], v[48:51], v[20:23], v[112:127]
    ds_read_b64_tr_b16 v[48:49], v228 offset:5184
    ds_read_b64_tr_b16 v[50:51], v228 offset:5824
    s_waitcnt lgkmcnt(6)
    v_mfma_f32_32x32x16_bf16 v[128:143], v[52:55], v[20:23], v[128:143]
    s_add_u32 s35, s37, 15360
    buffer_load_dwordx4 v[44:47], v13, s[20:23], s35 offen
    ds_read_b64_tr_b16 v[52:53], v228 offset:5216
    ds_read_b64_tr_b16 v[54:55], v228 offset:5856
    s_waitcnt vmcnt(9) lgkmcnt(6)
    v_mfma_f32_32x32x16_bf16 v[64:79], v[56:59], v[24:27], v[64:79]
    ds_read_b64_tr_b16 v[56:57], v228 offset:5248
    ds_read_b64_tr_b16 v[58:59], v228 offset:5888
    s_waitcnt lgkmcnt(6)
    v_mfma_f32_32x32x16_bf16 v[80:95], v[60:63], v[24:27], v[80:95]
    ds_read_b64_tr_b16 v[60:61], v228 offset:7680
    ds_read_b64_tr_b16 v[62:63], v228 offset:8320
    s_waitcnt lgkmcnt(6)
    v_mfma_f32_32x32x16_bf16 v[96:111], v[48:51], v[24:27], v[96:111]
    ds_read_b64_tr_b16 v[48:49], v228 offset:7712
    ds_read_b64_tr_b16 v[50:51], v228 offset:8352
    s_waitcnt lgkmcnt(6)
    v_mfma_f32_32x32x16_bf16 v[112:127], v[52:55], v[24:27], v[112:127]
    ds_read_b64_tr_b16 v[52:53], v228 offset:7744
    ds_read_b64_tr_b16 v[54:55], v228 offset:8384
    s_waitcnt lgkmcnt(6)
    v_mfma_f32_32x32x16_bf16 v[128:143], v[56:59], v[24:27], v[128:143]
    s_add_u32 s35, s37, 16384
    buffer_load_dwordx4 v[16:19], v13, s[20:23], s35 offen
    ds_read_b64_tr_b16 v[56:57], v228 offset:7776
    ds_read_b64_tr_b16 v[58:59], v228 offset:8416
    s_waitcnt vmcnt(8) lgkmcnt(6)
    v_mfma_f32_32x32x16_bf16 v[64:79], v[60:63], v[28:31], v[64:79]
    ds_read_b64_tr_b16 v[60:61], v228 offset:7808
    ds_read_b64_tr_b16 v[62:63], v228 offset:8448
    s_waitcnt lgkmcnt(6)
    v_mfma_f32_32x32x16_bf16 v[80:95], v[48:51], v[28:31], v[80:95]
    s_waitcnt lgkmcnt(4)
    v_mfma_f32_32x32x16_bf16 v[96:111], v[52:55], v[28:31], v[96:111]
    s_waitcnt lgkmcnt(2)
    v_mfma_f32_32x32x16_bf16 v[112:127], v[56:59], v[28:31], v[112:127]
    s_waitcnt lgkmcnt(0)
    v_mfma_f32_32x32x16_bf16 v[128:143], v[60:63], v[28:31], v[128:143]
    s_add_u32 s35, s37, 17408
    buffer_load_dwordx4 v[20:23], v13, s[20:23], s35 offen
    s_waitcnt vmcnt(9)
    s_barrier
    ds_read_b64_tr_b16 v[48:49], v229 offset:0
    ds_read_b64_tr_b16 v[50:51], v229 offset:640
    ds_read_b64_tr_b16 v[52:53], v229 offset:32
    ds_read_b64_tr_b16 v[54:55], v229 offset:672
    ds_read_b64_tr_b16 v[56:57], v229 offset:64
    ds_read_b64_tr_b16 v[58:59], v229 offset:704
    ds_read_b64_tr_b16 v[60:61], v229 offset:96
    ds_read_b64_tr_b16 v[62:63], v229 offset:736
    s_waitcnt vmcnt(7) lgkmcnt(6)
    v_mfma_f32_32x32x16_bf16 v[64:79], v[48:51], v[32:35], v[64:79]
    ds_read_b64_tr_b16 v[48:49], v229 offset:128
    ds_read_b64_tr_b16 v[50:51], v229 offset:768
    s_waitcnt lgkmcnt(6)
    v_mfma_f32_32x32x16_bf16 v[80:95], v[52:55], v[32:35], v[80:95]
    s_add_u32 m0, s29, 20736
    s_add_u32 s30, s28, 4128768
    buffer_load_dwordx4 v8, s[12:15], s30 offen lds
    ds_read_b64_tr_b16 v[52:53], v229 offset:2560
    ds_read_b64_tr_b16 v[54:55], v229 offset:3200
    s_waitcnt lgkmcnt(6)
    v_mfma_f32_32x32x16_bf16 v[96:111], v[56:59], v[32:35], v[96:111]
    ds_read_b64_tr_b16 v[56:57], v229 offset:2592
    ds_read_b64_tr_b16 v[58:59], v229 offset:3232
    s_waitcnt lgkmcnt(6)
    v_mfma_f32_32x32x16_bf16 v[112:127], v[60:63], v[32:35], v[112:127]
    s_add_u32 m0, s29, 24832
    s_add_u32 s30, s28, 4128768
    buffer_load_dwordx4 v9, s[12:15], s30 offen lds
    ds_read_b64_tr_b16 v[60:61], v229 offset:2624
    ds_read_b64_tr_b16 v[62:63], v229 offset:3264
    s_waitcnt lgkmcnt(6)
    v_mfma_f32_32x32x16_bf16 v[128:143], v[48:51], v[32:35], v[128:143]
    s_add_u32 s35, s37, 18432
    buffer_load_dwordx4 v[24:27], v13, s[20:23], s35 offen
    ds_read_b64_tr_b16 v[48:49], v229 offset:2656
    ds_read_b64_tr_b16 v[50:51], v229 offset:3296
    s_waitcnt vmcnt(9) lgkmcnt(6)
    v_mfma_f32_32x32x16_bf16 v[64:79], v[52:55], v[36:39], v[64:79]
    s_cmp_ge_u32 s32, 2
    s_cbranch_scc1 nod_k3_gateup_kernel_9
    s_add_u32 m0, s29, 28928
    s_add_u32 s30, s28, 4128768
    buffer_load_dwordx4 v10, s[12:15], s30 offen lds
nod_k3_gateup_kernel_9:
    ds_read_b64_tr_b16 v[52:53], v229 offset:2688
    ds_read_b64_tr_b16 v[54:55], v229 offset:3328
    s_waitcnt lgkmcnt(6)
    v_mfma_f32_32x32x16_bf16 v[80:95], v[56:59], v[36:39], v[80:95]
    ds_read_b64_tr_b16 v[56:57], v229 offset:5120
    ds_read_b64_tr_b16 v[58:59], v229 offset:5760
    s_waitcnt lgkmcnt(6)
    v_mfma_f32_32x32x16_bf16 v[96:111], v[60:63], v[36:39], v[96:111]
    ds_read_b64_tr_b16 v[60:61], v229 offset:5152
    ds_read_b64_tr_b16 v[62:63], v229 offset:5792
    s_waitcnt lgkmcnt(6)
    v_mfma_f32_32x32x16_bf16 v[112:127], v[48:51], v[36:39], v[112:127]
    ds_read_b64_tr_b16 v[48:49], v229 offset:5184
    ds_read_b64_tr_b16 v[50:51], v229 offset:5824
    s_waitcnt lgkmcnt(6)
    v_mfma_f32_32x32x16_bf16 v[128:143], v[52:55], v[36:39], v[128:143]
    s_add_u32 s35, s37, 19456
    buffer_load_dwordx4 v[28:31], v13, s[20:23], s35 offen
    ds_read_b64_tr_b16 v[52:53], v229 offset:5216
    ds_read_b64_tr_b16 v[54:55], v229 offset:5856
    s_waitcnt vmcnt(7) lgkmcnt(6)
    v_mfma_f32_32x32x16_bf16 v[64:79], v[56:59], v[40:43], v[64:79]
    ds_read_b64_tr_b16 v[56:57], v229 offset:5248
    ds_read_b64_tr_b16 v[58:59], v229 offset:5888
    s_waitcnt lgkmcnt(6)
    v_mfma_f32_32x32x16_bf16 v[80:95], v[60:63], v[40:43], v[80:95]
    ds_read_b64_tr_b16 v[60:61], v229 offset:7680
    ds_read_b64_tr_b16 v[62:63], v229 offset:8320
    s_waitcnt lgkmcnt(6)
    v_mfma_f32_32x32x16_bf16 v[96:111], v[48:51], v[40:43], v[96:111]
    ds_read_b64_tr_b16 v[48:49], v229 offset:7712
    ds_read_b64_tr_b16 v[50:51], v229 offset:8352
    s_waitcnt lgkmcnt(6)
    v_mfma_f32_32x32x16_bf16 v[112:127], v[52:55], v[40:43], v[112:127]
    ds_read_b64_tr_b16 v[52:53], v229 offset:7744
    ds_read_b64_tr_b16 v[54:55], v229 offset:8384
    s_waitcnt lgkmcnt(6)
    v_mfma_f32_32x32x16_bf16 v[128:143], v[56:59], v[40:43], v[128:143]
    s_add_u32 s35, s37, 20480
    buffer_load_dwordx4 v[32:35], v13, s[20:23], s35 offen
    ds_read_b64_tr_b16 v[56:57], v229 offset:7776
    ds_read_b64_tr_b16 v[58:59], v229 offset:8416
    s_waitcnt vmcnt(7) lgkmcnt(6)
    v_mfma_f32_32x32x16_bf16 v[64:79], v[60:63], v[44:47], v[64:79]
    ds_read_b64_tr_b16 v[60:61], v229 offset:7808
    ds_read_b64_tr_b16 v[62:63], v229 offset:8448
    s_waitcnt lgkmcnt(6)
    v_mfma_f32_32x32x16_bf16 v[80:95], v[48:51], v[44:47], v[80:95]
    s_waitcnt lgkmcnt(4)
    v_mfma_f32_32x32x16_bf16 v[96:111], v[52:55], v[44:47], v[96:111]
    s_waitcnt lgkmcnt(2)
    v_mfma_f32_32x32x16_bf16 v[112:127], v[56:59], v[44:47], v[112:127]
    s_waitcnt lgkmcnt(0)
    v_mfma_f32_32x32x16_bf16 v[128:143], v[60:63], v[44:47], v[128:143]
    s_add_u32 s35, s37, 21504
    buffer_load_dwordx4 v[36:39], v13, s[20:23], s35 offen
    s_waitcnt vmcnt(8)
    s_barrier
    ds_read_b64_tr_b16 v[48:49], v230 offset:0
    ds_read_b64_tr_b16 v[50:51], v230 offset:640
    ds_read_b64_tr_b16 v[52:53], v230 offset:32
    ds_read_b64_tr_b16 v[54:55], v230 offset:672
    ds_read_b64_tr_b16 v[56:57], v230 offset:64
    ds_read_b64_tr_b16 v[58:59], v230 offset:704
    ds_read_b64_tr_b16 v[60:61], v230 offset:96
    ds_read_b64_tr_b16 v[62:63], v230 offset:736
    s_waitcnt vmcnt(7) lgkmcnt(6)
    v_mfma_f32_32x32x16_bf16 v[64:79], v[48:51], v[16:19], v[64:79]
    ds_read_b64_tr_b16 v[48:49], v230 offset:128
    ds_read_b64_tr_b16 v[50:51], v230 offset:768
    s_waitcnt lgkmcnt(6)
    v_mfma_f32_32x32x16_bf16 v[80:95], v[52:55], v[16:19], v[80:95]
    s_add_u32 m0, s29, 41472
    s_add_u32 s30, s28, 4718592
    buffer_load_dwordx4 v8, s[12:15], s30 offen lds
    ds_read_b64_tr_b16 v[52:53], v230 offset:2560
    ds_read_b64_tr_b16 v[54:55], v230 offset:3200
    s_waitcnt lgkmcnt(6)
    v_mfma_f32_32x32x16_bf16 v[96:111], v[56:59], v[16:19], v[96:111]
    ds_read_b64_tr_b16 v[56:57], v230 offset:2592
    ds_read_b64_tr_b16 v[58:59], v230 offset:3232
    s_waitcnt lgkmcnt(6)
    v_mfma_f32_32x32x16_bf16 v[112:127], v[60:63], v[16:19], v[112:127]
    s_add_u32 m0, s29, 45568
    s_add_u32 s30, s28, 4718592
    buffer_load_dwordx4 v9, s[12:15], s30 offen lds
    ds_read_b64_tr_b16 v[60:61], v230 offset:2624
    ds_read_b64_tr_b16 v[62:63], v230 offset:3264
    s_waitcnt lgkmcnt(6)
    v_mfma_f32_32x32x16_bf16 v[128:143], v[48:51], v[16:19], v[128:143]
    s_add_u32 s35, s37, 22528
    buffer_load_dwordx4 v[40:43], v13, s[20:23], s35 offen
    ds_read_b64_tr_b16 v[48:49], v230 offset:2656
    ds_read_b64_tr_b16 v[50:51], v230 offset:3296
    s_waitcnt vmcnt(9) lgkmcnt(6)
    v_mfma_f32_32x32x16_bf16 v[64:79], v[52:55], v[20:23], v[64:79]
    s_cmp_ge_u32 s32, 2
    s_cbranch_scc1 nod_k3_gateup_kernel_10
    s_add_u32 m0, s29, 49664
    s_add_u32 s30, s28, 4718592
    buffer_load_dwordx4 v10, s[12:15], s30 offen lds
nod_k3_gateup_kernel_10:
    ds_read_b64_tr_b16 v[52:53], v230 offset:2688
    ds_read_b64_tr_b16 v[54:55], v230 offset:3328
    s_waitcnt lgkmcnt(6)
    v_mfma_f32_32x32x16_bf16 v[80:95], v[56:59], v[20:23], v[80:95]
    ds_read_b64_tr_b16 v[56:57], v230 offset:5120
    ds_read_b64_tr_b16 v[58:59], v230 offset:5760
    s_waitcnt lgkmcnt(6)
    v_mfma_f32_32x32x16_bf16 v[96:111], v[60:63], v[20:23], v[96:111]
    ds_read_b64_tr_b16 v[60:61], v230 offset:5152
    ds_read_b64_tr_b16 v[62:63], v230 offset:5792
    s_waitcnt lgkmcnt(6)
    v_mfma_f32_32x32x16_bf16 v[112:127], v[48:51], v[20:23], v[112:127]
    ds_read_b64_tr_b16 v[48:49], v230 offset:5184
    ds_read_b64_tr_b16 v[50:51], v230 offset:5824
    s_waitcnt lgkmcnt(6)
    v_mfma_f32_32x32x16_bf16 v[128:143], v[52:55], v[20:23], v[128:143]
    s_add_u32 s35, s37, 23552
    buffer_load_dwordx4 v[44:47], v13, s[20:23], s35 offen
    ds_read_b64_tr_b16 v[52:53], v230 offset:5216
    ds_read_b64_tr_b16 v[54:55], v230 offset:5856
    s_waitcnt vmcnt(7) lgkmcnt(6)
    v_mfma_f32_32x32x16_bf16 v[64:79], v[56:59], v[24:27], v[64:79]
    ds_read_b64_tr_b16 v[56:57], v230 offset:5248
    ds_read_b64_tr_b16 v[58:59], v230 offset:5888
    s_waitcnt lgkmcnt(6)
    v_mfma_f32_32x32x16_bf16 v[80:95], v[60:63], v[24:27], v[80:95]
    ds_read_b64_tr_b16 v[60:61], v230 offset:7680
    ds_read_b64_tr_b16 v[62:63], v230 offset:8320
    s_waitcnt lgkmcnt(6)
    v_mfma_f32_32x32x16_bf16 v[96:111], v[48:51], v[24:27], v[96:111]
    ds_read_b64_tr_b16 v[48:49], v230 offset:7712
    ds_read_b64_tr_b16 v[50:51], v230 offset:8352
    s_waitcnt lgkmcnt(6)
    v_mfma_f32_32x32x16_bf16 v[112:127], v[52:55], v[24:27], v[112:127]
    ds_read_b64_tr_b16 v[52:53], v230 offset:7744
    ds_read_b64_tr_b16 v[54:55], v230 offset:8384
    s_waitcnt lgkmcnt(6)
    v_mfma_f32_32x32x16_bf16 v[128:143], v[56:59], v[24:27], v[128:143]
    s_add_u32 s35, s37, 24576
    buffer_load_dwordx4 v[16:19], v13, s[20:23], s35 offen
    ds_read_b64_tr_b16 v[56:57], v230 offset:7776
    ds_read_b64_tr_b16 v[58:59], v230 offset:8416
    s_waitcnt vmcnt(7) lgkmcnt(6)
    v_mfma_f32_32x32x16_bf16 v[64:79], v[60:63], v[28:31], v[64:79]
    ds_read_b64_tr_b16 v[60:61], v230 offset:7808
    ds_read_b64_tr_b16 v[62:63], v230 offset:8448
    s_waitcnt lgkmcnt(6)
    v_mfma_f32_32x32x16_bf16 v[80:95], v[48:51], v[28:31], v[80:95]
    s_waitcnt lgkmcnt(4)
    v_mfma_f32_32x32x16_bf16 v[96:111], v[52:55], v[28:31], v[96:111]
    s_waitcnt lgkmcnt(2)
    v_mfma_f32_32x32x16_bf16 v[112:127], v[56:59], v[28:31], v[112:127]
    s_waitcnt lgkmcnt(0)
    v_mfma_f32_32x32x16_bf16 v[128:143], v[60:63], v[28:31], v[128:143]
    s_add_u32 s35, s37, 25600
    buffer_load_dwordx4 v[20:23], v13, s[20:23], s35 offen
    s_waitcnt vmcnt(8)
    s_barrier
    ds_read_b64_tr_b16 v[48:49], v231 offset:0
    ds_read_b64_tr_b16 v[50:51], v231 offset:640
    ds_read_b64_tr_b16 v[52:53], v231 offset:32
    ds_read_b64_tr_b16 v[54:55], v231 offset:672
    ds_read_b64_tr_b16 v[56:57], v231 offset:64
    ds_read_b64_tr_b16 v[58:59], v231 offset:704
    ds_read_b64_tr_b16 v[60:61], v231 offset:96
    ds_read_b64_tr_b16 v[62:63], v231 offset:736
    s_waitcnt vmcnt(7) lgkmcnt(6)
    v_mfma_f32_32x32x16_bf16 v[64:79], v[48:51], v[32:35], v[64:79]
    ds_read_b64_tr_b16 v[48:49], v231 offset:128
    ds_read_b64_tr_b16 v[50:51], v231 offset:768
    s_waitcnt lgkmcnt(6)
    v_mfma_f32_32x32x16_bf16 v[80:95], v[52:55], v[32:35], v[80:95]
    s_add_u32 m0, s29, 62208
    s_add_u32 s30, s28, 128
    buffer_load_dwordx4 v8, s[12:15], s30 offen lds
    ds_read_b64_tr_b16 v[52:53], v231 offset:2560
    ds_read_b64_tr_b16 v[54:55], v231 offset:3200
    s_waitcnt lgkmcnt(6)
    v_mfma_f32_32x32x16_bf16 v[96:111], v[56:59], v[32:35], v[96:111]
    ds_read_b64_tr_b16 v[56:57], v231 offset:2592
    ds_read_b64_tr_b16 v[58:59], v231 offset:3232
    s_waitcnt lgkmcnt(6)
    v_mfma_f32_32x32x16_bf16 v[112:127], v[60:63], v[32:35], v[112:127]
    s_add_u32 m0, s29, 66304
    s_add_u32 s30, s28, 128
    buffer_load_dwordx4 v9, s[12:15], s30 offen lds
    ds_read_b64_tr_b16 v[60:61], v231 offset:2624
    ds_read_b64_tr_b16 v[62:63], v231 offset:3264
    s_waitcnt lgkmcnt(6)
    v_mfma_f32_32x32x16_bf16 v[128:143], v[48:51], v[32:35], v[128:143]
    s_add_u32 s35, s37, 26624
    buffer_load_dwordx4 v[24:27], v13, s[20:23], s35 offen
    ds_read_b64_tr_b16 v[48:49], v231 offset:2656
    ds_read_b64_tr_b16 v[50:51], v231 offset:3296
    s_waitcnt vmcnt(9) lgkmcnt(6)
    v_mfma_f32_32x32x16_bf16 v[64:79], v[52:55], v[36:39], v[64:79]
    s_cmp_ge_u32 s32, 2
    s_cbranch_scc1 nod_k3_gateup_kernel_11
    s_add_u32 m0, s29, 70400
    s_add_u32 s30, s28, 128
    buffer_load_dwordx4 v10, s[12:15], s30 offen lds
nod_k3_gateup_kernel_11:
    ds_read_b64_tr_b16 v[52:53], v231 offset:2688
    ds_read_b64_tr_b16 v[54:55], v231 offset:3328
    s_waitcnt lgkmcnt(6)
    v_mfma_f32_32x32x16_bf16 v[80:95], v[56:59], v[36:39], v[80:95]
    ds_read_b64_tr_b16 v[56:57], v231 offset:5120
    ds_read_b64_tr_b16 v[58:59], v231 offset:5760
    s_waitcnt lgkmcnt(6)
    v_mfma_f32_32x32x16_bf16 v[96:111], v[60:63], v[36:39], v[96:111]
    ds_read_b64_tr_b16 v[60:61], v231 offset:5152
    ds_read_b64_tr_b16 v[62:63], v231 offset:5792
    s_waitcnt lgkmcnt(6)
    v_mfma_f32_32x32x16_bf16 v[112:127], v[48:51], v[36:39], v[112:127]
    ds_read_b64_tr_b16 v[48:49], v231 offset:5184
    ds_read_b64_tr_b16 v[50:51], v231 offset:5824
    s_waitcnt lgkmcnt(6)
    v_mfma_f32_32x32x16_bf16 v[128:143], v[52:55], v[36:39], v[128:143]
    s_add_u32 s35, s37, 27648
    buffer_load_dwordx4 v[28:31], v13, s[20:23], s35 offen
    ds_read_b64_tr_b16 v[52:53], v231 offset:5216
    ds_read_b64_tr_b16 v[54:55], v231 offset:5856
    s_waitcnt vmcnt(7) lgkmcnt(6)
    v_mfma_f32_32x32x16_bf16 v[64:79], v[56:59], v[40:43], v[64:79]
    ds_read_b64_tr_b16 v[56:57], v231 offset:5248
    ds_read_b64_tr_b16 v[58:59], v231 offset:5888
    s_waitcnt lgkmcnt(6)
    v_mfma_f32_32x32x16_bf16 v[80:95], v[60:63], v[40:43], v[80:95]
    ds_read_b64_tr_b16 v[60:61], v231 offset:7680
    ds_read_b64_tr_b16 v[62:63], v231 offset:8320
    s_waitcnt lgkmcnt(6)
    v_mfma_f32_32x32x16_bf16 v[96:111], v[48:51], v[40:43], v[96:111]
    ds_read_b64_tr_b16 v[48:49], v231 offset:7712
    ds_read_b64_tr_b16 v[50:51], v231 offset:8352
    s_waitcnt lgkmcnt(6)
    v_mfma_f32_32x32x16_bf16 v[112:127], v[52:55], v[40:43], v[112:127]
    ds_read_b64_tr_b16 v[52:53], v231 offset:7744
    ds_read_b64_tr_b16 v[54:55], v231 offset:8384
    s_waitcnt lgkmcnt(6)
    v_mfma_f32_32x32x16_bf16 v[128:143], v[56:59], v[40:43], v[128:143]
    s_add_u32 s35, s37, 28672
    buffer_load_dwordx4 v[32:35], v13, s[20:23], s35 offen
    ds_read_b64_tr_b16 v[56:57], v231 offset:7776
    ds_read_b64_tr_b16 v[58:59], v231 offset:8416
    s_waitcnt vmcnt(7) lgkmcnt(6)
    v_mfma_f32_32x32x16_bf16 v[64:79], v[60:63], v[44:47], v[64:79]
    ds_read_b64_tr_b16 v[60:61], v231 offset:7808
    ds_read_b64_tr_b16 v[62:63], v231 offset:8448
    s_waitcnt lgkmcnt(6)
    v_mfma_f32_32x32x16_bf16 v[80:95], v[48:51], v[44:47], v[80:95]
    s_waitcnt lgkmcnt(4)
    v_mfma_f32_32x32x16_bf16 v[96:111], v[52:55], v[44:47], v[96:111]
    s_waitcnt lgkmcnt(2)
    v_mfma_f32_32x32x16_bf16 v[112:127], v[56:59], v[44:47], v[112:127]
    s_waitcnt lgkmcnt(0)
    v_mfma_f32_32x32x16_bf16 v[128:143], v[60:63], v[44:47], v[128:143]
    s_add_u32 s35, s37, 29696
    buffer_load_dwordx4 v[36:39], v13, s[20:23], s35 offen
    s_waitcnt vmcnt(8)
    s_barrier
    ds_read_b64_tr_b16 v[48:49], v226 offset:0
    ds_read_b64_tr_b16 v[50:51], v226 offset:640
    ds_read_b64_tr_b16 v[52:53], v226 offset:32
    ds_read_b64_tr_b16 v[54:55], v226 offset:672
    ds_read_b64_tr_b16 v[56:57], v226 offset:64
    ds_read_b64_tr_b16 v[58:59], v226 offset:704
    ds_read_b64_tr_b16 v[60:61], v226 offset:96
    ds_read_b64_tr_b16 v[62:63], v226 offset:736
    s_waitcnt vmcnt(7) lgkmcnt(6)
    v_mfma_f32_32x32x16_bf16 v[64:79], v[48:51], v[16:19], v[64:79]
    ds_read_b64_tr_b16 v[48:49], v226 offset:128
    ds_read_b64_tr_b16 v[50:51], v226 offset:768
    s_waitcnt lgkmcnt(6)
    v_mfma_f32_32x32x16_bf16 v[80:95], v[52:55], v[16:19], v[80:95]
    s_add_u32 m0, s29, 82944
    s_add_u32 s30, s28, 589952
    buffer_load_dwordx4 v8, s[12:15], s30 offen lds
    ds_read_b64_tr_b16 v[52:53], v226 offset:2560
    ds_read_b64_tr_b16 v[54:55], v226 offset:3200
    s_waitcnt lgkmcnt(6)
    v_mfma_f32_32x32x16_bf16 v[96:111], v[56:59], v[16:19], v[96:111]
    ds_read_b64_tr_b16 v[56:57], v226 offset:2592
    ds_read_b64_tr_b16 v[58:59], v226 offset:3232
    s_waitcnt lgkmcnt(6)
    v_mfma_f32_32x32x16_bf16 v[112:127], v[60:63], v[16:19], v[112:127]
    s_add_u32 m0, s29, 87040
    s_add_u32 s30, s28, 589952
    buffer_load_dwordx4 v9, s[12:15], s30 offen lds
    ds_read_b64_tr_b16 v[60:61], v226 offset:2624
    ds_read_b64_tr_b16 v[62:63], v226 offset:3264
    s_waitcnt lgkmcnt(6)
    v_mfma_f32_32x32x16_bf16 v[128:143], v[48:51], v[16:19], v[128:143]
    s_add_u32 s35, s37, 30720
    buffer_load_dwordx4 v[40:43], v13, s[20:23], s35 offen
    ds_read_b64_tr_b16 v[48:49], v226 offset:2656
    ds_read_b64_tr_b16 v[50:51], v226 offset:3296
    s_waitcnt vmcnt(9) lgkmcnt(6)
    v_mfma_f32_32x32x16_bf16 v[64:79], v[52:55], v[20:23], v[64:79]
    s_cmp_ge_u32 s32, 2
    s_cbranch_scc1 nod_k3_gateup_kernel_12
    s_add_u32 m0, s29, 91136
    s_add_u32 s30, s28, 589952
    buffer_load_dwordx4 v10, s[12:15], s30 offen lds
nod_k3_gateup_kernel_12:
    ds_read_b64_tr_b16 v[52:53], v226 offset:2688
    ds_read_b64_tr_b16 v[54:55], v226 offset:3328
    s_waitcnt lgkmcnt(6)
    v_mfma_f32_32x32x16_bf16 v[80:95], v[56:59], v[20:23], v[80:95]
    ds_read_b64_tr_b16 v[56:57], v226 offset:5120
    ds_read_b64_tr_b16 v[58:59], v226 offset:5760
    s_waitcnt lgkmcnt(6)
    v_mfma_f32_32x32x16_bf16 v[96:111], v[60:63], v[20:23], v[96:111]
    ds_read_b64_tr_b16 v[60:61], v226 offset:5152
    ds_read_b64_tr_b16 v[62:63], v226 offset:5792
    s_waitcnt lgkmcnt(6)
    v_mfma_f32_32x32x16_bf16 v[112:127], v[48:51], v[20:23], v[112:127]
    ds_read_b64_tr_b16 v[48:49], v226 offset:5184
    ds_read_b64_tr_b16 v[50:51], v226 offset:5824
    s_waitcnt lgkmcnt(6)
    v_mfma_f32_32x32x16_bf16 v[128:143], v[52:55], v[20:23], v[128:143]
    s_add_u32 s35, s37, 31744
    buffer_load_dwordx4 v[44:47], v13, s[20:23], s35 offen
    ds_read_b64_tr_b16 v[52:53], v226 offset:5216
    ds_read_b64_tr_b16 v[54:55], v226 offset:5856
    s_waitcnt vmcnt(7) lgkmcnt(6)
    v_mfma_f32_32x32x16_bf16 v[64:79], v[56:59], v[24:27], v[64:79]
    ds_read_b64_tr_b16 v[56:57], v226 offset:5248
    ds_read_b64_tr_b16 v[58:59], v226 offset:5888
    s_waitcnt lgkmcnt(6)
    v_mfma_f32_32x32x16_bf16 v[80:95], v[60:63], v[24:27], v[80:95]
    ds_read_b64_tr_b16 v[60:61], v226 offset:7680
    ds_read_b64_tr_b16 v[62:63], v226 offset:8320
    s_waitcnt lgkmcnt(6)
    v_mfma_f32_32x32x16_bf16 v[96:111], v[48:51], v[24:27], v[96:111]
    ds_read_b64_tr_b16 v[48:49], v226 offset:7712
    ds_read_b64_tr_b16 v[50:51], v226 offset:8352
    s_waitcnt lgkmcnt(6)
    v_mfma_f32_32x32x16_bf16 v[112:127], v[52:55], v[24:27], v[112:127]
    ds_read_b64_tr_b16 v[52:53], v226 offset:7744
    ds_read_b64_tr_b16 v[54:55], v226 offset:8384
    s_waitcnt lgkmcnt(6)
    v_mfma_f32_32x32x16_bf16 v[128:143], v[56:59], v[24:27], v[128:143]
    s_add_u32 s35, s37, 32768
    buffer_load_dwordx4 v[16:19], v13, s[20:23], s35 offen
    ds_read_b64_tr_b16 v[56:57], v226 offset:7776
    ds_read_b64_tr_b16 v[58:59], v226 offset:8416
    s_waitcnt vmcnt(7) lgkmcnt(6)
    v_mfma_f32_32x32x16_bf16 v[64:79], v[60:63], v[28:31], v[64:79]
    ds_read_b64_tr_b16 v[60:61], v226 offset:7808
    ds_read_b64_tr_b16 v[62:63], v226 offset:8448
    s_waitcnt lgkmcnt(6)
    v_mfma_f32_32x32x16_bf16 v[80:95], v[48:51], v[28:31], v[80:95]
    s_waitcnt lgkmcnt(4)
    v_mfma_f32_32x32x16_bf16 v[96:111], v[52:55], v[28:31], v[96:111]
    s_waitcnt lgkmcnt(2)
    v_mfma_f32_32x32x16_bf16 v[112:127], v[56:59], v[28:31], v[112:127]
    s_waitcnt lgkmcnt(0)
    v_mfma_f32_32x32x16_bf16 v[128:143], v[60:63], v[28:31], v[128:143]
    s_add_u32 s35, s37, 33792
    buffer_load_dwordx4 v[20:23], v13, s[20:23], s35 offen
    s_waitcnt vmcnt(8)
    s_barrier
    ds_read_b64_tr_b16 v[48:49], v227 offset:0
    ds_read_b64_tr_b16 v[50:51], v227 offset:640
    ds_read_b64_tr_b16 v[52:53], v227 offset:32
    ds_read_b64_tr_b16 v[54:55], v227 offset:672
    ds_read_b64_tr_b16 v[56:57], v227 offset:64
    ds_read_b64_tr_b16 v[58:59], v227 offset:704
    ds_read_b64_tr_b16 v[60:61], v227 offset:96
    ds_read_b64_tr_b16 v[62:63], v227 offset:736
    s_waitcnt vmcnt(7) lgkmcnt(6)
    v_mfma_f32_32x32x16_bf16 v[64:79], v[48:51], v[32:35], v[64:79]
    ds_read_b64_tr_b16 v[48:49], v227 offset:128
    ds_read_b64_tr_b16 v[50:51], v227 offset:768
    s_waitcnt lgkmcnt(6)
    v_mfma_f32_32x32x16_bf16 v[80:95], v[52:55], v[32:35], v[80:95]
    s_add_u32 m0, s29, 103680
    s_add_u32 s30, s28, 1179776
    buffer_load_dwordx4 v8, s[12:15], s30 offen lds
    ds_read_b64_tr_b16 v[52:53], v227 offset:2560
    ds_read_b64_tr_b16 v[54:55], v227 offset:3200
    s_waitcnt lgkmcnt(6)
    v_mfma_f32_32x32x16_bf16 v[96:111], v[56:59], v[32:35], v[96:111]
    ds_read_b64_tr_b16 v[56:57], v227 offset:2592
    ds_read_b64_tr_b16 v[58:59], v227 offset:3232
    s_waitcnt lgkmcnt(6)
    v_mfma_f32_32x32x16_bf16 v[112:127], v[60:63], v[32:35], v[112:127]
    s_add_u32 m0, s29, 107776
    s_add_u32 s30, s28, 1179776
    buffer_load_dwordx4 v9, s[12:15], s30 offen lds
    ds_read_b64_tr_b16 v[60:61], v227 offset:2624
    ds_read_b64_tr_b16 v[62:63], v227 offset:3264
    s_waitcnt lgkmcnt(6)
    v_mfma_f32_32x32x16_bf16 v[128:143], v[48:51], v[32:35], v[128:143]
    s_add_u32 s35, s37, 34816
    buffer_load_dwordx4 v[24:27], v13, s[20:23], s35 offen
    ds_read_b64_tr_b16 v[48:49], v227 offset:2656
    ds_read_b64_tr_b16 v[50:51], v227 offset:3296
    s_waitcnt vmcnt(9) lgkmcnt(6)
    v_mfma_f32_32x32x16_bf16 v[64:79], v[52:55], v[36:39], v[64:79]
    s_cmp_ge_u32 s32, 2
    s_cbranch_scc1 nod_k3_gateup_kernel_13
    s_add_u32 m0, s29, 111872
    s_add_u32 s30, s28, 1179776
    buffer_load_dwordx4 v10, s[12:15], s30 offen lds
nod_k3_gateup_kernel_13:
    ds_read_b64_tr_b16 v[52:53], v227 offset:2688
    ds_read_b64_tr_b16 v[54:55], v227 offset:3328
    s_waitcnt lgkmcnt(6)
    v_mfma_f32_32x32x16_bf16 v[80:95], v[56:59], v[36:39], v[80:95]
    ds_read_b64_tr_b16 v[56:57], v227 offset:5120
    ds_read_b64_tr_b16 v[58:59], v227 offset:5760
    s_waitcnt lgkmcnt(6)
    v_mfma_f32_32x32x16_bf16 v[96:111], v[60:63], v[36:39], v[96:111]
    ds_read_b64_tr_b16 v[60:61], v227 offset:5152
    ds_read_b64_tr_b16 v[62:63], v227 offset:5792
    s_waitcnt lgkmcnt(6)
    v_mfma_f32_32x32x16_bf16 v[112:127], v[48:51], v[36:39], v[112:127]
    ds_read_b64_tr_b16 v[48:49], v227 offset:5184
    ds_read_b64_tr_b16 v[50:51], v227 offset:5824
    s_waitcnt lgkmcnt(6)
    v_mfma_f32_32x32x16_bf16 v[128:143], v[52:55], v[36:39], v[128:143]
    s_add_u32 s35, s37, 35840
    buffer_load_dwordx4 v[28:31], v13, s[20:23], s35 offen
    ds_read_b64_tr_b16 v[52:53], v227 offset:5216
    ds_read_b64_tr_b16 v[54:55], v227 offset:5856
    s_waitcnt vmcnt(7) lgkmcnt(6)
    v_mfma_f32_32x32x16_bf16 v[64:79], v[56:59], v[40:43], v[64:79]
    ds_read_b64_tr_b16 v[56:57], v227 offset:5248
    ds_read_b64_tr_b16 v[58:59], v227 offset:5888
    s_waitcnt lgkmcnt(6)
    v_mfma_f32_32x32x16_bf16 v[80:95], v[60:63], v[40:43], v[80:95]
    ds_read_b64_tr_b16 v[60:61], v227 offset:7680
    ds_read_b64_tr_b16 v[62:63], v227 offset:8320
    s_waitcnt lgkmcnt(6)
    v_mfma_f32_32x32x16_bf16 v[96:111], v[48:51], v[40:43], v[96:111]
    ds_read_b64_tr_b16 v[48:49], v227 offset:7712
    ds_read_b64_tr_b16 v[50:51], v227 offset:8352
    s_waitcnt lgkmcnt(6)
    v_mfma_f32_32x32x16_bf16 v[112:127], v[52:55], v[40:43], v[112:127]
    ds_read_b64_tr_b16 v[52:53], v227 offset:7744
    ds_read_b64_tr_b16 v[54:55], v227 offset:8384
    s_waitcnt lgkmcnt(6)
    v_mfma_f32_32x32x16_bf16 v[128:143], v[56:59], v[40:43], v[128:143]
    s_add_u32 s35, s37, 0
    buffer_load_dwordx4 v[32:35], v13, s[20:23], s35 offen
    ds_read_b64_tr_b16 v[56:57], v227 offset:7776
    ds_read_b64_tr_b16 v[58:59], v227 offset:8416
    s_waitcnt vmcnt(7) lgkmcnt(6)
    v_mfma_f32_32x32x16_bf16 v[64:79], v[60:63], v[44:47], v[64:79]
    ds_read_b64_tr_b16 v[60:61], v227 offset:7808
    ds_read_b64_tr_b16 v[62:63], v227 offset:8448
    s_waitcnt lgkmcnt(6)
    v_mfma_f32_32x32x16_bf16 v[80:95], v[48:51], v[44:47], v[80:95]
    s_waitcnt lgkmcnt(4)
    v_mfma_f32_32x32x16_bf16 v[96:111], v[52:55], v[44:47], v[96:111]
    s_waitcnt lgkmcnt(2)
    v_mfma_f32_32x32x16_bf16 v[112:127], v[56:59], v[44:47], v[112:127]
    s_waitcnt lgkmcnt(0)
    v_mfma_f32_32x32x16_bf16 v[128:143], v[60:63], v[44:47], v[128:143]
    s_add_u32 s35, s37, 1024
    buffer_load_dwordx4 v[36:39], v13, s[20:23], s35 offen
    s_waitcnt vmcnt(8)
    s_barrier
    ds_read_b64_tr_b16 v[48:49], v228 offset:0
    ds_read_b64_tr_b16 v[50:51], v228 offset:640
    ds_read_b64_tr_b16 v[52:53], v228 offset:32
    ds_read_b64_tr_b16 v[54:55], v228 offset:672
    ds_read_b64_tr_b16 v[56:57], v228 offset:64
    ds_read_b64_tr_b16 v[58:59], v228 offset:704
    ds_read_b64_tr_b16 v[60:61], v228 offset:96
    ds_read_b64_tr_b16 v[62:63], v228 offset:736
    s_waitcnt vmcnt(7) lgkmcnt(6)
    v_mfma_f32_32x32x16_bf16 v[64:79], v[48:51], v[16:19], v[64:79]
    ds_read_b64_tr_b16 v[48:49], v228 offset:128
    ds_read_b64_tr_b16 v[50:51], v228 offset:768
    s_waitcnt lgkmcnt(6)
    v_mfma_f32_32x32x16_bf16 v[80:95], v[52:55], v[16:19], v[80:95]
    s_add_u32 m0, s29, 0
    s_add_u32 s30, s28, 1769600
    buffer_load_dwordx4 v8, s[12:15], s30 offen lds
    ds_read_b64_tr_b16 v[52:53], v228 offset:2560
    ds_read_b64_tr_b16 v[54:55], v228 offset:3200
    s_waitcnt lgkmcnt(6)
    v_mfma_f32_32x32x16_bf16 v[96:111], v[56:59], v[16:19], v[96:111]
    ds_read_b64_tr_b16 v[56:57], v228 offset:2592
    ds_read_b64_tr_b16 v[58:59], v228 offset:3232
    s_waitcnt lgkmcnt(6)
    v_mfma_f32_32x32x16_bf16 v[112:127], v[60:63], v[16:19], v[112:127]
    s_add_u32 m0, s29, 4096
    s_add_u32 s30, s28, 1769600
    buffer_load_dwordx4 v9, s[12:15], s30 offen lds
    ds_read_b64_tr_b16 v[60:61], v228 offset:2624
    ds_read_b64_tr_b16 v[62:63], v228 offset:3264
    s_waitcnt lgkmcnt(6)
    v_mfma_f32_32x32x16_bf16 v[128:143], v[48:51], v[16:19], v[128:143]
    s_add_u32 s35, s37, 2048
    buffer_load_dwordx4 v[40:43], v13, s[20:23], s35 offen
    ds_read_b64_tr_b16 v[48:49], v228 offset:2656
    ds_read_b64_tr_b16 v[50:51], v228 offset:3296
    s_waitcnt vmcnt(9) lgkmcnt(6)
    v_mfma_f32_32x32x16_bf16 v[64:79], v[52:55], v[20:23], v[64:79]
    s_cmp_ge_u32 s32, 2
    s_cbranch_scc1 nod_k3_gateup_kernel_14
    s_add_u32 m0, s29, 8192
    s_add_u32 s30, s28, 1769600
    buffer_load_dwordx4 v10, s[12:15], s30 offen lds
nod_k3_gateup_kernel_14:
    ds_read_b64_tr_b16 v[52:53], v228 offset:2688
    ds_read_b64_tr_b16 v[54:55], v228 offset:3328
    s_waitcnt lgkmcnt(6)
    v_mfma_f32_32x32x16_bf16 v[80:95], v[56:59], v[20:23], v[80:95]
    ds_read_b64_tr_b16 v[56:57], v228 offset:5120
    ds_read_b64_tr_b16 v[58:59], v228 offset:5760
    s_waitcnt lgkmcnt(6)
    v_mfma_f32_32x32x16_bf16 v[96:111], v[60:63], v[20:23], v[96:111]
    ds_read_b64_tr_b16 v[60:61], v228 offset:5152
    ds_read_b64_tr_b16 v[62:63], v228 offset:5792
    s_waitcnt lgkmcnt(6)
    v_mfma_f32_32x32x16_bf16 v[112:127], v[48:51], v[20:23], v[112:127]
    ds_read_b64_tr_b16 v[48:49], v228 offset:5184
    ds_read_b64_tr_b16 v[50:51], v228 offset:5824
    s_waitcnt lgkmcnt(6)
    v_mfma_f32_32x32x16_bf16 v[128:143], v[52:55], v[20:23], v[128:143]
    s_add_u32 s35, s37, 3072
    buffer_load_dwordx4 v[44:47], v13, s[20:23], s35 offen
    ds_read_b64_tr_b16 v[52:53], v228 offset:5216
    ds_read_b64_tr_b16 v[54:55], v228 offset:5856
    s_waitcnt vmcnt(7) lgkmcnt(6)
    v_mfma_f32_32x32x16_bf16 v[64:79], v[56:59], v[24:27], v[64:79]
    ds_read_b64_tr_b16 v[56:57], v228 offset:5248
    ds_read_b64_tr_b16 v[58:59], v228 offset:5888
    s_waitcnt lgkmcnt(6)
    v_mfma_f32_32x32x16_bf16 v[80:95], v[60:63], v[24:27], v[80:95]
    ds_read_b64_tr_b16 v[60:61], v228 offset:7680
    ds_read_b64_tr_b16 v[62:63], v228 offset:8320
    s_waitcnt lgkmcnt(6)
    v_mfma_f32_32x32x16_bf16 v[96:111], v[48:51], v[24:27], v[96:111]
    ds_read_b64_tr_b16 v[48:49], v228 offset:7712
    ds_read_b64_tr_b16 v[50:51], v228 offset:8352
    s_waitcnt lgkmcnt(6)
    v_mfma_f32_32x32x16_bf16 v[112:127], v[52:55], v[24:27], v[112:127]
    ds_read_b64_tr_b16 v[52:53], v228 offset:7744
    ds_read_b64_tr_b16 v[54:55], v228 offset:8384
    s_waitcnt lgkmcnt(6)
    v_mfma_f32_32x32x16_bf16 v[128:143], v[56:59], v[24:27], v[128:143]
    s_add_u32 s35, s37, 4096
    buffer_load_dwordx4 v[16:19], v13, s[20:23], s35 offen
    ds_read_b64_tr_b16 v[56:57], v228 offset:7776
    ds_read_b64_tr_b16 v[58:59], v228 offset:8416
    s_waitcnt vmcnt(7) lgkmcnt(6)
    v_mfma_f32_32x32x16_bf16 v[64:79], v[60:63], v[28:31], v[64:79]
    ds_read_b64_tr_b16 v[60:61], v228 offset:7808
    ds_read_b64_tr_b16 v[62:63], v228 offset:8448
    s_waitcnt lgkmcnt(6)
    v_mfma_f32_32x32x16_bf16 v[80:95], v[48:51], v[28:31], v[80:95]
    s_waitcnt lgkmcnt(4)
    v_mfma_f32_32x32x16_bf16 v[96:111], v[52:55], v[28:31], v[96:111]
    s_waitcnt lgkmcnt(2)
    v_mfma_f32_32x32x16_bf16 v[112:127], v[56:59], v[28:31], v[112:127]
    s_waitcnt lgkmcnt(0)
    v_mfma_f32_32x32x16_bf16 v[128:143], v[60:63], v[28:31], v[128:143]
    s_add_u32 s35, s37, 5120
    buffer_load_dwordx4 v[20:23], v13, s[20:23], s35 offen
    s_waitcnt vmcnt(8)
    s_barrier
    ds_read_b64_tr_b16 v[48:49], v229 offset:32
    ds_read_b64_tr_b16 v[50:51], v229 offset:672
    ds_read_b64_tr_b16 v[52:53], v229 offset:64
    ds_read_b64_tr_b16 v[54:55], v229 offset:704
    ds_read_b64_tr_b16 v[56:57], v229 offset:96
    ds_read_b64_tr_b16 v[58:59], v229 offset:736
    ds_read_b64_tr_b16 v[60:61], v229 offset:128
    ds_read_b64_tr_b16 v[62:63], v229 offset:768
    s_waitcnt vmcnt(7) lgkmcnt(6)
    v_mfma_f32_32x32x16_bf16 v[144:159], v[48:51], v[32:35], 0
    ds_read_b64_tr_b16 v[48:49], v229 offset:2592
    ds_read_b64_tr_b16 v[50:51], v229 offset:3232
    s_waitcnt lgkmcnt(6)
    v_mfma_f32_32x32x16_bf16 v[160:175], v[52:55], v[32:35], 0
    s_add_u32 m0, s29, 20736
    s_add_u32 s30, s28, 2359424
    buffer_load_dwordx4 v8, s[12:15], s30 offen lds
    ds_read_b64_tr_b16 v[52:53], v229 offset:2624
    ds_read_b64_tr_b16 v[54:55], v229 offset:3264
    s_waitcnt lgkmcnt(6)
    v_mfma_f32_32x32x16_bf16 v[176:191], v[56:59], v[32:35], 0
    v_cvt_pk_bf16_f32 v208, v64, v65
    v_cvt_pk_bf16_f32 v209, v66, v67
    v_cvt_pk_bf16_f32 v210, v68, v69
    ds_read_b64_tr_b16 v[56:57], v229 offset:2656
    ds_read_b64_tr_b16 v[58:59], v229 offset:3296
    s_waitcnt lgkmcnt(6)
    v_mfma_f32_32x32x16_bf16 v[192:207], v[60:63], v[32:35], 0
    s_add_u32 s35, s37, 6144
    buffer_load_dwordx4 v[24:27], v13, s[20:23], s35 offen
    s_add_u32 m0, s29, 24832
    s_add_u32 s30, s28, 2359424
    buffer_load_dwordx4 v9, s[12:15], s30 offen lds
    v_cvt_pk_bf16_f32 v211, v70, v71
    v_cvt_pk_bf16_f32 v212, v72, v73
    v_cvt_pk_bf16_f32 v213, v74, v75
    ds_read_b64_tr_b16 v[60:61], v229 offset:2688
    ds_read_b64_tr_b16 v[62:63], v229 offset:3328
    s_waitcnt vmcnt(9) lgkmcnt(6)
    v_mfma_f32_32x32x16_bf16 v[144:159], v[48:51], v[36:39], v[144:159]
    v_cvt_pk_bf16_f32 v214, v76, v77
    v_cvt_pk_bf16_f32 v215, v78, v79
    v_lshlrev_b32 v64, 16, v208
    ds_read_b64_tr_b16 v[48:49], v229 offset:5152
    ds_read_b64_tr_b16 v[50:51], v229 offset:5792
    s_waitcnt lgkmcnt(6)
    v_mfma_f32_32x32x16_bf16 v[160:175], v[52:55], v[36:39], v[160:175]
    s_cmp_ge_u32 s32, 2
    s_cbranch_scc1 nod_k3_gateup_kernel_15
    s_add_u32 m0, s29, 28928
    s_add_u32 s30, s28, 2359424
    buffer_load_dwordx4 v10, s[12:15], s30 offen lds
nod_k3_gateup_kernel_15:
    v_and_b32 v65, 0xffff0000, v208
    v_lshlrev_b32 v66, 16, v209
    v_and_b32 v67, 0xffff0000, v209
    ds_read_b64_tr_b16 v[52:53], v229 offset:5184
    ds_read_b64_tr_b16 v[54:55], v229 offset:5824
    s_waitcnt lgkmcnt(6)
    v_mfma_f32_32x32x16_bf16 v[176:191], v[56:59], v[36:39], v[176:191]
    v_lshlrev_b32 v68, 16, v210
    v_and_b32 v69, 0xffff0000, v210
    v_lshlrev_b32 v70, 16, v211
    ds_read_b64_tr_b16 v[56:57], v229 offset:5216
    ds_read_b64_tr_b16 v[58:59], v229 offset:5856
    s_waitcnt lgkmcnt(6)
    v_mfma_f32_32x32x16_bf16 v[192:207], v[60:63], v[36:39], v[192:207]
    s_add_u32 s35, s37, 7168
    buffer_load_dwordx4 v[28:31], v13, s[20:23], s35 offen
    v_and_b32 v71, 0xffff0000, v211
    v_lshlrev_b32 v72, 16, v212
    v_and_b32 v73, 0xffff0000, v212
    ds_read_b64_tr_b16 v[60:61], v229 offset:5248
    ds_read_b64_tr_b16 v[62:63], v229 offset:5888
    s_waitcnt vmcnt(7) lgkmcnt(6)
    v_mfma_f32_32x32x16_bf16 v[144:159], v[48:51], v[40:43], v[144:159]
    v_lshlrev_b32 v74, 16, v213
    v_and_b32 v75, 0xffff0000, v213
    v_lshlrev_b32 v76, 16, v214
    ds_read_b64_tr_b16 v[48:49], v229 offset:7712
    ds_read_b64_tr_b16 v[50:51], v229 offset:8352
    s_waitcnt lgkmcnt(6)
    v_mfma_f32_32x32x16_bf16 v[160:175], v[52:55], v[40:43], v[160:175]
    v_and_b32 v77, 0xffff0000, v214
    v_lshlrev_b32 v78, 16, v215
    v_and_b32 v79, 0xffff0000, v215
    ds_read_b64_tr_b16 v[52:53], v229 offset:7744
    ds_read_b64_tr_b16 v[54:55], v229 offset:8384
    s_waitcnt lgkmcnt(6)
    v_mfma_f32_32x32x16_bf16 v[176:191], v[56:59], v[40:43], v[176:191]
    v_pk_mul_f32 v[208:209], v[64:65], v[64:65]
    v_pk_mul_f32 v[210:211], v[66:67], v[66:67]
    v_pk_mul_f32 v[212:213], v[68:69], v[68:69]
    ds_read_b64_tr_b16 v[56:57], v229 offset:7776
    ds_read_b64_tr_b16 v[58:59], v229 offset:8416
    s_waitcnt lgkmcnt(6)
    v_mfma_f32_32x32x16_bf16 v[192:207], v[60:63], v[40:43], v[192:207]
    s_add_u32 s35, s37, 8192
    buffer_load_dwordx4 v[32:35], v13, s[20:23], s35 offen
    v_pk_mul_f32 v[214:215], v[70:71], v[70:71]
    v_pk_fma_f32 v[208:209], v[208:209], v[222:223], v[220:221]
    v_pk_fma_f32 v[210:211], v[210:211], v[222:223], v[220:221]
    ds_read_b64_tr_b16 v[60:61], v229 offset:7808
    ds_read_b64_tr_b16 v[62:63], v229 offset:8448
    s_waitcnt vmcnt(7) lgkmcnt(6)
    v_mfma_f32_32x32x16_bf16 v[144:159], v[48:51], v[44:47], v[144:159]
    v_pk_fma_f32 v[212:213], v[212:213], v[222:223], v[220:221]
    v_pk_fma_f32 v[214:215], v[214:215], v[222:223], v[220:221]
    v_pk_mul_f32 v[208:209], v[208:209], v[64:65]
    s_waitcnt lgkmcnt(4)
    v_mfma_f32_32x32x16_bf16 v[160:175], v[52:55], v[44:47], v[160:175]
    v_pk_mul_f32 v[210:211], v[210:211], v[66:67]
    v_pk_mul_f32 v[212:213], v[212:213], v[68:69]
    v_pk_mul_f32 v[214:215], v[214:215], v[70:71]
    s_waitcnt lgkmcnt(2)
    v_mfma_f32_32x32x16_bf16 v[176:191], v[56:59], v[44:47], v[176:191]
    v_exp_f32 v208, v208
    v_exp_f32 v209, v209
    v_exp_f32 v210, v210
    s_waitcnt lgkmcnt(0)
    v_mfma_f32_32x32x16_bf16 v[192:207], v[60:63], v[44:47], v[192:207]
    s_add_u32 s35, s37, 9216
    buffer_load_dwordx4 v[36:39], v13, s[20:23], s35 offen
    v_exp_f32 v211, v211
    v_exp_f32 v212, v212
    v_exp_f32 v213, v213
    s_waitcnt vmcnt(8)
    s_barrier
    ds_read_b64_tr_b16 v[48:49], v230 offset:32
    ds_read_b64_tr_b16 v[50:51], v230 offset:672
    ds_read_b64_tr_b16 v[52:53], v230 offset:64
    ds_read_b64_tr_b16 v[54:55], v230 offset:704
    ds_read_b64_tr_b16 v[56:57], v230 offset:96
    ds_read_b64_tr_b16 v[58:59], v230 offset:736
    ds_read_b64_tr_b16 v[60:61], v230 offset:128
    ds_read_b64_tr_b16 v[62:63], v230 offset:768
    s_waitcnt vmcnt(7) lgkmcnt(6)
    v_mfma_f32_32x32x16_bf16 v[144:159], v[48:51], v[16:19], v[144:159]
    v_exp_f32 v214, v214
    v_exp_f32 v215, v215
    v_pk_add_f32 v[208:209], v[208:209], v[224:225]
    ds_read_b64_tr_b16 v[48:49], v230 offset:2592
    ds_read_b64_tr_b16 v[50:51], v230 offset:3232
    s_waitcnt lgkmcnt(6)
    v_mfma_f32_32x32x16_bf16 v[160:175], v[52:55], v[16:19], v[160:175]
    s_add_u32 m0, s29, 41472
    s_add_u32 s30, s28, 2949248
    buffer_load_dwordx4 v8, s[12:15], s30 offen lds
    v_pk_add_f32 v[210:211], v[210:211], v[224:225]
    v_pk_add_f32 v[212:213], v[212:213], v[224:225]
    v_pk_add_f32 v[214:215], v[214:215], v[224:225]
    ds_read_b64_tr_b16 v[52:53], v230 offset:2624
    ds_read_b64_tr_b16 v[54:55], v230 offset:3264
    s_waitcnt lgkmcnt(6)
    v_mfma_f32_32x32x16_bf16 v[176:191], v[56:59], v[16:19], v[176:191]
    v_rcp_f32 v208, v208
    v_rcp_f32 v209, v209
    v_rcp_f32 v210, v210
    ds_read_b64_tr_b16 v[56:57], v230 offset:2656
    ds_read_b64_tr_b16 v[58:59], v230 offset:3296
    s_waitcnt lgkmcnt(6)
    v_mfma_f32_32x32x16_bf16 v[192:207], v[60:63], v[16:19], v[192:207]
    s_add_u32 s35, s37, 10240
    buffer_load_dwordx4 v[40:43], v13, s[20:23], s35 offen
    s_add_u32 m0, s29, 45568
    s_add_u32 s30, s28, 2949248
    buffer_load_dwordx4 v9, s[12:15], s30 offen lds
    v_rcp_f32 v211, v211
    v_rcp_f32 v212, v212
    v_rcp_f32 v213, v213
    ds_read_b64_tr_b16 v[60:61], v230 offset:2688
    ds_read_b64_tr_b16 v[62:63], v230 offset:3328
    s_waitcnt vmcnt(9) lgkmcnt(6)
    v_mfma_f32_32x32x16_bf16 v[144:159], v[48:51], v[20:23], v[144:159]
    v_rcp_f32 v214, v214
    v_rcp_f32 v215, v215
    v_pk_mul_f32 v[64:65], v[64:65], v[208:209]
    ds_read_b64_tr_b16 v[48:49], v230 offset:5152
    ds_read_b64_tr_b16 v[50:51], v230 offset:5792
    s_waitcnt lgkmcnt(6)
    v_mfma_f32_32x32x16_bf16 v[160:175], v[52:55], v[20:23], v[160:175]
    s_cmp_ge_u32 s32, 2
    s_cbranch_scc1 nod_k3_gateup_kernel_16
    s_add_u32 m0, s29, 49664
    s_add_u32 s30, s28, 2949248
    buffer_load_dwordx4 v10, s[12:15], s30 offen lds
nod_k3_gateup_kernel_16:
    v_pk_mul_f32 v[66:67], v[66:67], v[210:211]
    v_pk_mul_f32 v[68:69], v[68:69], v[212:213]
    v_pk_mul_f32 v[70:71], v[70:71], v[214:215]
    ds_read_b64_tr_b16 v[52:53], v230 offset:5184
    ds_read_b64_tr_b16 v[54:55], v230 offset:5824
    s_waitcnt lgkmcnt(6)
    v_mfma_f32_32x32x16_bf16 v[176:191], v[56:59], v[20:23], v[176:191]
    v_cvt_pk_bf16_f32 v208, v64, v65
    v_cvt_pk_bf16_f32 v209, v66, v67
    v_cvt_pk_bf16_f32 v210, v68, v69
    ds_read_b64_tr_b16 v[56:57], v230 offset:5216
    ds_read_b64_tr_b16 v[58:59], v230 offset:5856
    s_waitcnt lgkmcnt(6)
    v_mfma_f32_32x32x16_bf16 v[192:207], v[60:63], v[20:23], v[192:207]
    s_add_u32 s35, s37, 11264
    buffer_load_dwordx4 v[44:47], v13, s[20:23], s35 offen
    v_cvt_pk_bf16_f32 v211, v70, v71
    v_lshlrev_b32 v64, 16, v208
    v_and_b32 v65, 0xffff0000, v208
    ds_read_b64_tr_b16 v[60:61], v230 offset:5248
    ds_read_b64_tr_b16 v[62:63], v230 offset:5888
    s_waitcnt vmcnt(8) lgkmcnt(6)
    v_mfma_f32_32x32x16_bf16 v[144:159], v[48:51], v[24:27], v[144:159]
    v_lshlrev_b32 v66, 16, v209
    v_and_b32 v67, 0xffff0000, v209
    v_lshlrev_b32 v68, 16, v210
    ds_read_b64_tr_b16 v[48:49], v230 offset:7712
    ds_read_b64_tr_b16 v[50:51], v230 offset:8352
    s_waitcnt lgkmcnt(6)
    v_mfma_f32_32x32x16_bf16 v[160:175], v[52:55], v[24:27], v[160:175]
    v_and_b32 v69, 0xffff0000, v210
    v_lshlrev_b32 v70, 16, v211
    v_and_b32 v71, 0xffff0000, v211
    ds_read_b64_tr_b16 v[52:53], v230 offset:7744
    ds_read_b64_tr_b16 v[54:55], v230 offset:8384
    s_waitcnt lgkmcnt(6)
    v_mfma_f32_32x32x16_bf16 v[176:191], v[56:59], v[24:27], v[176:191]
    v_pk_mul_f32 v[64:65], v[64:65], v[72:73]
    v_pk_mul_f32 v[66:67], v[66:67], v[74:75]
    v_pk_mul_f32 v[68:69], v[68:69], v[76:77]
    ds_read_b64_tr_b16 v[56:57], v230 offset:7776
    ds_read_b64_tr_b16 v[58:59], v230 offset:8416
    s_waitcnt lgkmcnt(6)
    v_mfma_f32_32x32x16_bf16 v[192:207], v[60:63], v[24:27], v[192:207]
    s_add_u32 s35, s37, 12288
    buffer_load_dwordx4 v[16:19], v13, s[20:23], s35 offen
    v_pk_mul_f32 v[70:71], v[70:71], v[78:79]
    v_cvt_pk_bf16_f32 v216, v64, v65
    v_cvt_pk_bf16_f32 v217, v66, v67
    ds_read_b64_tr_b16 v[60:61], v230 offset:7808
    ds_read_b64_tr_b16 v[62:63], v230 offset:8448
    s_waitcnt vmcnt(7) lgkmcnt(6)
    v_mfma_f32_32x32x16_bf16 v[144:159], v[48:51], v[28:31], v[144:159]
    v_cvt_pk_bf16_f32 v218, v68, v69
    v_cvt_pk_bf16_f32 v219, v70, v71
    s_add_u32 s41, s38, 0
    s_waitcnt lgkmcnt(4)
    v_mfma_f32_32x32x16_bf16 v[160:175], v[52:55], v[28:31], v[160:175]
    buffer_store_dwordx4 v[216:219], v13, s[20:23], s41 offen
    v_cvt_pk_bf16_f32 v208, v80, v81
    v_cvt_pk_bf16_f32 v209, v82, v83
    s_waitcnt lgkmcnt(2)
    v_mfma_f32_32x32x16_bf16 v[176:191], v[56:59], v[28:31], v[176:191]
    v_cvt_pk_bf16_f32 v210, v84, v85
    v_cvt_pk_bf16_f32 v211, v86, v87
    v_cvt_pk_bf16_f32 v212, v88, v89
    s_waitcnt lgkmcnt(0)
    v_mfma_f32_32x32x16_bf16 v[192:207], v[60:63], v[28:31], v[192:207]
    s_add_u32 s35, s37, 13312
    buffer_load_dwordx4 v[20:23], v13, s[20:23], s35 offen
    v_cvt_pk_bf16_f32 v213, v90, v91
    v_cvt_pk_bf16_f32 v214, v92, v93
    v_cvt_pk_bf16_f32 v215, v94, v95
    s_waitcnt vmcnt(9)
    s_barrier
    ds_read_b64_tr_b16 v[48:49], v231 offset:32
    ds_read_b64_tr_b16 v[50:51], v231 offset:672
    ds_read_b64_tr_b16 v[52:53], v231 offset:64
    ds_read_b64_tr_b16 v[54:55], v231 offset:704
    ds_read_b64_tr_b16 v[56:57], v231 offset:96
    ds_read_b64_tr_b16 v[58:59], v231 offset:736
    ds_read_b64_tr_b16 v[60:61], v231 offset:128
    ds_read_b64_tr_b16 v[62:63], v231 offset:768
    s_waitcnt vmcnt(8) lgkmcnt(6)
    v_mfma_f32_32x32x16_bf16 v[144:159], v[48:51], v[32:35], v[144:159]
    v_lshlrev_b32 v80, 16, v208
    v_and_b32 v81, 0xffff0000, v208
    v_lshlrev_b32 v82, 16, v209
    ds_read_b64_tr_b16 v[48:49], v231 offset:2592
    ds_read_b64_tr_b16 v[50:51], v231 offset:3232
    s_waitcnt lgkmcnt(6)
    v_mfma_f32_32x32x16_bf16 v[160:175], v[52:55], v[32:35], v[160:175]
    s_add_u32 m0, s29, 62208
    s_add_u32 s30, s28, 3539072
    buffer_load_dwordx4 v8, s[12:15], s30 offen lds
    v_and_b32 v83, 0xffff0000, v209
    v_lshlrev_b32 v84, 16, v210
    v_and_b32 v85, 0xffff0000, v210
    ds_read_b64_tr_b16 v[52:53], v231 offset:2624
    ds_read_b64_tr_b16 v[54:55], v231 offset:3264
    s_waitcnt lgkmcnt(6)
    v_mfma_f32_32x32x16_bf16 v[176:191], v[56:59], v[32:35], v[176:191]
    v_lshlrev_b32 v86, 16, v211
    v_and_b32 v87, 0xffff0000, v211
    v_lshlrev_b32 v88, 16, v212
    ds_read_b64_tr_b16 v[56:57], v231 offset:2656
    ds_read_b64_tr_b16 v[58:59], v231 offset:3296
    s_waitcnt lgkmcnt(6)
    v_mfma_f32_32x32x16_bf16 v[192:207], v[60:63], v[32:35], v[192:207]
    s_add_u32 s35, s37, 14336
    buffer_load_dwordx4 v[24:27], v13, s[20:23], s35 offen
    s_add_u32 m0, s29, 66304
    s_add_u32 s30, s28, 3539072
    buffer_load_dwordx4 v9, s[12:15], s30 offen lds
    v_and_b32 v89, 0xffff0000, v212
    v_lshlrev_b32 v90, 16, v213
    v_and_b32 v91, 0xffff0000, v213
    ds_read_b64_tr_b16 v[60:61], v231 offset:2688
    ds_read_b64_tr_b16 v[62:63], v231 offset:3328
    s_waitcnt vmcnt(10) lgkmcnt(6)
    v_mfma_f32_32x32x16_bf16 v[144:159], v[48:51], v[36:39], v[144:159]
    v_lshlrev_b32 v92, 16, v214
    v_and_b32 v93, 0xffff0000, v214
    v_lshlrev_b32 v94, 16, v215
    ds_read_b64_tr_b16 v[48:49], v231 offset:5152
    ds_read_b64_tr_b16 v[50:51], v231 offset:5792
    s_waitcnt lgkmcnt(6)
    v_mfma_f32_32x32x16_bf16 v[160:175], v[52:55], v[36:39], v[160:175]
    s_cmp_ge_u32 s32, 2
    s_cbranch_scc1 nod_k3_gateup_kernel_17
    s_add_u32 m0, s29, 70400
    s_add_u32 s30, s28, 3539072
    buffer_load_dwordx4 v10, s[12:15], s30 offen lds
nod_k3_gateup_kernel_17:
    v_and_b32 v95, 0xffff0000, v215
    v_pk_mul_f32 v[208:209], v[80:81], v[80:81]
    v_pk_mul_f32 v[210:211], v[82:83], v[82:83]
    ds_read_b64_tr_b16 v[52:53], v231 offset:5184
    ds_read_b64_tr_b16 v[54:55], v231 offset:5824
    s_waitcnt lgkmcnt(6)
    v_mfma_f32_32x32x16_bf16 v[176:191], v[56:59], v[36:39], v[176:191]
    v_pk_mul_f32 v[212:213], v[84:85], v[84:85]
    v_pk_mul_f32 v[214:215], v[86:87], v[86:87]
    v_pk_fma_f32 v[208:209], v[208:209], v[222:223], v[220:221]
    ds_read_b64_tr_b16 v[56:57], v231 offset:5216
    ds_read_b64_tr_b16 v[58:59], v231 offset:5856
    s_waitcnt lgkmcnt(6)
    v_mfma_f32_32x32x16_bf16 v[192:207], v[60:63], v[36:39], v[192:207]
    s_add_u32 s35, s37, 15360
    buffer_load_dwordx4 v[28:31], v13, s[20:23], s35 offen
    v_pk_fma_f32 v[210:211], v[210:211], v[222:223], v[220:221]
    v_pk_fma_f32 v[212:213], v[212:213], v[222:223], v[220:221]
    v_pk_fma_f32 v[214:215], v[214:215], v[222:223], v[220:221]
    ds_read_b64_tr_b16 v[60:61], v231 offset:5248
    ds_read_b64_tr_b16 v[62:63], v231 offset:5888
    s_waitcnt vmcnt(9) lgkmcnt(6)
    v_mfma_f32_32x32x16_bf16 v[144:159], v[48:51], v[40:43], v[144:159]
    v_pk_mul_f32 v[208:209], v[208:209], v[80:81]
    v_pk_mul_f32 v[210:211], v[210:211], v[82:83]
    v_pk_mul_f32 v[212:213], v[212:213], v[84:85]
    ds_read_b64_tr_b16 v[48:49], v231 offset:7712
    ds_read_b64_tr_b16 v[50:51], v231 offset:8352
    s_waitcnt lgkmcnt(6)
    v_mfma_f32_32x32x16_bf16 v[160:175], v[52:55], v[40:43], v[160:175]
    v_pk_mul_f32 v[214:215], v[214:215], v[86:87]
    v_exp_f32 v208, v208
    v_exp_f32 v209, v209
    ds_read_b64_tr_b16 v[52:53], v231 offset:7744
    ds_read_b64_tr_b16 v[54:55], v231 offset:8384
    s_waitcnt lgkmcnt(6)
    v_mfma_f32_32x32x16_bf16 v[176:191], v[56:59], v[40:43], v[176:191]
    v_exp_f32 v210, v210
    v_exp_f32 v211, v211
    v_exp_f32 v212, v212
    ds_read_b64_tr_b16 v[56:57], v231 offset:7776
    ds_read_b64_tr_b16 v[58:59], v231 offset:8416
    s_waitcnt lgkmcnt(6)
    v_mfma_f32_32x32x16_bf16 v[192:207], v[60:63], v[40:43], v[192:207]
    s_add_u32 s35, s37, 16384
    buffer_load_dwordx4 v[32:35], v13, s[20:23], s35 offen
    v_exp_f32 v213, v213
    v_exp_f32 v214, v214
    v_exp_f32 v215, v215
    ds_read_b64_tr_b16 v[60:61], v231 offset:7808
    ds_read_b64_tr_b16 v[62:63], v231 offset:8448
    s_waitcnt vmcnt(8) lgkmcnt(6)
    v_mfma_f32_32x32x16_bf16 v[144:159], v[48:51], v[44:47], v[144:159]
    v_pk_add_f32 v[208:209], v[208:209], v[224:225]
    v_pk_add_f32 v[210:211], v[210:211], v[224:225]
    v_pk_add_f32 v[212:213], v[212:213], v[224:225]
    s_waitcnt lgkmcnt(4)
    v_mfma_f32_32x32x16_bf16 v[160:175], v[52:55], v[44:47], v[160:175]
    v_pk_add_f32 v[214:215], v[214:215], v[224:225]
    v_rcp_f32 v208, v208
    v_rcp_f32 v209, v209
    s_waitcnt lgkmcnt(2)
    v_mfma_f32_32x32x16_bf16 v[176:191], v[56:59], v[44:47], v[176:191]
    v_rcp_f32 v210, v210
    v_rcp_f32 v211, v211
    v_rcp_f32 v212, v212
    s_waitcnt lgkmcnt(0)
    v_mfma_f32_32x32x16_bf16 v[192:207], v[60:63], v[44:47], v[192:207]
    s_add_u32 s35, s37, 17408
    buffer_load_dwordx4 v[36:39], v13, s[20:23], s35 offen
    v_rcp_f32 v213, v213
    v_rcp_f32 v214, v214
    v_rcp_f32 v215, v215
    s_waitcnt vmcnt(9)
    s_barrier
    ds_read_b64_tr_b16 v[48:49], v226 offset:32
    ds_read_b64_tr_b16 v[50:51], v226 offset:672
    ds_read_b64_tr_b16 v[52:53], v226 offset:64
    ds_read_b64_tr_b16 v[54:55], v226 offset:704
    ds_read_b64_tr_b16 v[56:57], v226 offset:96
    ds_read_b64_tr_b16 v[58:59], v226 offset:736
    ds_read_b64_tr_b16 v[60:61], v226 offset:128
    ds_read_b64_tr_b16 v[62:63], v226 offset:768
    s_waitcnt vmcnt(8) lgkmcnt(6)
    v_mfma_f32_32x32x16_bf16 v[144:159], v[48:51], v[16:19], v[144:159]
    v_pk_mul_f32 v[80:81], v[80:81], v[208:209]
    v_pk_mul_f32 v[82:83], v[82:83], v[210:211]
    v_pk_mul_f32 v[84:85], v[84:85], v[212:213]
    ds_read_b64_tr_b16 v[48:49], v226 offset:2592
    ds_read_b64_tr_b16 v[50:51], v226 offset:3232
    s_waitcnt lgkmcnt(6)
    v_mfma_f32_32x32x16_bf16 v[160:175], v[52:55], v[16:19], v[160:175]
    s_add_u32 m0, s29, 82944
    s_add_u32 s30, s28, 4128896
    buffer_load_dwordx4 v8, s[12:15], s30 offen lds
    v_pk_mul_f32 v[86:87], v[86:87], v[214:215]
    v_cvt_pk_bf16_f32 v208, v80, v81
    v_cvt_pk_bf16_f32 v209, v82, v83
    ds_read_b64_tr_b16 v[52:53], v226 offset:2624
    ds_read_b64_tr_b16 v[54:55], v226 offset:3264
    s_waitcnt lgkmcnt(6)
    v_mfma_f32_32x32x16_bf16 v[176:191], v[56:59], v[16:19], v[176:191]
    v_cvt_pk_bf16_f32 v210, v84, v85
    v_cvt_pk_bf16_f32 v211, v86, v87
    v_lshlrev_b32 v80, 16, v208
    ds_read_b64_tr_b16 v[56:57], v226 offset:2656
    ds_read_b64_tr_b16 v[58:59], v226 offset:3296
    s_waitcnt lgkmcnt(6)
    v_mfma_f32_32x32x16_bf16 v[192:207], v[60:63], v[16:19], v[192:207]
    s_add_u32 s35, s37, 18432
    buffer_load_dwordx4 v[40:43], v13, s[20:23], s35 offen
    s_add_u32 m0, s29, 87040
    s_add_u32 s30, s28, 4128896
    buffer_load_dwordx4 v9, s[12:15], s30 offen lds
    v_and_b32 v81, 0xffff0000, v208
    v_lshlrev_b32 v82, 16, v209
    v_and_b32 v83, 0xffff0000, v209
    ds_read_b64_tr_b16 v[60:61], v226 offset:2688
    ds_read_b64_tr_b16 v[62:63], v226 offset:3328
    s_waitcnt vmcnt(9) lgkmcnt(6)
    v_mfma_f32_32x32x16_bf16 v[144:159], v[48:51], v[20:23], v[144:159]
    v_lshlrev_b32 v84, 16, v210
    v_and_b32 v85, 0xffff0000, v210
    v_lshlrev_b32 v86, 16, v211
    ds_read_b64_tr_b16 v[48:49], v226 offset:5152
    ds_read_b64_tr_b16 v[50:51], v226 offset:5792
    s_waitcnt lgkmcnt(6)
    v_mfma_f32_32x32x16_bf16 v[160:175], v[52:55], v[20:23], v[160:175]
    s_cmp_ge_u32 s32, 2
    s_cbranch_scc1 nod_k3_gateup_kernel_18
    s_add_u32 m0, s29, 91136
    s_add_u32 s30, s28, 4128896
    buffer_load_dwordx4 v10, s[12:15], s30 offen lds
nod_k3_gateup_kernel_18:
    v_and_b32 v87, 0xffff0000, v211
    v_pk_mul_f32 v[80:81], v[80:81], v[88:89]
    v_pk_mul_f32 v[82:83], v[82:83], v[90:91]
    ds_read_b64_tr_b16 v[52:53], v226 offset:5184
    ds_read_b64_tr_b16 v[54:55], v226 offset:5824
    s_waitcnt lgkmcnt(6)
    v_mfma_f32_32x32x16_bf16 v[176:191], v[56:59], v[20:23], v[176:191]
    v_pk_mul_f32 v[84:85], v[84:85], v[92:93]
    v_pk_mul_f32 v[86:87], v[86:87], v[94:95]
    v_cvt_pk_bf16_f32 v216, v80, v81
    ds_read_b64_tr_b16 v[56:57], v226 offset:5216
    ds_read_b64_tr_b16 v[58:59], v226 offset:5856
    s_waitcnt lgkmcnt(6)
    v_mfma_f32_32x32x16_bf16 v[192:207], v[60:63], v[20:23], v[192:207]
    s_add_u32 s35, s37, 19456
    buffer_load_dwordx4 v[44:47], v13, s[20:23], s35 offen
    v_cvt_pk_bf16_f32 v217, v82, v83
    v_cvt_pk_bf16_f32 v218, v84, v85
    v_cvt_pk_bf16_f32 v219, v86, v87
    ds_read_b64_tr_b16 v[60:61], v226 offset:5248
    ds_read_b64_tr_b16 v[62:63], v226 offset:5888
    s_waitcnt vmcnt(8) lgkmcnt(6)
    v_mfma_f32_32x32x16_bf16 v[144:159], v[48:51], v[24:27], v[144:159]
    s_add_u32 s41, s38, 1024
    buffer_store_dwordx4 v[216:219], v13, s[20:23], s41 offen
    v_cvt_pk_bf16_f32 v208, v96, v97
    ds_read_b64_tr_b16 v[48:49], v226 offset:7712
    ds_read_b64_tr_b16 v[50:51], v226 offset:8352
    s_waitcnt lgkmcnt(6)
    v_mfma_f32_32x32x16_bf16 v[160:175], v[52:55], v[24:27], v[160:175]
    v_cvt_pk_bf16_f32 v209, v98, v99
    v_cvt_pk_bf16_f32 v210, v100, v101
    v_cvt_pk_bf16_f32 v211, v102, v103
    ds_read_b64_tr_b16 v[52:53], v226 offset:7744
    ds_read_b64_tr_b16 v[54:55], v226 offset:8384
    s_waitcnt lgkmcnt(6)
    v_mfma_f32_32x32x16_bf16 v[176:191], v[56:59], v[24:27], v[176:191]
    v_cvt_pk_bf16_f32 v212, v104, v105
    v_cvt_pk_bf16_f32 v213, v106, v107
    v_cvt_pk_bf16_f32 v214, v108, v109
    ds_read_b64_tr_b16 v[56:57], v226 offset:7776
    ds_read_b64_tr_b16 v[58:59], v226 offset:8416
    s_waitcnt lgkmcnt(6)
    v_mfma_f32_32x32x16_bf16 v[192:207], v[60:63], v[24:27], v[192:207]
    s_add_u32 s35, s37, 20480
    buffer_load_dwordx4 v[16:19], v13, s[20:23], s35 offen
    v_cvt_pk_bf16_f32 v215, v110, v111
    v_lshlrev_b32 v96, 16, v208
    v_and_b32 v97, 0xffff0000, v208
    ds_read_b64_tr_b16 v[60:61], v226 offset:7808
    ds_read_b64_tr_b16 v[62:63], v226 offset:8448
    s_waitcnt vmcnt(8) lgkmcnt(6)
    v_mfma_f32_32x32x16_bf16 v[144:159], v[48:51], v[28:31], v[144:159]
    v_lshlrev_b32 v98, 16, v209
    v_and_b32 v99, 0xffff0000, v209
    v_lshlrev_b32 v100, 16, v210
    s_waitcnt lgkmcnt(4)
    v_mfma_f32_32x32x16_bf16 v[160:175], v[52:55], v[28:31], v[160:175]
    v_and_b32 v101, 0xffff0000, v210
    v_lshlrev_b32 v102, 16, v211
    v_and_b32 v103, 0xffff0000, v211
    s_waitcnt lgkmcnt(2)
    v_mfma_f32_32x32x16_bf16 v[176:191], v[56:59], v[28:31], v[176:191]
    v_lshlrev_b32 v104, 16, v212
    v_and_b32 v105, 0xffff0000, v212
    v_lshlrev_b32 v106, 16, v213
    s_waitcnt lgkmcnt(0)
    v_mfma_f32_32x32x16_bf16 v[192:207], v[60:63], v[28:31], v[192:207]
    s_add_u32 s35, s37, 21504
    buffer_load_dwordx4 v[20:23], v13, s[20:23], s35 offen
    v_and_b32 v107, 0xffff0000, v213
    v_lshlrev_b32 v108, 16, v214
    v_and_b32 v109, 0xffff0000, v214
    s_waitcnt vmcnt(9)
    s_barrier
    ds_read_b64_tr_b16 v[48:49], v227 offset:32
    ds_read_b64_tr_b16 v[50:51], v227 offset:672
    ds_read_b64_tr_b16 v[52:53], v227 offset:64
    ds_read_b64_tr_b16 v[54:55], v227 offset:704
    ds_read_b64_tr_b16 v[56:57], v227 offset:96
    ds_read_b64_tr_b16 v[58:59], v227 offset:736
    ds_read_b64_tr_b16 v[60:61], v227 offset:128
    ds_read_b64_tr_b16 v[62:63], v227 offset:768
    s_waitcnt vmcnt(8) lgkmcnt(6)
    v_mfma_f32_32x32x16_bf16 v[144:159], v[48:51], v[32:35], v[144:159]
    v_lshlrev_b32 v110, 16, v215
    v_and_b32 v111, 0xffff0000, v215
    v_pk_mul_f32 v[208:209], v[96:97], v[96:97]
    ds_read_b64_tr_b16 v[48:49], v227 offset:2592
    ds_read_b64_tr_b16 v[50:51], v227 offset:3232
    s_waitcnt lgkmcnt(6)
    v_mfma_f32_32x32x16_bf16 v[160:175], v[52:55], v[32:35], v[160:175]
    s_add_u32 m0, s29, 103680
    s_add_u32 s30, s28, 4718720
    buffer_load_dwordx4 v8, s[12:15], s30 offen lds
    v_pk_mul_f32 v[210:211], v[98:99], v[98:99]
    v_pk_mul_f32 v[212:213], v[100:101], v[100:101]
    v_pk_mul_f32 v[214:215], v[102:103], v[102:103]
    ds_read_b64_tr_b16 v[52:53], v227 offset:2624
    ds_read_b64_tr_b16 v[54:55], v227 offset:3264
    s_waitcnt lgkmcnt(6)
    v_mfma_f32_32x32x16_bf16 v[176:191], v[56:59], v[32:35], v[176:191]
    v_pk_fma_f32 v[208:209], v[208:209], v[222:223], v[220:221]
    v_pk_fma_f32 v[210:211], v[210:211], v[222:223], v[220:221]
    v_pk_fma_f32 v[212:213], v[212:213], v[222:223], v[220:221]
    ds_read_b64_tr_b16 v[56:57], v227 offset:2656
    ds_read_b64_tr_b16 v[58:59], v227 offset:3296
    s_waitcnt lgkmcnt(6)
    v_mfma_f32_32x32x16_bf16 v[192:207], v[60:63], v[32:35], v[192:207]
    s_add_u32 s35, s37, 22528
    buffer_load_dwordx4 v[24:27], v13, s[20:23], s35 offen
    s_add_u32 m0, s29, 107776
    s_add_u32 s30, s28, 4718720
    buffer_load_dwordx4 v9, s[12:15], s30 offen lds
    v_pk_fma_f32 v[214:215], v[214:215], v[222:223], v[220:221]
    v_pk_mul_f32 v[208:209], v[208:209], v[96:97]
    v_pk_mul_f32 v[210:211], v[210:211], v[98:99]
    ds_read_b64_tr_b16 v[60:61], v227 offset:2688
    ds_read_b64_tr_b16 v[62:63], v227 offset:3328
    s_waitcnt vmcnt(10) lgkmcnt(6)
    v_mfma_f32_32x32x16_bf16 v[144:159], v[48:51], v[36:39], v[144:159]
    v_pk_mul_f32 v[212:213], v[212:213], v[100:101]
    v_pk_mul_f32 v[214:215], v[214:215], v[102:103]
    v_exp_f32 v208, v208
    ds_read_b64_tr_b16 v[48:49], v227 offset:5152
    ds_read_b64_tr_b16 v[50:51], v227 offset:5792
    s_waitcnt lgkmcnt(6)
    v_mfma_f32_32x32x16_bf16 v[160:175], v[52:55], v[36:39], v[160:175]
    s_cmp_ge_u32 s32, 2
    s_cbranch_scc1 nod_k3_gateup_kernel_19
    s_add_u32 m0, s29, 111872
    s_add_u32 s30, s28, 4718720
    buffer_load_dwordx4 v10, s[12:15], s30 offen lds
nod_k3_gateup_kernel_19:
    v_exp_f32 v209, v209
    v_exp_f32 v210, v210
    v_exp_f32 v211, v211
    ds_read_b64_tr_b16 v[52:53], v227 offset:5184
    ds_read_b64_tr_b16 v[54:55], v227 offset:5824
    s_waitcnt lgkmcnt(6)
    v_mfma_f32_32x32x16_bf16 v[176:191], v[56:59], v[36:39], v[176:191]
    v_exp_f32 v212, v212
    v_exp_f32 v213, v213
    v_exp_f32 v214, v214
    ds_read_b64_tr_b16 v[56:57], v227 offset:5216
    ds_read_b64_tr_b16 v[58:59], v227 offset:5856
    s_waitcnt lgkmcnt(6)
    v_mfma_f32_32x32x16_bf16 v[192:207], v[60:63], v[36:39], v[192:207]
    s_add_u32 s35, s37, 23552
    buffer_load_dwordx4 v[28:31], v13, s[20:23], s35 offen
    v_exp_f32 v215, v215
    v_pk_add_f32 v[208:209], v[208:209], v[224:225]
    v_pk_add_f32 v[210:211], v[210:211], v[224:225]
    ds_read_b64_tr_b16 v[60:61], v227 offset:5248
    ds_read_b64_tr_b16 v[62:63], v227 offset:5888
    s_waitcnt vmcnt(9) lgkmcnt(6)
    v_mfma_f32_32x32x16_bf16 v[144:159], v[48:51], v[40:43], v[144:159]
    v_pk_add_f32 v[212:213], v[212:213], v[224:225]
    v_pk_add_f32 v[214:215], v[214:215], v[224:225]
    v_rcp_f32 v208, v208
    ds_read_b64_tr_b16 v[48:49], v227 offset:7712
    ds_read_b64_tr_b16 v[50:51], v227 offset:8352
    s_waitcnt lgkmcnt(6)
    v_mfma_f32_32x32x16_bf16 v[160:175], v[52:55], v[40:43], v[160:175]
    v_rcp_f32 v209, v209
    v_rcp_f32 v210, v210
    v_rcp_f32 v211, v211
    ds_read_b64_tr_b16 v[52:53], v227 offset:7744
    ds_read_b64_tr_b16 v[54:55], v227 offset:8384
    s_waitcnt lgkmcnt(6)
    v_mfma_f32_32x32x16_bf16 v[176:191], v[56:59], v[40:43], v[176:191]
    v_rcp_f32 v212, v212
    v_rcp_f32 v213, v213
    v_rcp_f32 v214, v214
    ds_read_b64_tr_b16 v[56:57], v227 offset:7776
    ds_read_b64_tr_b16 v[58:59], v227 offset:8416
    s_waitcnt lgkmcnt(6)
    v_mfma_f32_32x32x16_bf16 v[192:207], v[60:63], v[40:43], v[192:207]
    s_add_u32 s35, s37, 24576
    buffer_load_dwordx4 v[32:35], v13, s[20:23], s35 offen
    v_rcp_f32 v215, v215
    v_pk_mul_f32 v[96:97], v[96:97], v[208:209]
    v_pk_mul_f32 v[98:99], v[98:99], v[210:211]
    ds_read_b64_tr_b16 v[60:61], v227 offset:7808
    ds_read_b64_tr_b16 v[62:63], v227 offset:8448
    s_waitcnt vmcnt(8) lgkmcnt(6)
    v_mfma_f32_32x32x16_bf16 v[144:159], v[48:51], v[44:47], v[144:159]
    v_pk_mul_f32 v[100:101], v[100:101], v[212:213]
    v_pk_mul_f32 v[102:103], v[102:103], v[214:215]
    v_cvt_pk_bf16_f32 v208, v96, v97
    s_waitcnt lgkmcnt(4)
    v_mfma_f32_32x32x16_bf16 v[160:175], v[52:55], v[44:47], v[160:175]
    v_cvt_pk_bf16_f32 v209, v98, v99
    v_cvt_pk_bf16_f32 v210, v100, v101
    v_cvt_pk_bf16_f32 v211, v102, v103
    s_waitcnt lgkmcnt(2)
    v_mfma_f32_32x32x16_bf16 v[176:191], v[56:59], v[44:47], v[176:191]
    v_lshlrev_b32 v96, 16, v208
    v_and_b32 v97, 0xffff0000, v208
    v_lshlrev_b32 v98, 16, v209
    s_waitcnt lgkmcnt(0)
    v_mfma_f32_32x32x16_bf16 v[192:207], v[60:63], v[44:47], v[192:207]
    s_add_u32 s35, s37, 25600
    buffer_load_dwordx4 v[36:39], v13, s[20:23], s35 offen
    v_and_b32 v99, 0xffff0000, v209
    v_lshlrev_b32 v100, 16, v210
    v_and_b32 v101, 0xffff0000, v210
    s_waitcnt vmcnt(9)
    s_barrier
    ds_read_b64_tr_b16 v[48:49], v228 offset:32
    ds_read_b64_tr_b16 v[50:51], v228 offset:672
    ds_read_b64_tr_b16 v[52:53], v228 offset:64
    ds_read_b64_tr_b16 v[54:55], v228 offset:704
    ds_read_b64_tr_b16 v[56:57], v228 offset:96
    ds_read_b64_tr_b16 v[58:59], v228 offset:736
    ds_read_b64_tr_b16 v[60:61], v228 offset:128
    ds_read_b64_tr_b16 v[62:63], v228 offset:768
    s_waitcnt vmcnt(7) lgkmcnt(6)
    v_mfma_f32_32x32x16_bf16 v[144:159], v[48:51], v[16:19], v[144:159]
    v_lshlrev_b32 v102, 16, v211
    v_and_b32 v103, 0xffff0000, v211
    v_pk_mul_f32 v[96:97], v[96:97], v[104:105]
    ds_read_b64_tr_b16 v[48:49], v228 offset:2592
    ds_read_b64_tr_b16 v[50:51], v228 offset:3232
    s_waitcnt lgkmcnt(6)
    v_mfma_f32_32x32x16_bf16 v[160:175], v[52:55], v[16:19], v[160:175]
    v_pk_mul_f32 v[98:99], v[98:99], v[106:107]
    v_pk_mul_f32 v[100:101], v[100:101], v[108:109]
    v_pk_mul_f32 v[102:103], v[102:103], v[110:111]
    ds_read_b64_tr_b16 v[52:53], v228 offset:2624
    ds_read_b64_tr_b16 v[54:55], v228 offset:3264
    s_waitcnt lgkmcnt(6)
    v_mfma_f32_32x32x16_bf16 v[176:191], v[56:59], v[16:19], v[176:191]
    v_cvt_pk_bf16_f32 v216, v96, v97
    v_cvt_pk_bf16_f32 v217, v98, v99
    v_cvt_pk_bf16_f32 v218, v100, v101
    ds_read_b64_tr_b16 v[56:57], v228 offset:2656
    ds_read_b64_tr_b16 v[58:59], v228 offset:3296
    s_waitcnt lgkmcnt(6)
    v_mfma_f32_32x32x16_bf16 v[192:207], v[60:63], v[16:19], v[192:207]
    s_add_u32 s35, s37, 26624
    buffer_load_dwordx4 v[40:43], v13, s[20:23], s35 offen
    v_cvt_pk_bf16_f32 v219, v102, v103
    s_add_u32 s41, s38, 2048
    buffer_store_dwordx4 v[216:219], v13, s[20:23], s41 offen
    ds_read_b64_tr_b16 v[60:61], v228 offset:2688
    ds_read_b64_tr_b16 v[62:63], v228 offset:3328
    s_waitcnt vmcnt(8) lgkmcnt(6)
    v_mfma_f32_32x32x16_bf16 v[144:159], v[48:51], v[20:23], v[144:159]
    v_cvt_pk_bf16_f32 v208, v112, v113
    v_cvt_pk_bf16_f32 v209, v114, v115
    v_cvt_pk_bf16_f32 v210, v116, v117
    ds_read_b64_tr_b16 v[48:49], v228 offset:5152
    ds_read_b64_tr_b16 v[50:51], v228 offset:5792
    s_waitcnt lgkmcnt(6)
    v_mfma_f32_32x32x16_bf16 v[160:175], v[52:55], v[20:23], v[160:175]
    v_cvt_pk_bf16_f32 v211, v118, v119
    v_cvt_pk_bf16_f32 v212, v120, v121
    v_cvt_pk_bf16_f32 v213, v122, v123
    ds_read_b64_tr_b16 v[52:53], v228 offset:5184
    ds_read_b64_tr_b16 v[54:55], v228 offset:5824
    s_waitcnt lgkmcnt(6)
    v_mfma_f32_32x32x16_bf16 v[176:191], v[56:59], v[20:23], v[176:191]
    v_cvt_pk_bf16_f32 v214, v124, v125
    v_cvt_pk_bf16_f32 v215, v126, v127
    v_lshlrev_b32 v112, 16, v208
    ds_read_b64_tr_b16 v[56:57], v228 offset:5216
    ds_read_b64_tr_b16 v[58:59], v228 offset:5856
    s_waitcnt lgkmcnt(6)
    v_mfma_f32_32x32x16_bf16 v[192:207], v[60:63], v[20:23], v[192:207]
    s_add_u32 s35, s37, 27648
    buffer_load_dwordx4 v[44:47], v13, s[20:23], s35 offen
    v_and_b32 v113, 0xffff0000, v208
    v_lshlrev_b32 v114, 16, v209
    v_and_b32 v115, 0xffff0000, v209
    ds_read_b64_tr_b16 v[60:61], v228 offset:5248
    ds_read_b64_tr_b16 v[62:63], v228 offset:5888
    s_waitcnt vmcnt(7) lgkmcnt(6)
    v_mfma_f32_32x32x16_bf16 v[144:159], v[48:51], v[24:27], v[144:159]
    v_lshlrev_b32 v116, 16, v210
    v_and_b32 v117, 0xffff0000, v210
    v_lshlrev_b32 v118, 16, v211
    ds_read_b64_tr_b16 v[48:49], v228 offset:7712
    ds_read_b64_tr_b16 v[50:51], v228 offset:8352
    s_waitcnt lgkmcnt(6)
    v_mfma_f32_32x32x16_bf16 v[160:175], v[52:55], v[24:27], v[160:175]
    v_and_b32 v119, 0xffff0000, v211
    v_lshlrev_b32 v120, 16, v212
    v_and_b32 v121, 0xffff0000, v212
    ds_read_b64_tr_b16 v[52:53], v228 offset:7744
    ds_read_b64_tr_b16 v[54:55], v228 offset:8384
    s_waitcnt lgkmcnt(6)
    v_mfma_f32_32x32x16_bf16 v[176:191], v[56:59], v[24:27], v[176:191]
    v_lshlrev_b32 v122, 16, v213
    v_and_b32 v123, 0xffff0000, v213
    v_lshlrev_b32 v124, 16, v214
    ds_read_b64_tr_b16 v[56:57], v228 offset:7776
    ds_read_b64_tr_b16 v[58:59], v228 offset:8416
    s_waitcnt lgkmcnt(6)
    v_mfma_f32_32x32x16_bf16 v[192:207], v[60:63], v[24:27], v[192:207]
    s_add_u32 s35, s37, 28672
    buffer_load_dwordx4 v[16:19], v13, s[20:23], s35 offen
    v_and_b32 v125, 0xffff0000, v214
    v_lshlrev_b32 v126, 16, v215
    v_and_b32 v127, 0xffff0000, v215
    ds_read_b64_tr_b16 v[60:61], v228 offset:7808
    ds_read_b64_tr_b16 v[62:63], v228 offset:8448
    s_waitcnt vmcnt(6) lgkmcnt(6)
    v_mfma_f32_32x32x16_bf16 v[144:159], v[48:51], v[28:31], v[144:159]
    v_pk_mul_f32 v[208:209], v[112:113], v[112:113]
    v_pk_mul_f32 v[210:211], v[114:115], v[114:115]
    v_pk_mul_f32 v[212:213], v[116:117], v[116:117]
    s_waitcnt lgkmcnt(4)
    v_mfma_f32_32x32x16_bf16 v[160:175], v[52:55], v[28:31], v[160:175]
    v_pk_mul_f32 v[214:215], v[118:119], v[118:119]
    v_pk_fma_f32 v[208:209], v[208:209], v[222:223], v[220:221]
    v_pk_fma_f32 v[210:211], v[210:211], v[222:223], v[220:221]
    s_waitcnt lgkmcnt(2)
    v_mfma_f32_32x32x16_bf16 v[176:191], v[56:59], v[28:31], v[176:191]
    v_pk_fma_f32 v[212:213], v[212:213], v[222:223], v[220:221]
    v_pk_fma_f32 v[214:215], v[214:215], v[222:223], v[220:221]
    v_pk_mul_f32 v[208:209], v[208:209], v[112:113]
    s_waitcnt lgkmcnt(0)
    v_mfma_f32_32x32x16_bf16 v[192:207], v[60:63], v[28:31], v[192:207]
    s_add_u32 s35, s37, 29696
    buffer_load_dwordx4 v[20:23], v13, s[20:23], s35 offen
    v_pk_mul_f32 v[210:211], v[210:211], v[114:115]
    v_pk_mul_f32 v[212:213], v[212:213], v[116:117]
    v_pk_mul_f32 v[214:215], v[214:215], v[118:119]
    s_waitcnt vmcnt(7)
    s_barrier
    ds_read_b64_tr_b16 v[48:49], v229 offset:32
    ds_read_b64_tr_b16 v[50:51], v229 offset:672
    ds_read_b64_tr_b16 v[52:53], v229 offset:64
    ds_read_b64_tr_b16 v[54:55], v229 offset:704
    ds_read_b64_tr_b16 v[56:57], v229 offset:96
    ds_read_b64_tr_b16 v[58:59], v229 offset:736
    ds_read_b64_tr_b16 v[60:61], v229 offset:128
    ds_read_b64_tr_b16 v[62:63], v229 offset:768
    s_waitcnt vmcnt(6) lgkmcnt(6)
    v_mfma_f32_32x32x16_bf16 v[144:159], v[48:51], v[32:35], v[144:159]
    v_exp_f32 v208, v208
    v_exp_f32 v209, v209
    v_exp_f32 v210, v210
    ds_read_b64_tr_b16 v[48:49], v229 offset:2592
    ds_read_b64_tr_b16 v[50:51], v229 offset:3232
    s_waitcnt lgkmcnt(6)
    v_mfma_f32_32x32x16_bf16 v[160:175], v[52:55], v[32:35], v[160:175]
    v_exp_f32 v211, v211
    v_exp_f32 v212, v212
    v_exp_f32 v213, v213
    ds_read_b64_tr_b16 v[52:53], v229 offset:2624
    ds_read_b64_tr_b16 v[54:55], v229 offset:3264
    s_waitcnt lgkmcnt(6)
    v_mfma_f32_32x32x16_bf16 v[176:191], v[56:59], v[32:35], v[176:191]
    v_exp_f32 v214, v214
    v_exp_f32 v215, v215
    v_pk_add_f32 v[208:209], v[208:209], v[224:225]
    ds_read_b64_tr_b16 v[56:57], v229 offset:2656
    ds_read_b64_tr_b16 v[58:59], v229 offset:3296
    s_waitcnt lgkmcnt(6)
    v_mfma_f32_32x32x16_bf16 v[192:207], v[60:63], v[32:35], v[192:207]
    s_add_u32 s35, s37, 30720
    buffer_load_dwordx4 v[24:27], v13, s[20:23], s35 offen
    v_pk_add_f32 v[210:211], v[210:211], v[224:225]
    v_pk_add_f32 v[212:213], v[212:213], v[224:225]
    v_pk_add_f32 v[214:215], v[214:215], v[224:225]
    ds_read_b64_tr_b16 v[60:61], v229 offset:2688
    ds_read_b64_tr_b16 v[62:63], v229 offset:3328
    s_waitcnt vmcnt(6) lgkmcnt(6)
    v_mfma_f32_32x32x16_bf16 v[144:159], v[48:51], v[36:39], v[144:159]
    v_rcp_f32 v208, v208
    v_rcp_f32 v209, v209
    v_rcp_f32 v210, v210
    ds_read_b64_tr_b16 v[48:49], v229 offset:5152
    ds_read_b64_tr_b16 v[50:51], v229 offset:5792
    s_waitcnt lgkmcnt(6)
    v_mfma_f32_32x32x16_bf16 v[160:175], v[52:55], v[36:39], v[160:175]
    v_rcp_f32 v211, v211
    v_rcp_f32 v212, v212
    v_rcp_f32 v213, v213
    ds_read_b64_tr_b16 v[52:53], v229 offset:5184
    ds_read_b64_tr_b16 v[54:55], v229 offset:5824
    s_waitcnt lgkmcnt(6)
    v_mfma_f32_32x32x16_bf16 v[176:191], v[56:59], v[36:39], v[176:191]
    v_rcp_f32 v214, v214
    v_rcp_f32 v215, v215
    v_pk_mul_f32 v[112:113], v[112:113], v[208:209]
    ds_read_b64_tr_b16 v[56:57], v229 offset:5216
    ds_read_b64_tr_b16 v[58:59], v229 offset:5856
    s_waitcnt lgkmcnt(6)
    v_mfma_f32_32x32x16_bf16 v[192:207], v[60:63], v[36:39], v[192:207]
    s_add_u32 s35, s37, 31744
    buffer_load_dwordx4 v[28:31], v13, s[20:23], s35 offen
    v_pk_mul_f32 v[114:115], v[114:115], v[210:211]
    v_pk_mul_f32 v[116:117], v[116:117], v[212:213]
    v_pk_mul_f32 v[118:119], v[118:119], v[214:215]
    ds_read_b64_tr_b16 v[60:61], v229 offset:5248
    ds_read_b64_tr_b16 v[62:63], v229 offset:5888
    s_waitcnt vmcnt(6) lgkmcnt(6)
    v_mfma_f32_32x32x16_bf16 v[144:159], v[48:51], v[40:43], v[144:159]
    v_cvt_pk_bf16_f32 v208, v112, v113
    v_cvt_pk_bf16_f32 v209, v114, v115
    v_cvt_pk_bf16_f32 v210, v116, v117
    ds_read_b64_tr_b16 v[48:49], v229 offset:7712
    ds_read_b64_tr_b16 v[50:51], v229 offset:8352
    s_waitcnt lgkmcnt(6)
    v_mfma_f32_32x32x16_bf16 v[160:175], v[52:55], v[40:43], v[160:175]
    v_cvt_pk_bf16_f32 v211, v118, v119
    v_lshlrev_b32 v112, 16, v208
    v_and_b32 v113, 0xffff0000, v208
    ds_read_b64_tr_b16 v[52:53], v229 offset:7744
    ds_read_b64_tr_b16 v[54:55], v229 offset:8384
    s_waitcnt lgkmcnt(6)
    v_mfma_f32_32x32x16_bf16 v[176:191], v[56:59], v[40:43], v[176:191]
    v_lshlrev_b32 v114, 16, v209
    v_and_b32 v115, 0xffff0000, v209
    v_lshlrev_b32 v116, 16, v210
    ds_read_b64_tr_b16 v[56:57], v229 offset:7776
    ds_read_b64_tr_b16 v[58:59], v229 offset:8416
    s_waitcnt lgkmcnt(6)
    v_mfma_f32_32x32x16_bf16 v[192:207], v[60:63], v[40:43], v[192:207]
    s_add_u32 s35, s37, 32768
    buffer_load_dwordx4 v[32:35], v13, s[20:23], s35 offen
    v_and_b32 v117, 0xffff0000, v210
    v_lshlrev_b32 v118, 16, v211
    v_and_b32 v119, 0xffff0000, v211
    ds_read_b64_tr_b16 v[60:61], v229 offset:7808
    ds_read_b64_tr_b16 v[62:63], v229 offset:8448
    s_waitcnt vmcnt(5) lgkmcnt(6)
    v_mfma_f32_32x32x16_bf16 v[144:159], v[48:51], v[44:47], v[144:159]
    v_pk_mul_f32 v[112:113], v[112:113], v[120:121]
    v_pk_mul_f32 v[114:115], v[114:115], v[122:123]
    v_pk_mul_f32 v[116:117], v[116:117], v[124:125]
    s_waitcnt lgkmcnt(4)
    v_mfma_f32_32x32x16_bf16 v[160:175], v[52:55], v[44:47], v[160:175]
    v_pk_mul_f32 v[118:119], v[118:119], v[126:127]
    v_cvt_pk_bf16_f32 v216, v112, v113
    v_cvt_pk_bf16_f32 v217, v114, v115
    s_waitcnt lgkmcnt(2)
    v_mfma_f32_32x32x16_bf16 v[176:191], v[56:59], v[44:47], v[176:191]
    v_cvt_pk_bf16_f32 v218, v116, v117
    v_cvt_pk_bf16_f32 v219, v118, v119
    s_add_u32 s41, s38, 3072
    s_waitcnt lgkmcnt(0)
    v_mfma_f32_32x32x16_bf16 v[192:207], v[60:63], v[44:47], v[192:207]
    s_add_u32 s35, s37, 33792
    buffer_load_dwordx4 v[36:39], v13, s[20:23], s35 offen
    buffer_store_dwordx4 v[216:219], v13, s[20:23], s41 offen
    v_cvt_pk_bf16_f32 v208, v128, v129
    v_cvt_pk_bf16_f32 v209, v130, v131
    s_waitcnt vmcnt(7)
    s_barrier
    ds_read_b64_tr_b16 v[48:49], v230 offset:32
    ds_read_b64_tr_b16 v[50:51], v230 offset:672
    ds_read_b64_tr_b16 v[52:53], v230 offset:64
    ds_read_b64_tr_b16 v[54:55], v230 offset:704
    ds_read_b64_tr_b16 v[56:57], v230 offset:96
    ds_read_b64_tr_b16 v[58:59], v230 offset:736
    ds_read_b64_tr_b16 v[60:61], v230 offset:128
    ds_read_b64_tr_b16 v[62:63], v230 offset:768
    s_waitcnt vmcnt(6) lgkmcnt(6)
    v_mfma_f32_32x32x16_bf16 v[144:159], v[48:51], v[16:19], v[144:159]
    v_cvt_pk_bf16_f32 v210, v132, v133
    v_cvt_pk_bf16_f32 v211, v134, v135
    v_cvt_pk_bf16_f32 v212, v136, v137
    ds_read_b64_tr_b16 v[48:49], v230 offset:2592
    ds_read_b64_tr_b16 v[50:51], v230 offset:3232
    s_waitcnt lgkmcnt(6)
    v_mfma_f32_32x32x16_bf16 v[160:175], v[52:55], v[16:19], v[160:175]
    v_cvt_pk_bf16_f32 v213, v138, v139
    v_cvt_pk_bf16_f32 v214, v140, v141
    v_cvt_pk_bf16_f32 v215, v142, v143
    ds_read_b64_tr_b16 v[52:53], v230 offset:2624
    ds_read_b64_tr_b16 v[54:55], v230 offset:3264
    s_waitcnt lgkmcnt(6)
    v_mfma_f32_32x32x16_bf16 v[176:191], v[56:59], v[16:19], v[176:191]
    v_lshlrev_b32 v128, 16, v208
    v_and_b32 v129, 0xffff0000, v208
    v_lshlrev_b32 v130, 16, v209
    ds_read_b64_tr_b16 v[56:57], v230 offset:2656
    ds_read_b64_tr_b16 v[58:59], v230 offset:3296
    s_waitcnt lgkmcnt(6)
    v_mfma_f32_32x32x16_bf16 v[192:207], v[60:63], v[16:19], v[192:207]
    s_add_u32 s35, s37, 34816
    buffer_load_dwordx4 v[40:43], v13, s[20:23], s35 offen
    v_and_b32 v131, 0xffff0000, v209
    v_lshlrev_b32 v132, 16, v210
    v_and_b32 v133, 0xffff0000, v210
    ds_read_b64_tr_b16 v[60:61], v230 offset:2688
    ds_read_b64_tr_b16 v[62:63], v230 offset:3328
    s_waitcnt vmcnt(6) lgkmcnt(6)
    v_mfma_f32_32x32x16_bf16 v[144:159], v[48:51], v[20:23], v[144:159]
    v_lshlrev_b32 v134, 16, v211
    v_and_b32 v135, 0xffff0000, v211
    v_lshlrev_b32 v136, 16, v212
    ds_read_b64_tr_b16 v[48:49], v230 offset:5152
    ds_read_b64_tr_b16 v[50:51], v230 offset:5792
    s_waitcnt lgkmcnt(6)
    v_mfma_f32_32x32x16_bf16 v[160:175], v[52:55], v[20:23], v[160:175]
    v_and_b32 v137, 0xffff0000, v212
    v_lshlrev_b32 v138, 16, v213
    v_and_b32 v139, 0xffff0000, v213
    ds_read_b64_tr_b16 v[52:53], v230 offset:5184
    ds_read_b64_tr_b16 v[54:55], v230 offset:5824
    s_waitcnt lgkmcnt(6)
    v_mfma_f32_32x32x16_bf16 v[176:191], v[56:59], v[20:23], v[176:191]
    v_lshlrev_b32 v140, 16, v214
    v_and_b32 v141, 0xffff0000, v214
    v_lshlrev_b32 v142, 16, v215
    ds_read_b64_tr_b16 v[56:57], v230 offset:5216
    ds_read_b64_tr_b16 v[58:59], v230 offset:5856
    s_waitcnt lgkmcnt(6)
    v_mfma_f32_32x32x16_bf16 v[192:207], v[60:63], v[20:23], v[192:207]
    s_add_u32 s35, s37, 35840
    buffer_load_dwordx4 v[44:47], v13, s[20:23], s35 offen
    v_and_b32 v143, 0xffff0000, v215
    v_pk_mul_f32 v[208:209], v[128:129], v[128:129]
    v_pk_mul_f32 v[210:211], v[130:131], v[130:131]
    ds_read_b64_tr_b16 v[60:61], v230 offset:5248
    ds_read_b64_tr_b16 v[62:63], v230 offset:5888
    s_waitcnt vmcnt(6) lgkmcnt(6)
    v_mfma_f32_32x32x16_bf16 v[144:159], v[48:51], v[24:27], v[144:159]
    v_pk_mul_f32 v[212:213], v[132:133], v[132:133]
    v_pk_mul_f32 v[214:215], v[134:135], v[134:135]
    v_pk_fma_f32 v[208:209], v[208:209], v[222:223], v[220:221]
    ds_read_b64_tr_b16 v[48:49], v230 offset:7712
    ds_read_b64_tr_b16 v[50:51], v230 offset:8352
    s_waitcnt lgkmcnt(6)
    v_mfma_f32_32x32x16_bf16 v[160:175], v[52:55], v[24:27], v[160:175]
    v_pk_fma_f32 v[210:211], v[210:211], v[222:223], v[220:221]
    v_pk_fma_f32 v[212:213], v[212:213], v[222:223], v[220:221]
    v_pk_fma_f32 v[214:215], v[214:215], v[222:223], v[220:221]
    ds_read_b64_tr_b16 v[52:53], v230 offset:7744
    ds_read_b64_tr_b16 v[54:55], v230 offset:8384
    s_waitcnt lgkmcnt(6)
    v_mfma_f32_32x32x16_bf16 v[176:191], v[56:59], v[24:27], v[176:191]
    v_pk_mul_f32 v[208:209], v[208:209], v[128:129]
    v_pk_mul_f32 v[210:211], v[210:211], v[130:131]
    v_pk_mul_f32 v[212:213], v[212:213], v[132:133]
    ds_read_b64_tr_b16 v[56:57], v230 offset:7776
    ds_read_b64_tr_b16 v[58:59], v230 offset:8416
    s_waitcnt lgkmcnt(6)
    v_mfma_f32_32x32x16_bf16 v[192:207], v[60:63], v[24:27], v[192:207]
    v_pk_mul_f32 v[214:215], v[214:215], v[134:135]
    v_exp_f32 v208, v208
    v_exp_f32 v209, v209
    ds_read_b64_tr_b16 v[60:61], v230 offset:7808
    ds_read_b64_tr_b16 v[62:63], v230 offset:8448
    s_waitcnt vmcnt(5) lgkmcnt(6)
    v_mfma_f32_32x32x16_bf16 v[144:159], v[48:51], v[28:31], v[144:159]
    v_exp_f32 v210, v210
    v_exp_f32 v211, v211
    v_exp_f32 v212, v212
    s_waitcnt lgkmcnt(4)
    v_mfma_f32_32x32x16_bf16 v[160:175], v[52:55], v[28:31], v[160:175]
    v_exp_f32 v213, v213
    v_exp_f32 v214, v214
    v_exp_f32 v215, v215
    s_waitcnt lgkmcnt(2)
    v_mfma_f32_32x32x16_bf16 v[176:191], v[56:59], v[28:31], v[176:191]
    v_pk_add_f32 v[208:209], v[208:209], v[224:225]
    v_pk_add_f32 v[210:211], v[210:211], v[224:225]
    v_pk_add_f32 v[212:213], v[212:213], v[224:225]
    s_waitcnt lgkmcnt(0)
    v_mfma_f32_32x32x16_bf16 v[192:207], v[60:63], v[28:31], v[192:207]
    v_pk_add_f32 v[214:215], v[214:215], v[224:225]
    v_rcp_f32 v208, v208
    v_rcp_f32 v209, v209
    s_waitcnt vmcnt(5)
    s_barrier
    ds_read_b64_tr_b16 v[48:49], v231 offset:32
    ds_read_b64_tr_b16 v[50:51], v231 offset:672
    ds_read_b64_tr_b16 v[52:53], v231 offset:64
    ds_read_b64_tr_b16 v[54:55], v231 offset:704
    ds_read_b64_tr_b16 v[56:57], v231 offset:96
    ds_read_b64_tr_b16 v[58:59], v231 offset:736
    ds_read_b64_tr_b16 v[60:61], v231 offset:128
    ds_read_b64_tr_b16 v[62:63], v231 offset:768
    s_waitcnt vmcnt(4) lgkmcnt(6)
    v_mfma_f32_32x32x16_bf16 v[144:159], v[48:51], v[32:35], v[144:159]
    v_rcp_f32 v210, v210
    v_rcp_f32 v211, v211
    v_rcp_f32 v212, v212
    ds_read_b64_tr_b16 v[48:49], v231 offset:2592
    ds_read_b64_tr_b16 v[50:51], v231 offset:3232
    s_waitcnt lgkmcnt(6)
    v_mfma_f32_32x32x16_bf16 v[160:175], v[52:55], v[32:35], v[160:175]
    v_rcp_f32 v213, v213
    v_rcp_f32 v214, v214
    v_rcp_f32 v215, v215
    ds_read_b64_tr_b16 v[52:53], v231 offset:2624
    ds_read_b64_tr_b16 v[54:55], v231 offset:3264
    s_waitcnt lgkmcnt(6)
    v_mfma_f32_32x32x16_bf16 v[176:191], v[56:59], v[32:35], v[176:191]
    v_pk_mul_f32 v[128:129], v[128:129], v[208:209]
    v_pk_mul_f32 v[130:131], v[130:131], v[210:211]
    v_pk_mul_f32 v[132:133], v[132:133], v[212:213]
    ds_read_b64_tr_b16 v[56:57], v231 offset:2656
    ds_read_b64_tr_b16 v[58:59], v231 offset:3296
    s_waitcnt lgkmcnt(6)
    v_mfma_f32_32x32x16_bf16 v[192:207], v[60:63], v[32:35], v[192:207]
    v_pk_mul_f32 v[134:135], v[134:135], v[214:215]
    v_cvt_pk_bf16_f32 v208, v128, v129
    v_cvt_pk_bf16_f32 v209, v130, v131
    ds_read_b64_tr_b16 v[60:61], v231 offset:2688
    ds_read_b64_tr_b16 v[62:63], v231 offset:3328
    s_waitcnt vmcnt(3) lgkmcnt(6)
    v_mfma_f32_32x32x16_bf16 v[144:159], v[48:51], v[36:39], v[144:159]
    v_cvt_pk_bf16_f32 v210, v132, v133
    v_cvt_pk_bf16_f32 v211, v134, v135
    v_lshlrev_b32 v128, 16, v208
    ds_read_b64_tr_b16 v[48:49], v231 offset:5152
    ds_read_b64_tr_b16 v[50:51], v231 offset:5792
    s_waitcnt lgkmcnt(6)
    v_mfma_f32_32x32x16_bf16 v[160:175], v[52:55], v[36:39], v[160:175]
    v_and_b32 v129, 0xffff0000, v208
    v_lshlrev_b32 v130, 16, v209
    v_and_b32 v131, 0xffff0000, v209
    ds_read_b64_tr_b16 v[52:53], v231 offset:5184
    ds_read_b64_tr_b16 v[54:55], v231 offset:5824
    s_waitcnt lgkmcnt(6)
    v_mfma_f32_32x32x16_bf16 v[176:191], v[56:59], v[36:39], v[176:191]
    v_lshlrev_b32 v132, 16, v210
    v_and_b32 v133, 0xffff0000, v210
    v_lshlrev_b32 v134, 16, v211
    ds_read_b64_tr_b16 v[56:57], v231 offset:5216
    ds_read_b64_tr_b16 v[58:59], v231 offset:5856
    s_waitcnt lgkmcnt(6)
    v_mfma_f32_32x32x16_bf16 v[192:207], v[60:63], v[36:39], v[192:207]
    v_and_b32 v135, 0xffff0000, v211
    v_pk_mul_f32 v[128:129], v[128:129], v[136:137]
    v_pk_mul_f32 v[130:131], v[130:131], v[138:139]
    ds_read_b64_tr_b16 v[60:61], v231 offset:5248
    ds_read_b64_tr_b16 v[62:63], v231 offset:5888
    s_waitcnt vmcnt(1) lgkmcnt(6)
    v_mfma_f32_32x32x16_bf16 v[144:159], v[48:51], v[40:43], v[144:159]
    v_pk_mul_f32 v[132:133], v[132:133], v[140:141]
    v_pk_mul_f32 v[134:135], v[134:135], v[142:143]
    v_cvt_pk_bf16_f32 v216, v128, v129
    ds_read_b64_tr_b16 v[48:49], v231 offset:7712
    ds_read_b64_tr_b16 v[50:51], v231 offset:8352
    s_waitcnt lgkmcnt(6)
    v_mfma_f32_32x32x16_bf16 v[160:175], v[52:55], v[40:43], v[160:175]
    v_cvt_pk_bf16_f32 v217, v130, v131
    v_cvt_pk_bf16_f32 v218, v132, v133
    v_cvt_pk_bf16_f32 v219, v134, v135
    ds_read_b64_tr_b16 v[52:53], v231 offset:7744
    ds_read_b64_tr_b16 v[54:55], v231 offset:8384
    s_waitcnt lgkmcnt(6)
    v_mfma_f32_32x32x16_bf16 v[176:191], v[56:59], v[40:43], v[176:191]
    s_add_u32 s41, s38, 4096
    buffer_store_dwordx4 v[216:219], v13, s[20:23], s41 offen
    ds_read_b64_tr_b16 v[56:57], v231 offset:7776
    ds_read_b64_tr_b16 v[58:59], v231 offset:8416
    s_waitcnt lgkmcnt(6)
    v_mfma_f32_32x32x16_bf16 v[192:207], v[60:63], v[40:43], v[192:207]
    ds_read_b64_tr_b16 v[60:61], v231 offset:7808
    ds_read_b64_tr_b16 v[62:63], v231 offset:8448
    s_waitcnt vmcnt(1) lgkmcnt(6)
    v_mfma_f32_32x32x16_bf16 v[144:159], v[48:51], v[44:47], v[144:159]
    s_waitcnt lgkmcnt(4)
    v_mfma_f32_32x32x16_bf16 v[160:175], v[52:55], v[44:47], v[160:175]
    s_waitcnt lgkmcnt(2)
    v_mfma_f32_32x32x16_bf16 v[176:191], v[56:59], v[44:47], v[176:191]
    s_waitcnt lgkmcnt(0)
    v_mfma_f32_32x32x16_bf16 v[192:207], v[60:63], v[44:47], v[192:207]
    s_lshl_b32 s54, s2, 3
    s_add_u32 s54, s54, s26
    s_mul_i32 s54, s54, 2592
    buffer_load_dwordx4 v[232:235], v13, s[56:59], s54 offen
    buffer_load_dwordx4 v[236:239], v13, s[56:59], s54 offen offset:1024
    buffer_load_dwordx4 v[240:243], v13, s[56:59], s54 offen offset:1568
    v_cvt_pk_bf16_f32 v208, v144, v145
    v_cvt_pk_bf16_f32 v209, v146, v147
    v_cvt_pk_bf16_f32 v210, v148, v149
    v_cvt_pk_bf16_f32 v211, v150, v151
    v_cvt_pk_bf16_f32 v212, v152, v153
    v_cvt_pk_bf16_f32 v213, v154, v155
    v_cvt_pk_bf16_f32 v214, v156, v157
    v_cvt_pk_bf16_f32 v215, v158, v159
    v_lshlrev_b32 v144, 16, v208
    v_and_b32 v145, 0xffff0000, v208
    v_lshlrev_b32 v146, 16, v209
    v_and_b32 v147, 0xffff0000, v209
    v_lshlrev_b32 v148, 16, v210
    v_and_b32 v149, 0xffff0000, v210
    v_lshlrev_b32 v150, 16, v211
    v_and_b32 v151, 0xffff0000, v211
    v_lshlrev_b32 v152, 16, v212
    v_and_b32 v153, 0xffff0000, v212
    v_lshlrev_b32 v154, 16, v213
    v_and_b32 v155, 0xffff0000, v213
    v_lshlrev_b32 v156, 16, v214
    v_and_b32 v157, 0xffff0000, v214
    v_lshlrev_b32 v158, 16, v215
    v_and_b32 v159, 0xffff0000, v215
    v_pk_mul_f32 v[208:209], v[144:145], v[144:145]
    v_pk_mul_f32 v[210:211], v[146:147], v[146:147]
    v_pk_mul_f32 v[212:213], v[148:149], v[148:149]
    v_pk_mul_f32 v[214:215], v[150:151], v[150:151]
    v_pk_fma_f32 v[208:209], v[208:209], v[222:223], v[220:221]
    v_pk_fma_f32 v[210:211], v[210:211], v[222:223], v[220:221]
    v_pk_fma_f32 v[212:213], v[212:213], v[222:223], v[220:221]
    v_pk_fma_f32 v[214:215], v[214:215], v[222:223], v[220:221]
    v_pk_mul_f32 v[208:209], v[208:209], v[144:145]
    v_pk_mul_f32 v[210:211], v[210:211], v[146:147]
    v_pk_mul_f32 v[212:213], v[212:213], v[148:149]
    v_pk_mul_f32 v[214:215], v[214:215], v[150:151]
    v_exp_f32 v208, v208
    v_exp_f32 v209, v209
    v_exp_f32 v210, v210
    v_exp_f32 v211, v211
    v_exp_f32 v212, v212
    v_exp_f32 v213, v213
    v_exp_f32 v214, v214
    v_exp_f32 v215, v215
    v_pk_add_f32 v[208:209], v[208:209], v[224:225]
    v_pk_add_f32 v[210:211], v[210:211], v[224:225]
    v_pk_add_f32 v[212:213], v[212:213], v[224:225]
    v_pk_add_f32 v[214:215], v[214:215], v[224:225]
    v_rcp_f32 v208, v208
    v_rcp_f32 v209, v209
    v_rcp_f32 v210, v210
    v_rcp_f32 v211, v211
    v_rcp_f32 v212, v212
    v_rcp_f32 v213, v213
    v_rcp_f32 v214, v214
    v_rcp_f32 v215, v215
    v_pk_mul_f32 v[144:145], v[144:145], v[208:209]
    v_pk_mul_f32 v[146:147], v[146:147], v[210:211]
    v_pk_mul_f32 v[148:149], v[148:149], v[212:213]
    v_pk_mul_f32 v[150:151], v[150:151], v[214:215]
    v_cvt_pk_bf16_f32 v208, v144, v145
    v_cvt_pk_bf16_f32 v209, v146, v147
    v_cvt_pk_bf16_f32 v210, v148, v149
    v_cvt_pk_bf16_f32 v211, v150, v151
    v_lshlrev_b32 v144, 16, v208
    v_and_b32 v145, 0xffff0000, v208
    v_lshlrev_b32 v146, 16, v209
    v_and_b32 v147, 0xffff0000, v209
    v_lshlrev_b32 v148, 16, v210
    v_and_b32 v149, 0xffff0000, v210
    v_lshlrev_b32 v150, 16, v211
    v_and_b32 v151, 0xffff0000, v211
    v_pk_mul_f32 v[144:145], v[144:145], v[152:153]
    v_pk_mul_f32 v[146:147], v[146:147], v[154:155]
    v_pk_mul_f32 v[148:149], v[148:149], v[156:157]
    v_pk_mul_f32 v[150:151], v[150:151], v[158:159]
    v_cvt_pk_bf16_f32 v216, v144, v145
    v_cvt_pk_bf16_f32 v217, v146, v147
    v_cvt_pk_bf16_f32 v218, v148, v149
    v_cvt_pk_bf16_f32 v219, v150, v151
    s_add_u32 s41, s38, 5120
    buffer_store_dwordx4 v[216:219], v13, s[20:23], s41 offen
    v_cvt_pk_bf16_f32 v208, v160, v161
    v_cvt_pk_bf16_f32 v209, v162, v163
    v_cvt_pk_bf16_f32 v210, v164, v165
    v_cvt_pk_bf16_f32 v211, v166, v167
    v_cvt_pk_bf16_f32 v212, v168, v169
    v_cvt_pk_bf16_f32 v213, v170, v171
    v_cvt_pk_bf16_f32 v214, v172, v173
    v_cvt_pk_bf16_f32 v215, v174, v175
    v_lshlrev_b32 v160, 16, v208
    v_and_b32 v161, 0xffff0000, v208
    v_lshlrev_b32 v162, 16, v209
    v_and_b32 v163, 0xffff0000, v209
    v_lshlrev_b32 v164, 16, v210
    v_and_b32 v165, 0xffff0000, v210
    v_lshlrev_b32 v166, 16, v211
    v_and_b32 v167, 0xffff0000, v211
    v_lshlrev_b32 v168, 16, v212
    v_and_b32 v169, 0xffff0000, v212
    v_lshlrev_b32 v170, 16, v213
    v_and_b32 v171, 0xffff0000, v213
    v_lshlrev_b32 v172, 16, v214
    v_and_b32 v173, 0xffff0000, v214
    v_lshlrev_b32 v174, 16, v215
    v_and_b32 v175, 0xffff0000, v215
    v_pk_mul_f32 v[208:209], v[160:161], v[160:161]
    v_pk_mul_f32 v[210:211], v[162:163], v[162:163]
    v_pk_mul_f32 v[212:213], v[164:165], v[164:165]
    v_pk_mul_f32 v[214:215], v[166:167], v[166:167]
    v_pk_fma_f32 v[208:209], v[208:209], v[222:223], v[220:221]
    v_pk_fma_f32 v[210:211], v[210:211], v[222:223], v[220:221]
    v_pk_fma_f32 v[212:213], v[212:213], v[222:223], v[220:221]
    v_pk_fma_f32 v[214:215], v[214:215], v[222:223], v[220:221]
    v_pk_mul_f32 v[208:209], v[208:209], v[160:161]
    v_pk_mul_f32 v[210:211], v[210:211], v[162:163]
    v_pk_mul_f32 v[212:213], v[212:213], v[164:165]
    v_pk_mul_f32 v[214:215], v[214:215], v[166:167]
    v_exp_f32 v208, v208
    v_exp_f32 v209, v209
    v_exp_f32 v210, v210
    v_exp_f32 v211, v211
    v_exp_f32 v212, v212
    v_exp_f32 v213, v213
    v_exp_f32 v214, v214
    v_exp_f32 v215, v215
    v_pk_add_f32 v[208:209], v[208:209], v[224:225]
    v_pk_add_f32 v[210:211], v[210:211], v[224:225]
    v_pk_add_f32 v[212:213], v[212:213], v[224:225]
    v_pk_add_f32 v[214:215], v[214:215], v[224:225]
    v_rcp_f32 v208, v208
    v_rcp_f32 v209, v209
    v_rcp_f32 v210, v210
    v_rcp_f32 v211, v211
    v_rcp_f32 v212, v212
    v_rcp_f32 v213, v213
    v_rcp_f32 v214, v214
    v_rcp_f32 v215, v215
    v_pk_mul_f32 v[160:161], v[160:161], v[208:209]
    v_pk_mul_f32 v[162:163], v[162:163], v[210:211]
    v_pk_mul_f32 v[164:165], v[164:165], v[212:213]
    v_pk_mul_f32 v[166:167], v[166:167], v[214:215]
    v_cvt_pk_bf16_f32 v208, v160, v161
    v_cvt_pk_bf16_f32 v209, v162, v163
    v_cvt_pk_bf16_f32 v210, v164, v165
    v_cvt_pk_bf16_f32 v211, v166, v167
    v_lshlrev_b32 v160, 16, v208
    v_and_b32 v161, 0xffff0000, v208
    v_lshlrev_b32 v162, 16, v209
    v_and_b32 v163, 0xffff0000, v209
    v_lshlrev_b32 v164, 16, v210
    v_and_b32 v165, 0xffff0000, v210
    v_lshlrev_b32 v166, 16, v211
    v_and_b32 v167, 0xffff0000, v211
    v_pk_mul_f32 v[160:161], v[160:161], v[168:169]
    v_pk_mul_f32 v[162:163], v[162:163], v[170:171]
    v_pk_mul_f32 v[164:165], v[164:165], v[172:173]
    v_pk_mul_f32 v[166:167], v[166:167], v[174:175]
    v_cvt_pk_bf16_f32 v216, v160, v161
    v_cvt_pk_bf16_f32 v217, v162, v163
    v_cvt_pk_bf16_f32 v218, v164, v165
    v_cvt_pk_bf16_f32 v219, v166, v167
    s_add_u32 s41, s38, 6144
    buffer_store_dwordx4 v[216:219], v13, s[20:23], s41 offen
    v_cvt_pk_bf16_f32 v208, v176, v177
    v_cvt_pk_bf16_f32 v209, v178, v179
    v_cvt_pk_bf16_f32 v210, v180, v181
    v_cvt_pk_bf16_f32 v211, v182, v183
    v_cvt_pk_bf16_f32 v212, v184, v185
    v_cvt_pk_bf16_f32 v213, v186, v187
    v_cvt_pk_bf16_f32 v214, v188, v189
    v_cvt_pk_bf16_f32 v215, v190, v191
    v_lshlrev_b32 v176, 16, v208
    v_and_b32 v177, 0xffff0000, v208
    v_lshlrev_b32 v178, 16, v209
    v_and_b32 v179, 0xffff0000, v209
    v_lshlrev_b32 v180, 16, v210
    v_and_b32 v181, 0xffff0000, v210
    v_lshlrev_b32 v182, 16, v211
    v_and_b32 v183, 0xffff0000, v211
    v_lshlrev_b32 v184, 16, v212
    v_and_b32 v185, 0xffff0000, v212
    v_lshlrev_b32 v186, 16, v213
    v_and_b32 v187, 0xffff0000, v213
    v_lshlrev_b32 v188, 16, v214
    v_and_b32 v189, 0xffff0000, v214
    v_lshlrev_b32 v190, 16, v215
    v_and_b32 v191, 0xffff0000, v215
    v_pk_mul_f32 v[208:209], v[176:177], v[176:177]
    v_pk_mul_f32 v[210:211], v[178:179], v[178:179]
    v_pk_mul_f32 v[212:213], v[180:181], v[180:181]
    v_pk_mul_f32 v[214:215], v[182:183], v[182:183]
    v_pk_fma_f32 v[208:209], v[208:209], v[222:223], v[220:221]
    v_pk_fma_f32 v[210:211], v[210:211], v[222:223], v[220:221]
    v_pk_fma_f32 v[212:213], v[212:213], v[222:223], v[220:221]
    v_pk_fma_f32 v[214:215], v[214:215], v[222:223], v[220:221]
    v_pk_mul_f32 v[208:209], v[208:209], v[176:177]
    v_pk_mul_f32 v[210:211], v[210:211], v[178:179]
    v_pk_mul_f32 v[212:213], v[212:213], v[180:181]
    v_pk_mul_f32 v[214:215], v[214:215], v[182:183]
    v_exp_f32 v208, v208
    v_exp_f32 v209, v209
    v_exp_f32 v210, v210
    v_exp_f32 v211, v211
    v_exp_f32 v212, v212
    v_exp_f32 v213, v213
    v_exp_f32 v214, v214
    v_exp_f32 v215, v215
    v_pk_add_f32 v[208:209], v[208:209], v[224:225]
    v_pk_add_f32 v[210:211], v[210:211], v[224:225]
    v_pk_add_f32 v[212:213], v[212:213], v[224:225]
    v_pk_add_f32 v[214:215], v[214:215], v[224:225]
    v_rcp_f32 v208, v208
    v_rcp_f32 v209, v209
    v_rcp_f32 v210, v210
    v_rcp_f32 v211, v211
    v_rcp_f32 v212, v212
    v_rcp_f32 v213, v213
    v_rcp_f32 v214, v214
    v_rcp_f32 v215, v215
    v_pk_mul_f32 v[176:177], v[176:177], v[208:209]
    v_pk_mul_f32 v[178:179], v[178:179], v[210:211]
    v_pk_mul_f32 v[180:181], v[180:181], v[212:213]
    v_pk_mul_f32 v[182:183], v[182:183], v[214:215]
    v_cvt_pk_bf16_f32 v208, v176, v177
    v_cvt_pk_bf16_f32 v209, v178, v179
    v_cvt_pk_bf16_f32 v210, v180, v181
    v_cvt_pk_bf16_f32 v211, v182, v183
    v_lshlrev_b32 v176, 16, v208
    v_and_b32 v177, 0xffff0000, v208
    v_lshlrev_b32 v178, 16, v209
    v_and_b32 v179, 0xffff0000, v209
    v_lshlrev_b32 v180, 16, v210
    v_and_b32 v181, 0xffff0000, v210
    v_lshlrev_b32 v182, 16, v211
    v_and_b32 v183, 0xffff0000, v211
    v_pk_mul_f32 v[176:177], v[176:177], v[184:185]
    v_pk_mul_f32 v[178:179], v[178:179], v[186:187]
    v_pk_mul_f32 v[180:181], v[180:181], v[188:189]
    v_pk_mul_f32 v[182:183], v[182:183], v[190:191]
    v_cvt_pk_bf16_f32 v216, v176, v177
    v_cvt_pk_bf16_f32 v217, v178, v179
    v_cvt_pk_bf16_f32 v218, v180, v181
    v_cvt_pk_bf16_f32 v219, v182, v183
    s_add_u32 s41, s38, 7168
    buffer_store_dwordx4 v[216:219], v13, s[20:23], s41 offen
    v_cvt_pk_bf16_f32 v208, v192, v193
    v_cvt_pk_bf16_f32 v209, v194, v195
    v_cvt_pk_bf16_f32 v210, v196, v197
    v_cvt_pk_bf16_f32 v211, v198, v199
    v_cvt_pk_bf16_f32 v212, v200, v201
    v_cvt_pk_bf16_f32 v213, v202, v203
    v_cvt_pk_bf16_f32 v214, v204, v205
    v_cvt_pk_bf16_f32 v215, v206, v207
    v_lshlrev_b32 v192, 16, v208
    v_and_b32 v193, 0xffff0000, v208
    v_lshlrev_b32 v194, 16, v209
    v_and_b32 v195, 0xffff0000, v209
    v_lshlrev_b32 v196, 16, v210
    v_and_b32 v197, 0xffff0000, v210
    v_lshlrev_b32 v198, 16, v211
    v_and_b32 v199, 0xffff0000, v211
    v_lshlrev_b32 v200, 16, v212
    v_and_b32 v201, 0xffff0000, v212
    v_lshlrev_b32 v202, 16, v213
    v_and_b32 v203, 0xffff0000, v213
    v_lshlrev_b32 v204, 16, v214
    v_and_b32 v205, 0xffff0000, v214
    v_lshlrev_b32 v206, 16, v215
    v_and_b32 v207, 0xffff0000, v215
    v_pk_mul_f32 v[208:209], v[192:193], v[192:193]
    v_pk_mul_f32 v[210:211], v[194:195], v[194:195]
    v_pk_mul_f32 v[212:213], v[196:197], v[196:197]
    v_pk_mul_f32 v[214:215], v[198:199], v[198:199]
    v_pk_fma_f32 v[208:209], v[208:209], v[222:223], v[220:221]
    v_pk_fma_f32 v[210:211], v[210:211], v[222:223], v[220:221]
    v_pk_fma_f32 v[212:213], v[212:213], v[222:223], v[220:221]
    v_pk_fma_f32 v[214:215], v[214:215], v[222:223], v[220:221]
    v_pk_mul_f32 v[208:209], v[208:209], v[192:193]
    v_pk_mul_f32 v[210:211], v[210:211], v[194:195]
    v_pk_mul_f32 v[212:213], v[212:213], v[196:197]
    v_pk_mul_f32 v[214:215], v[214:215], v[198:199]
    v_exp_f32 v208, v208
    v_exp_f32 v209, v209
    v_exp_f32 v210, v210
    v_exp_f32 v211, v211
    v_exp_f32 v212, v212
    v_exp_f32 v213, v213
    v_exp_f32 v214, v214
    v_exp_f32 v215, v215
    v_pk_add_f32 v[208:209], v[208:209], v[224:225]
    v_pk_add_f32 v[210:211], v[210:211], v[224:225]
    v_pk_add_f32 v[212:213], v[212:213], v[224:225]
    v_pk_add_f32 v[214:215], v[214:215], v[224:225]
    v_rcp_f32 v208, v208
    v_rcp_f32 v209, v209
    v_rcp_f32 v210, v210
    v_rcp_f32 v211, v211
    v_rcp_f32 v212, v212
    v_rcp_f32 v213, v213
    v_rcp_f32 v214, v214
    v_rcp_f32 v215, v215
    v_pk_mul_f32 v[192:193], v[192:193], v[208:209]
    v_pk_mul_f32 v[194:195], v[194:195], v[210:211]
    v_pk_mul_f32 v[196:197], v[196:197], v[212:213]
    v_pk_mul_f32 v[198:199], v[198:199], v[214:215]
    v_cvt_pk_bf16_f32 v208, v192, v193
    v_cvt_pk_bf16_f32 v209, v194, v195
    v_cvt_pk_bf16_f32 v210, v196, v197
    v_cvt_pk_bf16_f32 v211, v198, v199
    v_lshlrev_b32 v192, 16, v208
    v_and_b32 v193, 0xffff0000, v208
    v_lshlrev_b32 v194, 16, v209
    v_and_b32 v195, 0xffff0000, v209
    v_lshlrev_b32 v196, 16, v210
    v_and_b32 v197, 0xffff0000, v210
    v_lshlrev_b32 v198, 16, v211
    v_and_b32 v199, 0xffff0000, v211
    v_pk_mul_f32 v[192:193], v[192:193], v[200:201]
    v_pk_mul_f32 v[194:195], v[194:195], v[202:203]
    v_pk_mul_f32 v[196:197], v[196:197], v[204:205]
    v_pk_mul_f32 v[198:199], v[198:199], v[206:207]
    v_cvt_pk_bf16_f32 v216, v192, v193
    v_cvt_pk_bf16_f32 v217, v194, v195
    v_cvt_pk_bf16_f32 v218, v196, v197
    v_cvt_pk_bf16_f32 v219, v198, v199
    s_add_u32 s41, s38, 8192
    buffer_store_dwordx4 v[216:219], v13, s[20:23], s41 offen
end_k3_gateup_kernel_1:
    s_endpgm
.globl k4_down_kernel
.p2align 8
.type k4_down_kernel,@function
k4_down_kernel:
    s_load_dwordx2 s[4:5], s[0:1], 56
    s_load_dwordx2 s[8:9], s[0:1], 96
    s_waitcnt lgkmcnt(0)
    s_mov_b32 s12, s4
    s_and_b32 s13, s5, 0xffff
    s_mov_b32 s14, 5308416
    s_mov_b32 s15, 0x00020000
    s_mov_b32 s20, s8
    s_and_b32 s21, s9, 0xffff
    s_mov_b32 s22, 268435456
    s_mov_b32 s23, 0x00020000
    s_cmp_ge_u32 s2, 256
    s_cbranch_scc1 end_k4_down_kernel_1
    s_and_b32 s24, s2, 3
    s_lshr_b32 s25, s2, 3
    s_and_b32 s25, s25, 3
    s_lshr_b32 s33, s2, 2
    s_and_b32 s33, s33, 1
    s_lshl_b32 s33, s33, 3
    s_lshr_b32 s27, s2, 5
    s_add_u32 s33, s33, s27
    v_lshrrev_b32 v1, 6, v0
    v_and_b32 v2, 63, v0
    v_readfirstlane_b32 s26, v1
    v_lshrrev_b32 v5, 4, v2
    s_and_b32 s31, s26, 3
    s_lshr_b32 s32, s26, 2
    s_mul_i32 s34, s32, 320
    v_add_u32 v3, s34, v2
    v_mul_u32_u24 v6, 3641, v3
    v_lshrrev_b32 v6, 16, v6
    v_mul_u32_u24 v7, 18, v6
    v_sub_u32 v7, v3, v7
    v_mul_u32_u24 v6, 1152, v6
    v_lshlrev_b32 v7, 4, v7
    v_add_u32 v8, v6, v7
    v_add_u32 v3, s34, v2
    v_add_u32 v3, 64, v3
    v_mul_u32_u24 v6, 3641, v3
    v_lshrrev_b32 v6, 16, v6
    v_mul_u32_u24 v7, 18, v6
    v_sub_u32 v7, v3, v7
    v_mul_u32_u24 v6, 1152, v6
    v_lshlrev_b32 v7, 4, v7
    v_add_u32 v9, v6, v7
    v_add_u32 v3, s34, v2
    v_add_u32 v3, 128, v3
    v_mul_u32_u24 v6, 3641, v3
    v_lshrrev_b32 v6, 16, v6
    v_mul_u32_u24 v7, 18, v6
    v_sub_u32 v7, v3, v7
    v_mul_u32_u24 v6, 1152, v6
    v_lshlrev_b32 v7, 4, v7
    v_add_u32 v10, v6, v7
    v_add_u32 v3, s34, v2
    v_add_u32 v3, 192, v3
    v_mul_u32_u24 v6, 3641, v3
    v_lshrrev_b32 v6, 16, v6
    v_mul_u32_u24 v7, 18, v6
    v_sub_u32 v7, v3, v7
    v_mul_u32_u24 v6, 1152, v6
    v_lshlrev_b32 v7, 4, v7
    v_add_u32 v11, v6, v7
    v_add_u32 v3, s34, v2
    v_add_u32 v3, 256, v3
    v_mul_u32_u24 v6, 3641, v3
    v_lshrrev_b32 v6, 16, v6
    v_mul_u32_u24 v7, 18, v6
    v_sub_u32 v7, v3, v7
    v_mul_u32_u24 v6, 1152, v6
    v_lshlrev_b32 v7, 4, v7
    v_add_u32 v12, v6, v7
    s_mul_i32 s28, s24, 1327104
    s_mul_i32 s27, s25, 288
    s_add_u32 s28, s28, s27
    s_and_b32 s27, s31, 1
    s_mul_i32 s27, s27, 36864
    s_add_u32 s28, s28, s27
    s_lshr_b32 s27, s31, 1
    s_mul_i32 s27, s27, 663552
    s_add_u32 s28, s28, s27
    s_mul_i32 s29, s31, 9216
    s_mul_i32 s27, s32, 5120
    s_add_u32 s29, s29, s27
    v_lshrrev_b32 v3, 1, v5
    v_lshlrev_b32 v3, 10, v3
    v_and_b32 v6, 1, v5
    v_lshlrev_b32 v6, 9, v6
    v_add_u32 v3, v3, v6
    v_and_b32 v6, 15, v2
    v_lshlrev_b32 v6, 4, v6
    v_add_u32 v14, v3, v6
    v_lshlrev_b32 v13, 4, v2
    s_lshl_b32 s36, s33, 2
    s_add_u32 s36, s36, s31
    s_mul_i32 s37, s36, 294912
    s_mul_i32 s27, s24, 73728
    s_add_u32 s37, s37, s27
    s_mul_i32 s27, s32, 36864
    s_add_u32 s37, s37, s27
    s_add_u32 s37, s37, 13631488
    s_add_u32 m0, s29, 0
    s_add_u32 s30, s28, 0
    buffer_load_dwordx4 v8, s[12:15], s30 offen lds
    s_add_u32 m0, s29, 1024
    s_add_u32 s30, s28, 0
    buffer_load_dwordx4 v9, s[12:15], s30 offen lds
    s_add_u32 m0, s29, 2048
    s_add_u32 s30, s28, 0
    buffer_load_dwordx4 v10, s[12:15], s30 offen lds
    s_add_u32 m0, s29, 3072
    s_add_u32 s30, s28, 0
    buffer_load_dwordx4 v11, s[12:15], s30 offen lds
    s_cmp_lg_u32 s32, 0
    s_cbranch_scc1 nod_k4_down_kernel_2
    s_add_u32 m0, s29, 4096
    s_add_u32 s30, s28, 0
    buffer_load_dwordx4 v12, s[12:15], s30 offen lds
nod_k4_down_kernel_2:
    s_add_u32 s35, s37, 0
    buffer_load_dwordx4 v[16:19], v14, s[20:23], s35 offen
    buffer_load_dwordx4 v[20:23], v14, s[20:23], s35 offen offset:256
    s_add_u32 s35, s37, 2048
    buffer_load_dwordx4 v[24:27], v14, s[20:23], s35 offen
    buffer_load_dwordx4 v[28:31], v14, s[20:23], s35 offen offset:256
    s_add_u32 m0, s29, 36864
    s_add_u32 s30, s28, 73728
    buffer_load_dwordx4 v8, s[12:15], s30 offen lds
    s_add_u32 m0, s29, 37888
    s_add_u32 s30, s28, 73728
    buffer_load_dwordx4 v9, s[12:15], s30 offen lds
    s_add_u32 m0, s29, 38912
    s_add_u32 s30, s28, 73728
    buffer_load_dwordx4 v10, s[12:15], s30 offen lds
    s_add_u32 m0, s29, 39936
    s_add_u32 s30, s28, 73728
    buffer_load_dwordx4 v11, s[12:15], s30 offen lds
    s_cmp_lg_u32 s32, 0
    s_cbranch_scc1 nod_k4_down_kernel_3
    s_add_u32 m0, s29, 40960
    s_add_u32 s30, s28, 73728
    buffer_load_dwordx4 v12, s[12:15], s30 offen lds
nod_k4_down_kernel_3:
    s_add_u32 s35, s37, 4096
    buffer_load_dwordx4 v[32:35], v14, s[20:23], s35 offen
    buffer_load_dwordx4 v[36:39], v14, s[20:23], s35 offen offset:256
    s_add_u32 s35, s37, 6144
    buffer_load_dwordx4 v[40:43], v14, s[20:23], s35 offen
    buffer_load_dwordx4 v[44:47], v14, s[20:23], s35 offen offset:256
    v_and_b32 v7, 15, v2
    v_lshrrev_b32 v6, 2, v7
    v_and_b32 v7, 3, v7
    v_lshlrev_b32 v7, 3, v7
    v_lshrrev_b32 v3, 1, v5
    v_lshlrev_b32 v3, 4, v3
    v_add_u32 v6, v6, v3
    v_and_b32 v3, 1, v5
    v_lshlrev_b32 v3, 2, v3
    v_add_u32 v6, v6, v3
    v_mul_u32_u24 v6, 288, v6
    v_add_u32 v6, v6, v7
    s_mul_i32 s27, s32, 18432
    v_add_u32 v152, s27, v6
    v_add_u32 v153, 36864, v152
    v_add_u32 v154, 73728, v152
    v_add_u32 v155, 110592, v152
    s_waitcnt vmcnt(12)
    s_barrier
    ds_read_b64_tr_b16 v[64:65], v152 offset:0
    ds_read_b64_tr_b16 v[66:67], v152 offset:2304
    ds_read_b64_tr_b16 v[68:69], v152 offset:32
    ds_read_b64_tr_b16 v[70:71], v152 offset:2336
    ds_read_b64_tr_b16 v[72:73], v152 offset:64
    ds_read_b64_tr_b16 v[74:75], v152 offset:2368
    ds_read_b64_tr_b16 v[76:77], v152 offset:96
    ds_read_b64_tr_b16 v[78:79], v152 offset:2400
    s_waitcnt vmcnt(10) lgkmcnt(6)
    v_mfma_f32_16x16x32_bf16 v[80:83], v[64:67], v[16:19], 0
    v_mfma_f32_16x16x32_bf16 v[84:87], v[64:67], v[20:23], 0
    ds_read_b64_tr_b16 v[64:65], v152 offset:128
    ds_read_b64_tr_b16 v[66:67], v152 offset:2432
    s_waitcnt lgkmcnt(6)
    v_mfma_f32_16x16x32_bf16 v[88:91], v[68:71], v[16:19], 0
    v_mfma_f32_16x16x32_bf16 v[92:95], v[68:71], v[20:23], 0
    s_add_u32 m0, s29, 73728
    s_add_u32 s30, s28, 147456
    buffer_load_dwordx4 v8, s[12:15], s30 offen lds
    ds_read_b64_tr_b16 v[68:69], v152 offset:160
    ds_read_b64_tr_b16 v[70:71], v152 offset:2464
    s_waitcnt lgkmcnt(6)
    v_mfma_f32_16x16x32_bf16 v[96:99], v[72:75], v[16:19], 0
    v_mfma_f32_16x16x32_bf16 v[100:103], v[72:75], v[20:23], 0
    s_add_u32 m0, s29, 74752
    s_add_u32 s30, s28, 147456
    buffer_load_dwordx4 v9, s[12:15], s30 offen lds
    ds_read_b64_tr_b16 v[72:73], v152 offset:192
    ds_read_b64_tr_b16 v[74:75], v152 offset:2496
    s_waitcnt lgkmcnt(6)
    v_mfma_f32_16x16x32_bf16 v[104:107], v[76:79], v[16:19], 0
    v_mfma_f32_16x16x32_bf16 v[108:111], v[76:79], v[20:23], 0
    ds_read_b64_tr_b16 v[76:77], v152 offset:224
    ds_read_b64_tr_b16 v[78:79], v152 offset:2528
    s_waitcnt lgkmcnt(6)
    v_mfma_f32_16x16x32_bf16 v[112:115], v[64:67], v[16:19], 0
    v_mfma_f32_16x16x32_bf16 v[116:119], v[64:67], v[20:23], 0
    s_add_u32 m0, s29, 75776
    s_add_u32 s30, s28, 147456
    buffer_load_dwordx4 v10, s[12:15], s30 offen lds
    ds_read_b64_tr_b16 v[64:65], v152 offset:256
    ds_read_b64_tr_b16 v[66:67], v152 offset:2560
    s_waitcnt lgkmcnt(6)
    v_mfma_f32_16x16x32_bf16 v[120:123], v[68:71], v[16:19], 0
    v_mfma_f32_16x16x32_bf16 v[124:127], v[68:71], v[20:23], 0
    s_add_u32 m0, s29, 76800
    s_add_u32 s30, s28, 147456
    buffer_load_dwordx4 v11, s[12:15], s30 offen lds
    ds_read_b64_tr_b16 v[68:69], v152 offset:9216
    ds_read_b64_tr_b16 v[70:71], v152 offset:11520
    s_waitcnt lgkmcnt(6)
    v_mfma_f32_16x16x32_bf16 v[128:131], v[72:75], v[16:19], 0
    v_mfma_f32_16x16x32_bf16 v[132:135], v[72:75], v[20:23], 0
    ds_read_b64_tr_b16 v[72:73], v152 offset:9248
    ds_read_b64_tr_b16 v[74:75], v152 offset:11552
    s_waitcnt lgkmcnt(6)
    v_mfma_f32_16x16x32_bf16 v[136:139], v[76:79], v[16:19], 0
    v_mfma_f32_16x16x32_bf16 v[140:143], v[76:79], v[20:23], 0
    s_cmp_lg_u32 s32, 0
    s_cbranch_scc1 nod_k4_down_kernel_4
    s_add_u32 m0, s29, 77824
    s_add_u32 s30, s28, 147456
    buffer_load_dwordx4 v12, s[12:15], s30 offen lds
nod_k4_down_kernel_4:
    ds_read_b64_tr_b16 v[76:77], v152 offset:9280
    ds_read_b64_tr_b16 v[78:79], v152 offset:11584
    s_waitcnt lgkmcnt(6)
    v_mfma_f32_16x16x32_bf16 v[144:147], v[64:67], v[16:19], 0
    v_mfma_f32_16x16x32_bf16 v[148:151], v[64:67], v[20:23], 0
    s_add_u32 s35, s37, 8192
    buffer_load_dwordx4 v[48:51], v14, s[20:23], s35 offen
    buffer_load_dwordx4 v[52:55], v14, s[20:23], s35 offen offset:256
    s_add_u32 m0, s29, 110592
    s_add_u32 s30, s28, 221184
    buffer_load_dwordx4 v8, s[12:15], s30 offen lds
    ds_read_b64_tr_b16 v[64:65], v152 offset:9312
    ds_read_b64_tr_b16 v[66:67], v152 offset:11616
    s_waitcnt vmcnt(15) lgkmcnt(6)
    v_mfma_f32_16x16x32_bf16 v[80:83], v[68:71], v[24:27], v[80:83]
    v_mfma_f32_16x16x32_bf16 v[84:87], v[68:71], v[28:31], v[84:87]
    ds_read_b64_tr_b16 v[68:69], v152 offset:9344
    ds_read_b64_tr_b16 v[70:71], v152 offset:11648
    s_waitcnt lgkmcnt(6)
    v_mfma_f32_16x16x32_bf16 v[88:91], v[72:75], v[24:27], v[88:91]
    v_mfma_f32_16x16x32_bf16 v[92:95], v[72:75], v[28:31], v[92:95]
    s_add_u32 m0, s29, 111616
    s_add_u32 s30, s28, 221184
    buffer_load_dwordx4 v9, s[12:15], s30 offen lds
    ds_read_b64_tr_b16 v[72:73], v152 offset:9376
    ds_read_b64_tr_b16 v[74:75], v152 offset:11680
    s_waitcnt lgkmcnt(6)
    v_mfma_f32_16x16x32_bf16 v[96:99], v[76:79], v[24:27], v[96:99]
    v_mfma_f32_16x16x32_bf16 v[100:103], v[76:79], v[28:31], v[100:103]
    s_add_u32 m0, s29, 112640
    s_add_u32 s30, s28, 221184
    buffer_load_dwordx4 v10, s[12:15], s30 offen lds
    ds_read_b64_tr_b16 v[76:77], v152 offset:9408
    ds_read_b64_tr_b16 v[78:79], v152 offset:11712
    s_waitcnt lgkmcnt(6)
    v_mfma_f32_16x16x32_bf16 v[104:107], v[64:67], v[24:27], v[104:107]
    v_mfma_f32_16x16x32_bf16 v[108:111], v[64:67], v[28:31], v[108:111]
    ds_read_b64_tr_b16 v[64:65], v152 offset:9440
    ds_read_b64_tr_b16 v[66:67], v152 offset:11744
    s_waitcnt lgkmcnt(6)
    v_mfma_f32_16x16x32_bf16 v[112:115], v[68:71], v[24:27], v[112:115]
    v_mfma_f32_16x16x32_bf16 v[116:119], v[68:71], v[28:31], v[116:119]
    s_add_u32 m0, s29, 113664
    s_add_u32 s30, s28, 221184
    buffer_load_dwordx4 v11, s[12:15], s30 offen lds
    ds_read_b64_tr_b16 v[68:69], v152 offset:9472
    ds_read_b64_tr_b16 v[70:71], v152 offset:11776
    s_waitcnt lgkmcnt(6)
    v_mfma_f32_16x16x32_bf16 v[120:123], v[72:75], v[24:27], v[120:123]
    v_mfma_f32_16x16x32_bf16 v[124:127], v[72:75], v[28:31], v[124:127]
    s_cmp_lg_u32 s32, 0
    s_cbranch_scc1 nod_k4_down_kernel_5
    s_add_u32 m0, s29, 114688
    s_add_u32 s30, s28, 221184
    buffer_load_dwordx4 v12, s[12:15], s30 offen lds
nod_k4_down_kernel_5:
    s_waitcnt lgkmcnt(4)
    v_mfma_f32_16x16x32_bf16 v[128:131], v[76:79], v[24:27], v[128:131]
    v_mfma_f32_16x16x32_bf16 v[132:135], v[76:79], v[28:31], v[132:135]
    s_waitcnt lgkmcnt(2)
    v_mfma_f32_16x16x32_bf16 v[136:139], v[64:67], v[24:27], v[136:139]
    v_mfma_f32_16x16x32_bf16 v[140:143], v[64:67], v[28:31], v[140:143]
    s_waitcnt lgkmcnt(0)
    v_mfma_f32_16x16x32_bf16 v[144:147], v[68:71], v[24:27], v[144:147]
    v_mfma_f32_16x16x32_bf16 v[148:151], v[68:71], v[28:31], v[148:151]
    s_add_u32 s35, s37, 10240
    buffer_load_dwordx4 v[56:59], v14, s[20:23], s35 offen
    buffer_load_dwordx4 v[60:63], v14, s[20:23], s35 offen offset:256
    s_waitcnt vmcnt(16)
    s_barrier
    ds_read_b64_tr_b16 v[72:73], v153 offset:0
    ds_read_b64_tr_b16 v[74:75], v153 offset:2304
    ds_read_b64_tr_b16 v[76:77], v153 offset:32
    ds_read_b64_tr_b16 v[78:79], v153 offset:2336
    ds_read_b64_tr_b16 v[64:65], v153 offset:64
    ds_read_b64_tr_b16 v[66:67], v153 offset:2368
    ds_read_b64_tr_b16 v[68:69], v153 offset:96
    ds_read_b64_tr_b16 v[70:71], v153 offset:2400
    s_waitcnt vmcnt(14) lgkmcnt(6)
    v_mfma_f32_16x16x32_bf16 v[80:83], v[72:75], v[32:35], v[80:83]
    v_mfma_f32_16x16x32_bf16 v[84:87], v[72:75], v[36:39], v[84:87]
    ds_read_b64_tr_b16 v[72:73], v153 offset:128
    ds_read_b64_tr_b16 v[74:75], v153 offset:2432
    s_waitcnt lgkmcnt(6)
    v_mfma_f32_16x16x32_bf16 v[88:91], v[76:79], v[32:35], v[88:91]
    v_mfma_f32_16x16x32_bf16 v[92:95], v[76:79], v[36:39], v[92:95]
    s_add_u32 m0, s29, 0
    s_add_u32 s30, s28, 294912
    buffer_load_dwordx4 v8, s[12:15], s30 offen lds
    ds_read_b64_tr_b16 v[76:77], v153 offset:160
    ds_read_b64_tr_b16 v[78:79], v153 offset:2464
    s_waitcnt lgkmcnt(6)
    v_mfma_f32_16x16x32_bf16 v[96:99], v[64:67], v[32:35], v[96:99]
    v_mfma_f32_16x16x32_bf16 v[100:103], v[64:67], v[36:39], v[100:103]
    ds_read_b64_tr_b16 v[64:65], v153 offset:192
    ds_read_b64_tr_b16 v[66:67], v153 offset:2496
    s_waitcnt lgkmcnt(6)
    v_mfma_f32_16x16x32_bf16 v[104:107], v[68:71], v[32:35], v[104:107]
    v_mfma_f32_16x16x32_bf16 v[108:111], v[68:71], v[36:39], v[108:111]
    ds_read_b64_tr_b16 v[68:69], v153 offset:224
    ds_read_b64_tr_b16 v[70:71], v153 offset:2528
    s_waitcnt lgkmcnt(6)
    v_mfma_f32_16x16x32_bf16 v[112:115], v[72:75], v[32:35], v[112:115]
    v_mfma_f32_16x16x32_bf16 v[116:119], v[72:75], v[36:39], v[116:119]
    s_add_u32 m0, s29, 1024
    s_add_u32 s30, s28, 294912
    buffer_load_dwordx4 v9, s[12:15], s30 offen lds
    ds_read_b64_tr_b16 v[72:73], v153 offset:256
    ds_read_b64_tr_b16 v[74:75], v153 offset:2560
    s_waitcnt lgkmcnt(6)
    v_mfma_f32_16x16x32_bf16 v[120:123], v[76:79], v[32:35], v[120:123]
    v_mfma_f32_16x16x32_bf16 v[124:127], v[76:79], v[36:39], v[124:127]
    ds_read_b64_tr_b16 v[76:77], v153 offset:9216
    ds_read_b64_tr_b16 v[78:79], v153 offset:11520
    s_waitcnt lgkmcnt(6)
    v_mfma_f32_16x16x32_bf16 v[128:131], v[64:67], v[32:35], v[128:131]
    v_mfma_f32_16x16x32_bf16 v[132:135], v[64:67], v[36:39], v[132:135]
    ds_read_b64_tr_b16 v[64:65], v153 offset:9248
    ds_read_b64_tr_b16 v[66:67], v153 offset:11552
    s_waitcnt lgkmcnt(6)
    v_mfma_f32_16x16x32_bf16 v[136:139], v[68:71], v[32:35], v[136:139]
    v_mfma_f32_16x16x32_bf16 v[140:143], v[68:71], v[36:39], v[140:143]
    s_add_u32 m0, s29, 2048
    s_add_u32 s30, s28, 294912
    buffer_load_dwordx4 v10, s[12:15], s30 offen lds
    ds_read_b64_tr_b16 v[68:69], v153 offset:9280
    ds_read_b64_tr_b16 v[70:71], v153 offset:11584
    s_waitcnt lgkmcnt(6)
    v_mfma_f32_16x16x32_bf16 v[144:147], v[72:75], v[32:35], v[144:147]
    v_mfma_f32_16x16x32_bf16 v[148:151], v[72:75], v[36:39], v[148:151]
    s_add_u32 s35, s37, 12288
    buffer_load_dwordx4 v[16:19], v14, s[20:23], s35 offen
    buffer_load_dwordx4 v[20:23], v14, s[20:23], s35 offen offset:256
    ds_read_b64_tr_b16 v[72:73], v153 offset:9312
    ds_read_b64_tr_b16 v[74:75], v153 offset:11616
    s_waitcnt vmcnt(17) lgkmcnt(6)
    v_mfma_f32_16x16x32_bf16 v[80:83], v[76:79], v[40:43], v[80:83]
    v_mfma_f32_16x16x32_bf16 v[84:87], v[76:79], v[44:47], v[84:87]
    ds_read_b64_tr_b16 v[76:77], v153 offset:9344
    ds_read_b64_tr_b16 v[78:79], v153 offset:11648
    s_waitcnt lgkmcnt(6)
    v_mfma_f32_16x16x32_bf16 v[88:91], v[64:67], v[40:43], v[88:91]
    v_mfma_f32_16x16x32_bf16 v[92:95], v[64:67], v[44:47], v[92:95]
    s_add_u32 m0, s29, 3072
    s_add_u32 s30, s28, 294912
    buffer_load_dwordx4 v11, s[12:15], s30 offen lds
    ds_read_b64_tr_b16 v[64:65], v153 offset:9376
    ds_read_b64_tr_b16 v[66:67], v153 offset:11680
    s_waitcnt lgkmcnt(6)
    v_mfma_f32_16x16x32_bf16 v[96:99], v[68:71], v[40:43], v[96:99]
    v_mfma_f32_16x16x32_bf16 v[100:103], v[68:71], v[44:47], v[100:103]
    ds_read_b64_tr_b16 v[68:69], v153 offset:9408
    ds_read_b64_tr_b16 v[70:71], v153 offset:11712
    s_waitcnt lgkmcnt(6)
    v_mfma_f32_16x16x32_bf16 v[104:107], v[72:75], v[40:43], v[104:107]
    v_mfma_f32_16x16x32_bf16 v[108:111], v[72:75], v[44:47], v[108:111]
    ds_read_b64_tr_b16 v[72:73], v153 offset:9440
    ds_read_b64_tr_b16 v[74:75], v153 offset:11744
    s_waitcnt lgkmcnt(6)
    v_mfma_f32_16x16x32_bf16 v[112:115], v[76:79], v[40:43], v[112:115]
    v_mfma_f32_16x16x32_bf16 v[116:119], v[76:79], v[44:47], v[116:119]
    s_cmp_lg_u32 s32, 0
    s_cbranch_scc1 nod_k4_down_kernel_6
    s_add_u32 m0, s29, 4096
    s_add_u32 s30, s28, 294912
    buffer_load_dwordx4 v12, s[12:15], s30 offen lds
nod_k4_down_kernel_6:
    ds_read_b64_tr_b16 v[76:77], v153 offset:9472
    ds_read_b64_tr_b16 v[78:79], v153 offset:11776
    s_waitcnt lgkmcnt(6)
    v_mfma_f32_16x16x32_bf16 v[120:123], v[64:67], v[40:43], v[120:123]
    v_mfma_f32_16x16x32_bf16 v[124:127], v[64:67], v[44:47], v[124:127]
    s_waitcnt lgkmcnt(4)
    v_mfma_f32_16x16x32_bf16 v[128:131], v[68:71], v[40:43], v[128:131]
    v_mfma_f32_16x16x32_bf16 v[132:135], v[68:71], v[44:47], v[132:135]
    s_waitcnt lgkmcnt(2)
    v_mfma_f32_16x16x32_bf16 v[136:139], v[72:75], v[40:43], v[136:139]
    v_mfma_f32_16x16x32_bf16 v[140:143], v[72:75], v[44:47], v[140:143]
    s_waitcnt lgkmcnt(0)
    v_mfma_f32_16x16x32_bf16 v[144:147], v[76:79], v[40:43], v[144:147]
    v_mfma_f32_16x16x32_bf16 v[148:151], v[76:79], v[44:47], v[148:151]
    s_add_u32 s35, s37, 14336
    buffer_load_dwordx4 v[24:27], v14, s[20:23], s35 offen
    buffer_load_dwordx4 v[28:31], v14, s[20:23], s35 offen offset:256
    s_waitcnt vmcnt(16)
    s_barrier
    ds_read_b64_tr_b16 v[64:65], v154 offset:0
    ds_read_b64_tr_b16 v[66:67], v154 offset:2304
    ds_read_b64_tr_b16 v[68:69], v154 offset:32
    ds_read_b64_tr_b16 v[70:71], v154 offset:2336
    ds_read_b64_tr_b16 v[72:73], v154 offset:64
    ds_read_b64_tr_b16 v[74:75], v154 offset:2368
    ds_read_b64_tr_b16 v[76:77], v154 offset:96
    ds_read_b64_tr_b16 v[78:79], v154 offset:2400
    s_waitcnt vmcnt(14) lgkmcnt(6)
    v_mfma_f32_16x16x32_bf16 v[80:83], v[64:67], v[48:51], v[80:83]
    v_mfma_f32_16x16x32_bf16 v[84:87], v[64:67], v[52:55], v[84:87]
    ds_read_b64_tr_b16 v[64:65], v154 offset:128
    ds_read_b64_tr_b16 v[66:67], v154 offset:2432
    s_waitcnt lgkmcnt(6)
    v_mfma_f32_16x16x32_bf16 v[88:91], v[68:71], v[48:51], v[88:91]
    v_mfma_f32_16x16x32_bf16 v[92:95], v[68:71], v[52:55], v[92:95]
    s_add_u32 m0, s29, 36864
    s_add_u32 s30, s28, 368640
    buffer_load_dwordx4 v8, s[12:15], s30 offen lds
    ds_read_b64_tr_b16 v[68:69], v154 offset:160
    ds_read_b64_tr_b16 v[70:71], v154 offset:2464
    s_waitcnt lgkmcnt(6)
    v_mfma_f32_16x16x32_bf16 v[96:99], v[72:75], v[48:51], v[96:99]
    v_mfma_f32_16x16x32_bf16 v[100:103], v[72:75], v[52:55], v[100:103]
    ds_read_b64_tr_b16 v[72:73], v154 offset:192
    ds_read_b64_tr_b16 v[74:75], v154 offset:2496
    s_waitcnt lgkmcnt(6)
    v_mfma_f32_16x16x32_bf16 v[104:107], v[76:79], v[48:51], v[104:107]
    v_mfma_f32_16x16x32_bf16 v[108:111], v[76:79], v[52:55], v[108:111]
    ds_read_b64_tr_b16 v[76:77], v154 offset:224
    ds_read_b64_tr_b16 v[78:79], v154 offset:2528
    s_waitcnt lgkmcnt(6)
    v_mfma_f32_16x16x32_bf16 v[112:115], v[64:67], v[48:51], v[112:115]
    v_mfma_f32_16x16x32_bf16 v[116:119], v[64:67], v[52:55], v[116:119]
    s_add_u32 m0, s29, 37888
    s_add_u32 s30, s28, 368640
    buffer_load_dwordx4 v9, s[12:15], s30 offen lds
    ds_read_b64_tr_b16 v[64:65], v154 offset:256
    ds_read_b64_tr_b16 v[66:67], v154 offset:2560
    s_waitcnt lgkmcnt(6)
    v_mfma_f32_16x16x32_bf16 v[120:123], v[68:71], v[48:51], v[120:123]
    v_mfma_f32_16x16x32_bf16 v[124:127], v[68:71], v[52:55], v[124:127]
    ds_read_b64_tr_b16 v[68:69], v154 offset:9216
    ds_read_b64_tr_b16 v[70:71], v154 offset:11520
    s_waitcnt lgkmcnt(6)
    v_mfma_f32_16x16x32_bf16 v[128:131], v[72:75], v[48:51], v[128:131]
    v_mfma_f32_16x16x32_bf16 v[132:135], v[72:75], v[52:55], v[132:135]
    ds_read_b64_tr_b16 v[72:73], v154 offset:9248
    ds_read_b64_tr_b16 v[74:75], v154 offset:11552
    s_waitcnt lgkmcnt(6)
    v_mfma_f32_16x16x32_bf16 v[136:139], v[76:79], v[48:51], v[136:139]
    v_mfma_f32_16x16x32_bf16 v[140:143], v[76:79], v[52:55], v[140:143]
    s_add_u32 m0, s29, 38912
    s_add_u32 s30, s28, 368640
    buffer_load_dwordx4 v10, s[12:15], s30 offen lds
    ds_read_b64_tr_b16 v[76:77], v154 offset:9280
    ds_read_b64_tr_b16 v[78:79], v154 offset:11584
    s_waitcnt lgkmcnt(6)
    v_mfma_f32_16x16x32_bf16 v[144:147], v[64:67], v[48:51], v[144:147]
    v_mfma_f32_16x16x32_bf16 v[148:151], v[64:67], v[52:55], v[148:151]
    s_add_u32 s35, s37, 16384
    buffer_load_dwordx4 v[32:35], v14, s[20:23], s35 offen
    buffer_load_dwordx4 v[36:39], v14, s[20:23], s35 offen offset:256
    ds_read_b64_tr_b16 v[64:65], v154 offset:9312
    ds_read_b64_tr_b16 v[66:67], v154 offset:11616
    s_waitcnt vmcnt(13) lgkmcnt(6)
    v_mfma_f32_16x16x32_bf16 v[80:83], v[68:71], v[56:59], v[80:83]
    v_mfma_f32_16x16x32_bf16 v[84:87], v[68:71], v[60:63], v[84:87]
    ds_read_b64_tr_b16 v[68:69], v154 offset:9344
    ds_read_b64_tr_b16 v[70:71], v154 offset:11648
    s_waitcnt lgkmcnt(6)
    v_mfma_f32_16x16x32_bf16 v[88:91], v[72:75], v[56:59], v[88:91]
    v_mfma_f32_16x16x32_bf16 v[92:95], v[72:75], v[60:63], v[92:95]
    s_add_u32 m0, s29, 39936
    s_add_u32 s30, s28, 368640
    buffer_load_dwordx4 v11, s[12:15], s30 offen lds
    ds_read_b64_tr_b16 v[72:73], v154 offset:9376
    ds_read_b64_tr_b16 v[74:75], v154 offset:11680
    s_waitcnt lgkmcnt(6)
    v_mfma_f32_16x16x32_bf16 v[96:99], v[76:79], v[56:59], v[96:99]
    v_mfma_f32_16x16x32_bf16 v[100:103], v[76:79], v[60:63], v[100:103]
    ds_read_b64_tr_b16 v[76:77], v154 offset:9408
    ds_read_b64_tr_b16 v[78:79], v154 offset:11712
    s_waitcnt lgkmcnt(6)
    v_mfma_f32_16x16x32_bf16 v[104:107], v[64:67], v[56:59], v[104:107]
    v_mfma_f32_16x16x32_bf16 v[108:111], v[64:67], v[60:63], v[108:111]
    ds_read_b64_tr_b16 v[64:65], v154 offset:9440
    ds_read_b64_tr_b16 v[66:67], v154 offset:11744
    s_waitcnt lgkmcnt(6)
    v_mfma_f32_16x16x32_bf16 v[112:115], v[68:71], v[56:59], v[112:115]
    v_mfma_f32_16x16x32_bf16 v[116:119], v[68:71], v[60:63], v[116:119]
    s_cmp_lg_u32 s32, 0
    s_cbranch_scc1 nod_k4_down_kernel_7
    s_add_u32 m0, s29, 40960
    s_add_u32 s30, s28, 368640
    buffer_load_dwordx4 v12, s[12:15], s30 offen lds
nod_k4_down_kernel_7:
    ds_read_b64_tr_b16 v[68:69], v154 offset:9472
    ds_read_b64_tr_b16 v[70:71], v154 offset:11776
    s_waitcnt lgkmcnt(6)
    v_mfma_f32_16x16x32_bf16 v[120:123], v[72:75], v[56:59], v[120:123]
    v_mfma_f32_16x16x32_bf16 v[124:127], v[72:75], v[60:63], v[124:127]
    s_waitcnt lgkmcnt(4)
    v_mfma_f32_16x16x32_bf16 v[128:131], v[76:79], v[56:59], v[128:131]
    v_mfma_f32_16x16x32_bf16 v[132:135], v[76:79], v[60:63], v[132:135]
    s_waitcnt lgkmcnt(2)
    v_mfma_f32_16x16x32_bf16 v[136:139], v[64:67], v[56:59], v[136:139]
    v_mfma_f32_16x16x32_bf16 v[140:143], v[64:67], v[60:63], v[140:143]
    s_waitcnt lgkmcnt(0)
    v_mfma_f32_16x16x32_bf16 v[144:147], v[68:71], v[56:59], v[144:147]
    v_mfma_f32_16x16x32_bf16 v[148:151], v[68:71], v[60:63], v[148:151]
    s_add_u32 s35, s37, 18432
    buffer_load_dwordx4 v[40:43], v14, s[20:23], s35 offen
    buffer_load_dwordx4 v[44:47], v14, s[20:23], s35 offen offset:256
    s_waitcnt vmcnt(16)
    s_barrier
    ds_read_b64_tr_b16 v[72:73], v155 offset:0
    ds_read_b64_tr_b16 v[74:75], v155 offset:2304
    ds_read_b64_tr_b16 v[76:77], v155 offset:32
    ds_read_b64_tr_b16 v[78:79], v155 offset:2336
    ds_read_b64_tr_b16 v[64:65], v155 offset:64
    ds_read_b64_tr_b16 v[66:67], v155 offset:2368
    ds_read_b64_tr_b16 v[68:69], v155 offset:96
    ds_read_b64_tr_b16 v[70:71], v155 offset:2400
    s_waitcnt vmcnt(11) lgkmcnt(6)
    v_mfma_f32_16x16x32_bf16 v[80:83], v[72:75], v[16:19], v[80:83]
    v_mfma_f32_16x16x32_bf16 v[84:87], v[72:75], v[20:23], v[84:87]
    ds_read_b64_tr_b16 v[72:73], v155 offset:128
    ds_read_b64_tr_b16 v[74:75], v155 offset:2432
    s_waitcnt lgkmcnt(6)
    v_mfma_f32_16x16x32_bf16 v[88:91], v[76:79], v[16:19], v[88:91]
    v_mfma_f32_16x16x32_bf16 v[92:95], v[76:79], v[20:23], v[92:95]
    s_add_u32 m0, s29, 73728
    s_add_u32 s30, s28, 442368
    buffer_load_dwordx4 v8, s[12:15], s30 offen lds
    ds_read_b64_tr_b16 v[76:77], v155 offset:160
    ds_read_b64_tr_b16 v[78:79], v155 offset:2464
    s_waitcnt lgkmcnt(6)
    v_mfma_f32_16x16x32_bf16 v[96:99], v[64:67], v[16:19], v[96:99]
    v_mfma_f32_16x16x32_bf16 v[100:103], v[64:67], v[20:23], v[100:103]
    ds_read_b64_tr_b16 v[64:65], v155 offset:192
    ds_read_b64_tr_b16 v[66:67], v155 offset:2496
    s_waitcnt lgkmcnt(6)
    v_mfma_f32_16x16x32_bf16 v[104:107], v[68:71], v[16:19], v[104:107]
    v_mfma_f32_16x16x32_bf16 v[108:111], v[68:71], v[20:23], v[108:111]
    ds_read_b64_tr_b16 v[68:69], v155 offset:224
    ds_read_b64_tr_b16 v[70:71], v155 offset:2528
    s_waitcnt lgkmcnt(6)
    v_mfma_f32_16x16x32_bf16 v[112:115], v[72:75], v[16:19], v[112:115]
    v_mfma_f32_16x16x32_bf16 v[116:119], v[72:75], v[20:23], v[116:119]
    s_add_u32 m0, s29, 74752
    s_add_u32 s30, s28, 442368
    buffer_load_dwordx4 v9, s[12:15], s30 offen lds
    ds_read_b64_tr_b16 v[72:73], v155 offset:256
    ds_read_b64_tr_b16 v[74:75], v155 offset:2560
    s_waitcnt lgkmcnt(6)
    v_mfma_f32_16x16x32_bf16 v[120:123], v[76:79], v[16:19], v[120:123]
    v_mfma_f32_16x16x32_bf16 v[124:127], v[76:79], v[20:23], v[124:127]
    ds_read_b64_tr_b16 v[76:77], v155 offset:9216
    ds_read_b64_tr_b16 v[78:79], v155 offset:11520
    s_waitcnt lgkmcnt(6)
    v_mfma_f32_16x16x32_bf16 v[128:131], v[64:67], v[16:19], v[128:131]
    v_mfma_f32_16x16x32_bf16 v[132:135], v[64:67], v[20:23], v[132:135]
    ds_read_b64_tr_b16 v[64:65], v155 offset:9248
    ds_read_b64_tr_b16 v[66:67], v155 offset:11552
    s_waitcnt lgkmcnt(6)
    v_mfma_f32_16x16x32_bf16 v[136:139], v[68:71], v[16:19], v[136:139]
    v_mfma_f32_16x16x32_bf16 v[140:143], v[68:71], v[20:23], v[140:143]
    s_add_u32 m0, s29, 75776
    s_add_u32 s30, s28, 442368
    buffer_load_dwordx4 v10, s[12:15], s30 offen lds
    ds_read_b64_tr_b16 v[68:69], v155 offset:9280
    ds_read_b64_tr_b16 v[70:71], v155 offset:11584
    s_waitcnt lgkmcnt(6)
    v_mfma_f32_16x16x32_bf16 v[144:147], v[72:75], v[16:19], v[144:147]
    v_mfma_f32_16x16x32_bf16 v[148:151], v[72:75], v[20:23], v[148:151]
    s_add_u32 s35, s37, 20480
    buffer_load_dwordx4 v[48:51], v14, s[20:23], s35 offen
    buffer_load_dwordx4 v[52:55], v14, s[20:23], s35 offen offset:256
    ds_read_b64_tr_b16 v[72:73], v155 offset:9312
    ds_read_b64_tr_b16 v[74:75], v155 offset:11616
    s_waitcnt vmcnt(13) lgkmcnt(6)
    v_mfma_f32_16x16x32_bf16 v[80:83], v[76:79], v[24:27], v[80:83]
    v_mfma_f32_16x16x32_bf16 v[84:87], v[76:79], v[28:31], v[84:87]
    ds_read_b64_tr_b16 v[76:77], v155 offset:9344
    ds_read_b64_tr_b16 v[78:79], v155 offset:11648
    s_waitcnt lgkmcnt(6)
    v_mfma_f32_16x16x32_bf16 v[88:91], v[64:67], v[24:27], v[88:91]
    v_mfma_f32_16x16x32_bf16 v[92:95], v[64:67], v[28:31], v[92:95]
    s_add_u32 m0, s29, 76800
    s_add_u32 s30, s28, 442368
    buffer_load_dwordx4 v11, s[12:15], s30 offen lds
    ds_read_b64_tr_b16 v[64:65], v155 offset:9376
    ds_read_b64_tr_b16 v[66:67], v155 offset:11680
    s_waitcnt lgkmcnt(6)
    v_mfma_f32_16x16x32_bf16 v[96:99], v[68:71], v[24:27], v[96:99]
    v_mfma_f32_16x16x32_bf16 v[100:103], v[68:71], v[28:31], v[100:103]
    ds_read_b64_tr_b16 v[68:69], v155 offset:9408
    ds_read_b64_tr_b16 v[70:71], v155 offset:11712
    s_waitcnt lgkmcnt(6)
    v_mfma_f32_16x16x32_bf16 v[104:107], v[72:75], v[24:27], v[104:107]
    v_mfma_f32_16x16x32_bf16 v[108:111], v[72:75], v[28:31], v[108:111]
    ds_read_b64_tr_b16 v[72:73], v155 offset:9440
    ds_read_b64_tr_b16 v[74:75], v155 offset:11744
    s_waitcnt lgkmcnt(6)
    v_mfma_f32_16x16x32_bf16 v[112:115], v[76:79], v[24:27], v[112:115]
    v_mfma_f32_16x16x32_bf16 v[116:119], v[76:79], v[28:31], v[116:119]
    s_cmp_lg_u32 s32, 0
    s_cbranch_scc1 nod_k4_down_kernel_8
    s_add_u32 m0, s29, 77824
    s_add_u32 s30, s28, 442368
    buffer_load_dwordx4 v12, s[12:15], s30 offen lds
nod_k4_down_kernel_8:
    ds_read_b64_tr_b16 v[76:77], v155 offset:9472
    ds_read_b64_tr_b16 v[78:79], v155 offset:11776
    s_waitcnt lgkmcnt(6)
    v_mfma_f32_16x16x32_bf16 v[120:123], v[64:67], v[24:27], v[120:123]
    v_mfma_f32_16x16x32_bf16 v[124:127], v[64:67], v[28:31], v[124:127]
    s_waitcnt lgkmcnt(4)
    v_mfma_f32_16x16x32_bf16 v[128:131], v[68:71], v[24:27], v[128:131]
    v_mfma_f32_16x16x32_bf16 v[132:135], v[68:71], v[28:31], v[132:135]
    s_waitcnt lgkmcnt(2)
    v_mfma_f32_16x16x32_bf16 v[136:139], v[72:75], v[24:27], v[136:139]
    v_mfma_f32_16x16x32_bf16 v[140:143], v[72:75], v[28:31], v[140:143]
    s_waitcnt lgkmcnt(0)
    v_mfma_f32_16x16x32_bf16 v[144:147], v[76:79], v[24:27], v[144:147]
    v_mfma_f32_16x16x32_bf16 v[148:151], v[76:79], v[28:31], v[148:151]
    s_add_u32 s35, s37, 22528
    buffer_load_dwordx4 v[56:59], v14, s[20:23], s35 offen
    buffer_load_dwordx4 v[60:63], v14, s[20:23], s35 offen offset:256
    s_waitcnt vmcnt(16)
    s_barrier
    ds_read_b64_tr_b16 v[64:65], v152 offset:0
    ds_read_b64_tr_b16 v[66:67], v152 offset:2304
    ds_read_b64_tr_b16 v[68:69], v152 offset:32
    ds_read_b64_tr_b16 v[70:71], v152 offset:2336
    ds_read_b64_tr_b16 v[72:73], v152 offset:64
    ds_read_b64_tr_b16 v[74:75], v152 offset:2368
    ds_read_b64_tr_b16 v[76:77], v152 offset:96
    ds_read_b64_tr_b16 v[78:79], v152 offset:2400
    s_waitcnt vmcnt(11) lgkmcnt(6)
    v_mfma_f32_16x16x32_bf16 v[80:83], v[64:67], v[32:35], v[80:83]
    v_mfma_f32_16x16x32_bf16 v[84:87], v[64:67], v[36:39], v[84:87]
    ds_read_b64_tr_b16 v[64:65], v152 offset:128
    ds_read_b64_tr_b16 v[66:67], v152 offset:2432
    s_waitcnt lgkmcnt(6)
    v_mfma_f32_16x16x32_bf16 v[88:91], v[68:71], v[32:35], v[88:91]
    v_mfma_f32_16x16x32_bf16 v[92:95], v[68:71], v[36:39], v[92:95]
    s_add_u32 m0, s29, 110592
    s_add_u32 s30, s28, 516096
    buffer_load_dwordx4 v8, s[12:15], s30 offen lds
    ds_read_b64_tr_b16 v[68:69], v152 offset:160
    ds_read_b64_tr_b16 v[70:71], v152 offset:2464
    s_waitcnt lgkmcnt(6)
    v_mfma_f32_16x16x32_bf16 v[96:99], v[72:75], v[32:35], v[96:99]
    v_mfma_f32_16x16x32_bf16 v[100:103], v[72:75], v[36:39], v[100:103]
    ds_read_b64_tr_b16 v[72:73], v152 offset:192
    ds_read_b64_tr_b16 v[74:75], v152 offset:2496
    s_waitcnt lgkmcnt(6)
    v_mfma_f32_16x16x32_bf16 v[104:107], v[76:79], v[32:35], v[104:107]
    v_mfma_f32_16x16x32_bf16 v[108:111], v[76:79], v[36:39], v[108:111]
    ds_read_b64_tr_b16 v[76:77], v152 offset:224
    ds_read_b64_tr_b16 v[78:79], v152 offset:2528
    s_waitcnt lgkmcnt(6)
    v_mfma_f32_16x16x32_bf16 v[112:115], v[64:67], v[32:35], v[112:115]
    v_mfma_f32_16x16x32_bf16 v[116:119], v[64:67], v[36:39], v[116:119]
    s_add_u32 m0, s29, 111616
    s_add_u32 s30, s28, 516096
    buffer_load_dwordx4 v9, s[12:15], s30 offen lds
    ds_read_b64_tr_b16 v[64:65], v152 offset:256
    ds_read_b64_tr_b16 v[66:67], v152 offset:2560
    s_waitcnt lgkmcnt(6)
    v_mfma_f32_16x16x32_bf16 v[120:123], v[68:71], v[32:35], v[120:123]
    v_mfma_f32_16x16x32_bf16 v[124:127], v[68:71], v[36:39], v[124:127]
    ds_read_b64_tr_b16 v[68:69], v152 offset:9216
    ds_read_b64_tr_b16 v[70:71], v152 offset:11520
    s_waitcnt lgkmcnt(6)
    v_mfma_f32_16x16x32_bf16 v[128:131], v[72:75], v[32:35], v[128:131]
    v_mfma_f32_16x16x32_bf16 v[132:135], v[72:75], v[36:39], v[132:135]
    ds_read_b64_tr_b16 v[72:73], v152 offset:9248
    ds_read_b64_tr_b16 v[74:75], v152 offset:11552
    s_waitcnt lgkmcnt(6)
    v_mfma_f32_16x16x32_bf16 v[136:139], v[76:79], v[32:35], v[136:139]
    v_mfma_f32_16x16x32_bf16 v[140:143], v[76:79], v[36:39], v[140:143]
    s_add_u32 m0, s29, 112640
    s_add_u32 s30, s28, 516096
    buffer_load_dwordx4 v10, s[12:15], s30 offen lds
    ds_read_b64_tr_b16 v[76:77], v152 offset:9280
    ds_read_b64_tr_b16 v[78:79], v152 offset:11584
    s_waitcnt lgkmcnt(6)
    v_mfma_f32_16x16x32_bf16 v[144:147], v[64:67], v[32:35], v[144:147]
    v_mfma_f32_16x16x32_bf16 v[148:151], v[64:67], v[36:39], v[148:151]
    s_add_u32 s35, s37, 24576
    buffer_load_dwordx4 v[16:19], v14, s[20:23], s35 offen
    buffer_load_dwordx4 v[20:23], v14, s[20:23], s35 offen offset:256
    ds_read_b64_tr_b16 v[64:65], v152 offset:9312
    ds_read_b64_tr_b16 v[66:67], v152 offset:11616
    s_waitcnt vmcnt(13) lgkmcnt(6)
    v_mfma_f32_16x16x32_bf16 v[80:83], v[68:71], v[40:43], v[80:83]
    v_mfma_f32_16x16x32_bf16 v[84:87], v[68:71], v[44:47], v[84:87]
    ds_read_b64_tr_b16 v[68:69], v152 offset:9344
    ds_read_b64_tr_b16 v[70:71], v152 offset:11648
    s_waitcnt lgkmcnt(6)
    v_mfma_f32_16x16x32_bf16 v[88:91], v[72:75], v[40:43], v[88:91]
    v_mfma_f32_16x16x32_bf16 v[92:95], v[72:75], v[44:47], v[92:95]
    s_add_u32 m0, s29, 113664
    s_add_u32 s30, s28, 516096
    buffer_load_dwordx4 v11, s[12:15], s30 offen lds
    ds_read_b64_tr_b16 v[72:73], v152 offset:9376
    ds_read_b64_tr_b16 v[74:75], v152 offset:11680
    s_waitcnt lgkmcnt(6)
    v_mfma_f32_16x16x32_bf16 v[96:99], v[76:79], v[40:43], v[96:99]
    v_mfma_f32_16x16x32_bf16 v[100:103], v[76:79], v[44:47], v[100:103]
    ds_read_b64_tr_b16 v[76:77], v152 offset:9408
    ds_read_b64_tr_b16 v[78:79], v152 offset:11712
    s_waitcnt lgkmcnt(6)
    v_mfma_f32_16x16x32_bf16 v[104:107], v[64:67], v[40:43], v[104:107]
    v_mfma_f32_16x16x32_bf16 v[108:111], v[64:67], v[44:47], v[108:111]
    ds_read_b64_tr_b16 v[64:65], v152 offset:9440
    ds_read_b64_tr_b16 v[66:67], v152 offset:11744
    s_waitcnt lgkmcnt(6)
    v_mfma_f32_16x16x32_bf16 v[112:115], v[68:71], v[40:43], v[112:115]
    v_mfma_f32_16x16x32_bf16 v[116:119], v[68:71], v[44:47], v[116:119]
    s_cmp_lg_u32 s32, 0
    s_cbranch_scc1 nod_k4_down_kernel_9
    s_add_u32 m0, s29, 114688
    s_add_u32 s30, s28, 516096
    buffer_load_dwordx4 v12, s[12:15], s30 offen lds
nod_k4_down_kernel_9:
    ds_read_b64_tr_b16 v[68:69], v152 offset:9472
    ds_read_b64_tr_b16 v[70:71], v152 offset:11776
    s_waitcnt lgkmcnt(6)
    v_mfma_f32_16x16x32_bf16 v[120:123], v[72:75], v[40:43], v[120:123]
    v_mfma_f32_16x16x32_bf16 v[124:127], v[72:75], v[44:47], v[124:127]
    s_waitcnt lgkmcnt(4)
    v_mfma_f32_16x16x32_bf16 v[128:131], v[76:79], v[40:43], v[128:131]
    v_mfma_f32_16x16x32_bf16 v[132:135], v[76:79], v[44:47], v[132:135]
    s_waitcnt lgkmcnt(2)
    v_mfma_f32_16x16x32_bf16 v[136:139], v[64:67], v[40:43], v[136:139]
    v_mfma_f32_16x16x32_bf16 v[140:143], v[64:67], v[44:47], v[140:143]
    s_waitcnt lgkmcnt(0)
    v_mfma_f32_16x16x32_bf16 v[144:147], v[68:71], v[40:43], v[144:147]
    v_mfma_f32_16x16x32_bf16 v[148:151], v[68:71], v[44:47], v[148:151]
    s_add_u32 s35, s37, 26624
    buffer_load_dwordx4 v[24:27], v14, s[20:23], s35 offen
    buffer_load_dwordx4 v[28:31], v14, s[20:23], s35 offen offset:256
    s_waitcnt vmcnt(16)
    s_barrier
    ds_read_b64_tr_b16 v[72:73], v153 offset:0
    ds_read_b64_tr_b16 v[74:75], v153 offset:2304
    ds_read_b64_tr_b16 v[76:77], v153 offset:32
    ds_read_b64_tr_b16 v[78:79], v153 offset:2336
    ds_read_b64_tr_b16 v[64:65], v153 offset:64
    ds_read_b64_tr_b16 v[66:67], v153 offset:2368
    ds_read_b64_tr_b16 v[68:69], v153 offset:96
    ds_read_b64_tr_b16 v[70:71], v153 offset:2400
    s_waitcnt vmcnt(11) lgkmcnt(6)
    v_mfma_f32_16x16x32_bf16 v[80:83], v[72:75], v[48:51], v[80:83]
    v_mfma_f32_16x16x32_bf16 v[84:87], v[72:75], v[52:55], v[84:87]
    ds_read_b64_tr_b16 v[72:73], v153 offset:128
    ds_read_b64_tr_b16 v[74:75], v153 offset:2432
    s_waitcnt lgkmcnt(6)
    v_mfma_f32_16x16x32_bf16 v[88:91], v[76:79], v[48:51], v[88:91]
    v_mfma_f32_16x16x32_bf16 v[92:95], v[76:79], v[52:55], v[92:95]
    s_add_u32 m0, s29, 0
    s_add_u32 s30, s28, 589824
    buffer_load_dwordx4 v8, s[12:15], s30 offen lds
    ds_read_b64_tr_b16 v[76:77], v153 offset:160
    ds_read_b64_tr_b16 v[78:79], v153 offset:2464
    s_waitcnt lgkmcnt(6)
    v_mfma_f32_16x16x32_bf16 v[96:99], v[64:67], v[48:51], v[96:99]
    v_mfma_f32_16x16x32_bf16 v[100:103], v[64:67], v[52:55], v[100:103]
    ds_read_b64_tr_b16 v[64:65], v153 offset:192
    ds_read_b64_tr_b16 v[66:67], v153 offset:2496
    s_waitcnt lgkmcnt(6)
    v_mfma_f32_16x16x32_bf16 v[104:107], v[68:71], v[48:51], v[104:107]
    v_mfma_f32_16x16x32_bf16 v[108:111], v[68:71], v[52:55], v[108:111]
    ds_read_b64_tr_b16 v[68:69], v153 offset:224
    ds_read_b64_tr_b16 v[70:71], v153 offset:2528
    s_waitcnt lgkmcnt(6)
    v_mfma_f32_16x16x32_bf16 v[112:115], v[72:75], v[48:51], v[112:115]
    v_mfma_f32_16x16x32_bf16 v[116:119], v[72:75], v[52:55], v[116:119]
    s_add_u32 m0, s29, 1024
    s_add_u32 s30, s28, 589824
    buffer_load_dwordx4 v9, s[12:15], s30 offen lds
    ds_read_b64_tr_b16 v[72:73], v153 offset:256
    ds_read_b64_tr_b16 v[74:75], v153 offset:2560
    s_waitcnt lgkmcnt(6)
    v_mfma_f32_16x16x32_bf16 v[120:123], v[76:79], v[48:51], v[120:123]
    v_mfma_f32_16x16x32_bf16 v[124:127], v[76:79], v[52:55], v[124:127]
    ds_read_b64_tr_b16 v[76:77], v153 offset:9216
    ds_read_b64_tr_b16 v[78:79], v153 offset:11520
    s_waitcnt lgkmcnt(6)
    v_mfma_f32_16x16x32_bf16 v[128:131], v[64:67], v[48:51], v[128:131]
    v_mfma_f32_16x16x32_bf16 v[132:135], v[64:67], v[52:55], v[132:135]
    ds_read_b64_tr_b16 v[64:65], v153 offset:9248
    ds_read_b64_tr_b16 v[66:67], v153 offset:11552
    s_waitcnt lgkmcnt(6)
    v_mfma_f32_16x16x32_bf16 v[136:139], v[68:71], v[48:51], v[136:139]
    v_mfma_f32_16x16x32_bf16 v[140:143], v[68:71], v[52:55], v[140:143]
    s_add_u32 m0, s29, 2048
    s_add_u32 s30, s28, 589824
    buffer_load_dwordx4 v10, s[12:15], s30 offen lds
    ds_read_b64_tr_b16 v[68:69], v153 offset:9280
    ds_read_b64_tr_b16 v[70:71], v153 offset:11584
    s_waitcnt lgkmcnt(6)
    v_mfma_f32_16x16x32_bf16 v[144:147], v[72:75], v[48:51], v[144:147]
    v_mfma_f32_16x16x32_bf16 v[148:151], v[72:75], v[52:55], v[148:151]
    s_add_u32 s35, s37, 28672
    buffer_load_dwordx4 v[32:35], v14, s[20:23], s35 offen
    buffer_load_dwordx4 v[36:39], v14, s[20:23], s35 offen offset:256
    ds_read_b64_tr_b16 v[72:73], v153 offset:9312
    ds_read_b64_tr_b16 v[74:75], v153 offset:11616
    s_waitcnt vmcnt(13) lgkmcnt(6)
    v_mfma_f32_16x16x32_bf16 v[80:83], v[76:79], v[56:59], v[80:83]
    v_mfma_f32_16x16x32_bf16 v[84:87], v[76:79], v[60:63], v[84:87]
    ds_read_b64_tr_b16 v[76:77], v153 offset:9344
    ds_read_b64_tr_b16 v[78:79], v153 offset:11648
    s_waitcnt lgkmcnt(6)
    v_mfma_f32_16x16x32_bf16 v[88:91], v[64:67], v[56:59], v[88:91]
    v_mfma_f32_16x16x32_bf16 v[92:95], v[64:67], v[60:63], v[92:95]
    s_add_u32 m0, s29, 3072
    s_add_u32 s30, s28, 589824
    buffer_load_dwordx4 v11, s[12:15], s30 offen lds
    ds_read_b64_tr_b16 v[64:65], v153 offset:9376
    ds_read_b64_tr_b16 v[66:67], v153 offset:11680
    s_waitcnt lgkmcnt(6)
    v_mfma_f32_16x16x32_bf16 v[96:99], v[68:71], v[56:59], v[96:99]
    v_mfma_f32_16x16x32_bf16 v[100:103], v[68:71], v[60:63], v[100:103]
    ds_read_b64_tr_b16 v[68:69], v153 offset:9408
    ds_read_b64_tr_b16 v[70:71], v153 offset:11712
    s_waitcnt lgkmcnt(6)
    v_mfma_f32_16x16x32_bf16 v[104:107], v[72:75], v[56:59], v[104:107]
    v_mfma_f32_16x16x32_bf16 v[108:111], v[72:75], v[60:63], v[108:111]
    ds_read_b64_tr_b16 v[72:73], v153 offset:9440
    ds_read_b64_tr_b16 v[74:75], v153 offset:11744
    s_waitcnt lgkmcnt(6)
    v_mfma_f32_16x16x32_bf16 v[112:115], v[76:79], v[56:59], v[112:115]
    v_mfma_f32_16x16x32_bf16 v[116:119], v[76:79], v[60:63], v[116:119]
    s_cmp_lg_u32 s32, 0
    s_cbranch_scc1 nod_k4_down_kernel_10
    s_add_u32 m0, s29, 4096
    s_add_u32 s30, s28, 589824
    buffer_load_dwordx4 v12, s[12:15], s30 offen lds
nod_k4_down_kernel_10:
    ds_read_b64_tr_b16 v[76:77], v153 offset:9472
    ds_read_b64_tr_b16 v[78:79], v153 offset:11776
    s_waitcnt lgkmcnt(6)
    v_mfma_f32_16x16x32_bf16 v[120:123], v[64:67], v[56:59], v[120:123]
    v_mfma_f32_16x16x32_bf16 v[124:127], v[64:67], v[60:63], v[124:127]
    s_waitcnt lgkmcnt(4)
    v_mfma_f32_16x16x32_bf16 v[128:131], v[68:71], v[56:59], v[128:131]
    v_mfma_f32_16x16x32_bf16 v[132:135], v[68:71], v[60:63], v[132:135]
    s_waitcnt lgkmcnt(2)
    v_mfma_f32_16x16x32_bf16 v[136:139], v[72:75], v[56:59], v[136:139]
    v_mfma_f32_16x16x32_bf16 v[140:143], v[72:75], v[60:63], v[140:143]
    s_waitcnt lgkmcnt(0)
    v_mfma_f32_16x16x32_bf16 v[144:147], v[76:79], v[56:59], v[144:147]
    v_mfma_f32_16x16x32_bf16 v[148:151], v[76:79], v[60:63], v[148:151]
    s_add_u32 s35, s37, 30720
    buffer_load_dwordx4 v[40:43], v14, s[20:23], s35 offen
    buffer_load_dwordx4 v[44:47], v14, s[20:23], s35 offen offset:256
    s_waitcnt vmcnt(16)
    s_barrier
    ds_read_b64_tr_b16 v[64:65], v154 offset:0
    ds_read_b64_tr_b16 v[66:67], v154 offset:2304
    ds_read_b64_tr_b16 v[68:69], v154 offset:32
    ds_read_b64_tr_b16 v[70:71], v154 offset:2336
    ds_read_b64_tr_b16 v[72:73], v154 offset:64
    ds_read_b64_tr_b16 v[74:75], v154 offset:2368
    ds_read_b64_tr_b16 v[76:77], v154 offset:96
    ds_read_b64_tr_b16 v[78:79], v154 offset:2400
    s_waitcnt vmcnt(11) lgkmcnt(6)
    v_mfma_f32_16x16x32_bf16 v[80:83], v[64:67], v[16:19], v[80:83]
    v_mfma_f32_16x16x32_bf16 v[84:87], v[64:67], v[20:23], v[84:87]
    ds_read_b64_tr_b16 v[64:65], v154 offset:128
    ds_read_b64_tr_b16 v[66:67], v154 offset:2432
    s_waitcnt lgkmcnt(6)
    v_mfma_f32_16x16x32_bf16 v[88:91], v[68:71], v[16:19], v[88:91]
    v_mfma_f32_16x16x32_bf16 v[92:95], v[68:71], v[20:23], v[92:95]
    ds_read_b64_tr_b16 v[68:69], v154 offset:160
    ds_read_b64_tr_b16 v[70:71], v154 offset:2464
    s_waitcnt lgkmcnt(6)
    v_mfma_f32_16x16x32_bf16 v[96:99], v[72:75], v[16:19], v[96:99]
    v_mfma_f32_16x16x32_bf16 v[100:103], v[72:75], v[20:23], v[100:103]
    ds_read_b64_tr_b16 v[72:73], v154 offset:192
    ds_read_b64_tr_b16 v[74:75], v154 offset:2496
    s_waitcnt lgkmcnt(6)
    v_mfma_f32_16x16x32_bf16 v[104:107], v[76:79], v[16:19], v[104:107]
    v_mfma_f32_16x16x32_bf16 v[108:111], v[76:79], v[20:23], v[108:111]
    ds_read_b64_tr_b16 v[76:77], v154 offset:224
    ds_read_b64_tr_b16 v[78:79], v154 offset:2528
    s_waitcnt lgkmcnt(6)
    v_mfma_f32_16x16x32_bf16 v[112:115], v[64:67], v[16:19], v[112:115]
    v_mfma_f32_16x16x32_bf16 v[116:119], v[64:67], v[20:23], v[116:119]
    ds_read_b64_tr_b16 v[64:65], v154 offset:256
    ds_read_b64_tr_b16 v[66:67], v154 offset:2560
    s_waitcnt lgkmcnt(6)
    v_mfma_f32_16x16x32_bf16 v[120:123], v[68:71], v[16:19], v[120:123]
    v_mfma_f32_16x16x32_bf16 v[124:127], v[68:71], v[20:23], v[124:127]
    ds_read_b64_tr_b16 v[68:69], v154 offset:9216
    ds_read_b64_tr_b16 v[70:71], v154 offset:11520
    s_waitcnt lgkmcnt(6)
    v_mfma_f32_16x16x32_bf16 v[128:131], v[72:75], v[16:19], v[128:131]
    v_mfma_f32_16x16x32_bf16 v[132:135], v[72:75], v[20:23], v[132:135]
    ds_read_b64_tr_b16 v[72:73], v154 offset:9248
    ds_read_b64_tr_b16 v[74:75], v154 offset:11552
    s_waitcnt lgkmcnt(6)
    v_mfma_f32_16x16x32_bf16 v[136:139], v[76:79], v[16:19], v[136:139]
    v_mfma_f32_16x16x32_bf16 v[140:143], v[76:79], v[20:23], v[140:143]
    ds_read_b64_tr_b16 v[76:77], v154 offset:9280
    ds_read_b64_tr_b16 v[78:79], v154 offset:11584
    s_waitcnt lgkmcnt(6)
    v_mfma_f32_16x16x32_bf16 v[144:147], v[64:67], v[16:19], v[144:147]
    v_mfma_f32_16x16x32_bf16 v[148:151], v[64:67], v[20:23], v[148:151]
    s_add_u32 s35, s37, 32768
    buffer_load_dwordx4 v[48:51], v14, s[20:23], s35 offen
    buffer_load_dwordx4 v[52:55], v14, s[20:23], s35 offen offset:256
    ds_read_b64_tr_b16 v[64:65], v154 offset:9312
    ds_read_b64_tr_b16 v[66:67], v154 offset:11616
    s_waitcnt vmcnt(10) lgkmcnt(6)
    v_mfma_f32_16x16x32_bf16 v[80:83], v[68:71], v[24:27], v[80:83]
    v_mfma_f32_16x16x32_bf16 v[84:87], v[68:71], v[28:31], v[84:87]
    ds_read_b64_tr_b16 v[68:69], v154 offset:9344
    ds_read_b64_tr_b16 v[70:71], v154 offset:11648
    s_waitcnt lgkmcnt(6)
    v_mfma_f32_16x16x32_bf16 v[88:91], v[72:75], v[24:27], v[88:91]
    v_mfma_f32_16x16x32_bf16 v[92:95], v[72:75], v[28:31], v[92:95]
    ds_read_b64_tr_b16 v[72:73], v154 offset:9376
    ds_read_b64_tr_b16 v[74:75], v154 offset:11680
    s_waitcnt lgkmcnt(6)
    v_mfma_f32_16x16x32_bf16 v[96:99], v[76:79], v[24:27], v[96:99]
    v_mfma_f32_16x16x32_bf16 v[100:103], v[76:79], v[28:31], v[100:103]
    ds_read_b64_tr_b16 v[76:77], v154 offset:9408
    ds_read_b64_tr_b16 v[78:79], v154 offset:11712
    s_waitcnt lgkmcnt(6)
    v_mfma_f32_16x16x32_bf16 v[104:107], v[64:67], v[24:27], v[104:107]
    v_mfma_f32_16x16x32_bf16 v[108:111], v[64:67], v[28:31], v[108:111]
    ds_read_b64_tr_b16 v[64:65], v154 offset:9440
    ds_read_b64_tr_b16 v[66:67], v154 offset:11744
    s_waitcnt lgkmcnt(6)
    v_mfma_f32_16x16x32_bf16 v[112:115], v[68:71], v[24:27], v[112:115]
    v_mfma_f32_16x16x32_bf16 v[116:119], v[68:71], v[28:31], v[116:119]
    ds_read_b64_tr_b16 v[68:69], v154 offset:9472
    ds_read_b64_tr_b16 v[70:71], v154 offset:11776
    s_waitcnt lgkmcnt(6)
    v_mfma_f32_16x16x32_bf16 v[120:123], v[72:75], v[24:27], v[120:123]
    v_mfma_f32_16x16x32_bf16 v[124:127], v[72:75], v[28:31], v[124:127]
    s_waitcnt lgkmcnt(4)
    v_mfma_f32_16x16x32_bf16 v[128:131], v[76:79], v[24:27], v[128:131]
    v_mfma_f32_16x16x32_bf16 v[132:135], v[76:79], v[28:31], v[132:135]
    s_waitcnt lgkmcnt(2)
    v_mfma_f32_16x16x32_bf16 v[136:139], v[64:67], v[24:27], v[136:139]
    v_mfma_f32_16x16x32_bf16 v[140:143], v[64:67], v[28:31], v[140:143]
    s_waitcnt lgkmcnt(0)
    v_mfma_f32_16x16x32_bf16 v[144:147], v[68:71], v[24:27], v[144:147]
    v_mfma_f32_16x16x32_bf16 v[148:151], v[68:71], v[28:31], v[148:151]
    s_add_u32 s35, s37, 34816
    buffer_load_dwordx4 v[56:59], v14, s[20:23], s35 offen
    buffer_load_dwordx4 v[60:63], v14, s[20:23], s35 offen offset:256
    s_waitcnt vmcnt(12)
    s_barrier
    ds_read_b64_tr_b16 v[72:73], v155 offset:0
    ds_read_b64_tr_b16 v[74:75], v155 offset:2304
    ds_read_b64_tr_b16 v[76:77], v155 offset:32
    ds_read_b64_tr_b16 v[78:79], v155 offset:2336
    ds_read_b64_tr_b16 v[64:65], v155 offset:64
    ds_read_b64_tr_b16 v[66:67], v155 offset:2368
    ds_read_b64_tr_b16 v[68:69], v155 offset:96
    ds_read_b64_tr_b16 v[70:71], v155 offset:2400
    s_waitcnt vmcnt(7) lgkmcnt(6)
    v_mfma_f32_16x16x32_bf16 v[80:83], v[72:75], v[32:35], v[80:83]
    v_mfma_f32_16x16x32_bf16 v[84:87], v[72:75], v[36:39], v[84:87]
    ds_read_b64_tr_b16 v[72:73], v155 offset:128
    ds_read_b64_tr_b16 v[74:75], v155 offset:2432
    s_waitcnt lgkmcnt(6)
    v_mfma_f32_16x16x32_bf16 v[88:91], v[76:79], v[32:35], v[88:91]
    v_mfma_f32_16x16x32_bf16 v[92:95], v[76:79], v[36:39], v[92:95]
    ds_read_b64_tr_b16 v[76:77], v155 offset:160
    ds_read_b64_tr_b16 v[78:79], v155 offset:2464
    s_waitcnt lgkmcnt(6)
    v_mfma_f32_16x16x32_bf16 v[96:99], v[64:67], v[32:35], v[96:99]
    v_mfma_f32_16x16x32_bf16 v[100:103], v[64:67], v[36:39], v[100:103]
    ds_read_b64_tr_b16 v[64:65], v155 offset:192
    ds_read_b64_tr_b16 v[66:67], v155 offset:2496
    s_waitcnt lgkmcnt(6)
    v_mfma_f32_16x16x32_bf16 v[104:107], v[68:71], v[32:35], v[104:107]
    v_mfma_f32_16x16x32_bf16 v[108:111], v[68:71], v[36:39], v[108:111]
    ds_read_b64_tr_b16 v[68:69], v155 offset:224
    ds_read_b64_tr_b16 v[70:71], v155 offset:2528
    s_waitcnt lgkmcnt(6)
    v_mfma_f32_16x16x32_bf16 v[112:115], v[72:75], v[32:35], v[112:115]
    v_mfma_f32_16x16x32_bf16 v[116:119], v[72:75], v[36:39], v[116:119]
    ds_read_b64_tr_b16 v[72:73], v155 offset:256
    ds_read_b64_tr_b16 v[74:75], v155 offset:2560
    s_waitcnt lgkmcnt(6)
    v_mfma_f32_16x16x32_bf16 v[120:123], v[76:79], v[32:35], v[120:123]
    v_mfma_f32_16x16x32_bf16 v[124:127], v[76:79], v[36:39], v[124:127]
    ds_read_b64_tr_b16 v[76:77], v155 offset:9216
    ds_read_b64_tr_b16 v[78:79], v155 offset:11520
    s_waitcnt lgkmcnt(6)
    v_mfma_f32_16x16x32_bf16 v[128:131], v[64:67], v[32:35], v[128:131]
    v_mfma_f32_16x16x32_bf16 v[132:135], v[64:67], v[36:39], v[132:135]
    ds_read_b64_tr_b16 v[64:65], v155 offset:9248
    ds_read_b64_tr_b16 v[66:67], v155 offset:11552
    s_waitcnt lgkmcnt(6)
    v_mfma_f32_16x16x32_bf16 v[136:139], v[68:71], v[32:35], v[136:139]
    v_mfma_f32_16x16x32_bf16 v[140:143], v[68:71], v[36:39], v[140:143]
    ds_read_b64_tr_b16 v[68:69], v155 offset:9280
    ds_read_b64_tr_b16 v[70:71], v155 offset:11584
    s_waitcnt lgkmcnt(6)
    v_mfma_f32_16x16x32_bf16 v[144:147], v[72:75], v[32:35], v[144:147]
    v_mfma_f32_16x16x32_bf16 v[148:151], v[72:75], v[36:39], v[148:151]
    ds_read_b64_tr_b16 v[72:73], v155 offset:9312
    ds_read_b64_tr_b16 v[74:75], v155 offset:11616
    s_waitcnt vmcnt(4) lgkmcnt(6)
    v_mfma_f32_16x16x32_bf16 v[80:83], v[76:79], v[40:43], v[80:83]
    v_mfma_f32_16x16x32_bf16 v[84:87], v[76:79], v[44:47], v[84:87]
    ds_read_b64_tr_b16 v[76:77], v155 offset:9344
    ds_read_b64_tr_b16 v[78:79], v155 offset:11648
    s_waitcnt lgkmcnt(6)
    v_mfma_f32_16x16x32_bf16 v[88:91], v[64:67], v[40:43], v[88:91]
    v_mfma_f32_16x16x32_bf16 v[92:95], v[64:67], v[44:47], v[92:95]
    ds_read_b64_tr_b16 v[64:65], v155 offset:9376
    ds_read_b64_tr_b16 v[66:67], v155 offset:11680
    s_waitcnt lgkmcnt(6)
    v_mfma_f32_16x16x32_bf16 v[96:99], v[68:71], v[40:43], v[96:99]
    v_mfma_f32_16x16x32_bf16 v[100:103], v[68:71], v[44:47], v[100:103]
    ds_read_b64_tr_b16 v[68:69], v155 offset:9408
    ds_read_b64_tr_b16 v[70:71], v155 offset:11712
    s_waitcnt lgkmcnt(6)
    v_mfma_f32_16x16x32_bf16 v[104:107], v[72:75], v[40:43], v[104:107]
    v_mfma_f32_16x16x32_bf16 v[108:111], v[72:75], v[44:47], v[108:111]
    ds_read_b64_tr_b16 v[72:73], v155 offset:9440
    ds_read_b64_tr_b16 v[74:75], v155 offset:11744
    s_waitcnt lgkmcnt(6)
    v_mfma_f32_16x16x32_bf16 v[112:115], v[76:79], v[40:43], v[112:115]
    v_mfma_f32_16x16x32_bf16 v[116:119], v[76:79], v[44:47], v[116:119]
    ds_read_b64_tr_b16 v[76:77], v155 offset:9472
    ds_read_b64_tr_b16 v[78:79], v155 offset:11776
    s_waitcnt lgkmcnt(6)
    v_mfma_f32_16x16x32_bf16 v[120:123], v[64:67], v[40:43], v[120:123]
    v_mfma_f32_16x16x32_bf16 v[124:127], v[64:67], v[44:47], v[124:127]
    s_waitcnt lgkmcnt(4)
    v_mfma_f32_16x16x32_bf16 v[128:131], v[68:71], v[40:43], v[128:131]
    v_mfma_f32_16x16x32_bf16 v[132:135], v[68:71], v[44:47], v[132:135]
    s_waitcnt lgkmcnt(2)
    v_mfma_f32_16x16x32_bf16 v[136:139], v[72:75], v[40:43], v[136:139]
    v_mfma_f32_16x16x32_bf16 v[140:143], v[72:75], v[44:47], v[140:143]
    s_waitcnt lgkmcnt(0)
    v_mfma_f32_16x16x32_bf16 v[144:147], v[76:79], v[40:43], v[144:147]
    v_mfma_f32_16x16x32_bf16 v[148:151], v[76:79], v[44:47], v[148:151]
    s_waitcnt vmcnt(4)
    s_barrier
    ds_read_b64_tr_b16 v[64:65], v152 offset:0
    ds_read_b64_tr_b16 v[66:67], v152 offset:2304
    ds_read_b64_tr_b16 v[68:69], v152 offset:32
    ds_read_b64_tr_b16 v[70:71], v152 offset:2336
    ds_read_b64_tr_b16 v[72:73], v152 offset:64
    ds_read_b64_tr_b16 v[74:75], v152 offset:2368
    ds_read_b64_tr_b16 v[76:77], v152 offset:96
    ds_read_b64_tr_b16 v[78:79], v152 offset:2400
    s_waitcnt vmcnt(2) lgkmcnt(6)
    v_mfma_f32_16x16x32_bf16 v[80:83], v[64:67], v[48:51], v[80:83]
    v_mfma_f32_16x16x32_bf16 v[84:87], v[64:67], v[52:55], v[84:87]
    ds_read_b64_tr_b16 v[64:65], v152 offset:128
    ds_read_b64_tr_b16 v[66:67], v152 offset:2432
    s_waitcnt lgkmcnt(6)
    v_mfma_f32_16x16x32_bf16 v[88:91], v[68:71], v[48:51], v[88:91]
    v_mfma_f32_16x16x32_bf16 v[92:95], v[68:71], v[52:55], v[92:95]
    ds_read_b64_tr_b16 v[68:69], v152 offset:160
    ds_read_b64_tr_b16 v[70:71], v152 offset:2464
    s_waitcnt lgkmcnt(6)
    v_mfma_f32_16x16x32_bf16 v[96:99], v[72:75], v[48:51], v[96:99]
    v_mfma_f32_16x16x32_bf16 v[100:103], v[72:75], v[52:55], v[100:103]
    ds_read_b64_tr_b16 v[72:73], v152 offset:192
    ds_read_b64_tr_b16 v[74:75], v152 offset:2496
    s_waitcnt lgkmcnt(6)
    v_mfma_f32_16x16x32_bf16 v[104:107], v[76:79], v[48:51], v[104:107]
    v_mfma_f32_16x16x32_bf16 v[108:111], v[76:79], v[52:55], v[108:111]
    ds_read_b64_tr_b16 v[76:77], v152 offset:224
    ds_read_b64_tr_b16 v[78:79], v152 offset:2528
    s_waitcnt lgkmcnt(6)
    v_mfma_f32_16x16x32_bf16 v[112:115], v[64:67], v[48:51], v[112:115]
    v_mfma_f32_16x16x32_bf16 v[116:119], v[64:67], v[52:55], v[116:119]
    ds_read_b64_tr_b16 v[64:65], v152 offset:256
    ds_read_b64_tr_b16 v[66:67], v152 offset:2560
    s_waitcnt lgkmcnt(6)
    v_mfma_f32_16x16x32_bf16 v[120:123], v[68:71], v[48:51], v[120:123]
    v_mfma_f32_16x16x32_bf16 v[124:127], v[68:71], v[52:55], v[124:127]
    ds_read_b64_tr_b16 v[68:69], v152 offset:9216
    ds_read_b64_tr_b16 v[70:71], v152 offset:11520
    s_waitcnt lgkmcnt(6)
    v_mfma_f32_16x16x32_bf16 v[128:131], v[72:75], v[48:51], v[128:131]
    v_mfma_f32_16x16x32_bf16 v[132:135], v[72:75], v[52:55], v[132:135]
    ds_read_b64_tr_b16 v[72:73], v152 offset:9248
    ds_read_b64_tr_b16 v[74:75], v152 offset:11552
    s_waitcnt lgkmcnt(6)
    v_mfma_f32_16x16x32_bf16 v[136:139], v[76:79], v[48:51], v[136:139]
    v_mfma_f32_16x16x32_bf16 v[140:143], v[76:79], v[52:55], v[140:143]
    ds_read_b64_tr_b16 v[76:77], v152 offset:9280
    ds_read_b64_tr_b16 v[78:79], v152 offset:11584
    s_waitcnt lgkmcnt(6)
    v_mfma_f32_16x16x32_bf16 v[144:147], v[64:67], v[48:51], v[144:147]
    v_mfma_f32_16x16x32_bf16 v[148:151], v[64:67], v[52:55], v[148:151]
    ds_read_b64_tr_b16 v[64:65], v152 offset:9312
    ds_read_b64_tr_b16 v[66:67], v152 offset:11616
    s_waitcnt vmcnt(0) lgkmcnt(6)
    v_mfma_f32_16x16x32_bf16 v[80:83], v[68:71], v[56:59], v[80:83]
    v_mfma_f32_16x16x32_bf16 v[84:87], v[68:71], v[60:63], v[84:87]
    ds_read_b64_tr_b16 v[68:69], v152 offset:9344
    ds_read_b64_tr_b16 v[70:71], v152 offset:11648
    s_waitcnt lgkmcnt(6)
    v_mfma_f32_16x16x32_bf16 v[88:91], v[72:75], v[56:59], v[88:91]
    v_mfma_f32_16x16x32_bf16 v[92:95], v[72:75], v[60:63], v[92:95]
    ds_read_b64_tr_b16 v[72:73], v152 offset:9376
    ds_read_b64_tr_b16 v[74:75], v152 offset:11680
    s_waitcnt lgkmcnt(6)
    v_mfma_f32_16x16x32_bf16 v[96:99], v[76:79], v[56:59], v[96:99]
    v_mfma_f32_16x16x32_bf16 v[100:103], v[76:79], v[60:63], v[100:103]
    ds_read_b64_tr_b16 v[76:77], v152 offset:9408
    ds_read_b64_tr_b16 v[78:79], v152 offset:11712
    s_waitcnt lgkmcnt(6)
    v_mfma_f32_16x16x32_bf16 v[104:107], v[64:67], v[56:59], v[104:107]
    v_mfma_f32_16x16x32_bf16 v[108:111], v[64:67], v[60:63], v[108:111]
    ds_read_b64_tr_b16 v[64:65], v152 offset:9440
    ds_read_b64_tr_b16 v[66:67], v152 offset:11744
    s_waitcnt lgkmcnt(6)
    v_mfma_f32_16x16x32_bf16 v[112:115], v[68:71], v[56:59], v[112:115]
    v_mfma_f32_16x16x32_bf16 v[116:119], v[68:71], v[60:63], v[116:119]
    ds_read_b64_tr_b16 v[68:69], v152 offset:9472
    ds_read_b64_tr_b16 v[70:71], v152 offset:11776
    s_waitcnt lgkmcnt(6)
    v_mfma_f32_16x16x32_bf16 v[120:123], v[72:75], v[56:59], v[120:123]
    v_mfma_f32_16x16x32_bf16 v[124:127], v[72:75], v[60:63], v[124:127]
    s_waitcnt lgkmcnt(4)
    v_mfma_f32_16x16x32_bf16 v[128:131], v[76:79], v[56:59], v[128:131]
    v_mfma_f32_16x16x32_bf16 v[132:135], v[76:79], v[60:63], v[132:135]
    s_waitcnt lgkmcnt(2)
    v_mfma_f32_16x16x32_bf16 v[136:139], v[64:67], v[56:59], v[136:139]
    v_mfma_f32_16x16x32_bf16 v[140:143], v[64:67], v[60:63], v[140:143]
    s_waitcnt lgkmcnt(0)
    v_mfma_f32_16x16x32_bf16 v[144:147], v[68:71], v[56:59], v[144:147]
    v_mfma_f32_16x16x32_bf16 v[148:151], v[68:71], v[60:63], v[148:151]
    s_barrier
    s_nop 7
    s_mul_i32 s27, s26, 10240
    v_add_u32 v3, s27, v13
    s_xor_b32 s27, s26, 4
    s_mul_i32 s27, s27, 10240
    v_add_u32 v6, s27, v13
    s_cmp_eq_u32 s32, 0
    s_cbranch_scc1 give0_k4_down_kernel_11
    ds_write_b128 v3, v[80:83] offset:0
    ds_write_b128 v3, v[84:87] offset:1024
    ds_write_b128 v3, v[88:91] offset:2048
    ds_write_b128 v3, v[92:95] offset:3072
    ds_write_b128 v3, v[96:99] offset:4096
    ds_write_b128 v3, v[100:103] offset:5120
    ds_write_b128 v3, v[104:107] offset:6144
    ds_write_b128 v3, v[108:111] offset:7168
    ds_write_b128 v3, v[112:115] offset:8192
    ds_write_b128 v3, v[116:119] offset:9216
    s_branch join1_k4_down_kernel_12
give0_k4_down_kernel_11:
    ds_write_b128 v3, v[120:123] offset:0
    ds_write_b128 v3, v[124:127] offset:1024
    ds_write_b128 v3, v[128:131] offset:2048
    ds_write_b128 v3, v[132:135] offset:3072
    ds_write_b128 v3, v[136:139] offset:4096
    ds_write_b128 v3, v[140:143] offset:5120
    ds_write_b128 v3, v[144:147] offset:6144
    ds_write_b128 v3, v[148:151] offset:7168
join1_k4_down_kernel_12:
    s_waitcnt lgkmcnt(0)
    s_barrier
    s_mul_i32 s38, s24, 4718592
    s_mul_i32 s27, s36, 73728
    s_add_u32 s38, s38, s27
    s_mul_i32 s27, s25, 9216
    s_add_u32 s38, s38, s27
    s_add_u32 s38, s38, 32505856
    s_cmp_eq_u32 s32, 0
    s_cbranch_scc1 keep0_k4_down_kernel_13
    ds_read_b128 v[16:19], v6 offset:0
    ds_read_b128 v[20:23], v6 offset:1024
    ds_read_b128 v[24:27], v6 offset:2048
    ds_read_b128 v[28:31], v6 offset:3072
    ds_read_b128 v[32:35], v6 offset:4096
    ds_read_b128 v[36:39], v6 offset:5120
    ds_read_b128 v[40:43], v6 offset:6144
    ds_read_b128 v[44:47], v6 offset:7168
    s_waitcnt lgkmcnt(7)
    v_pk_add_f32 v[120:121], v[120:121], v[16:17]
    v_pk_add_f32 v[122:123], v[122:123], v[18:19]
    s_add_u32 s39, s38, 5120
    buffer_store_dwordx4 v[120:123], v13, s[20:23], s39 offen
    s_waitcnt lgkmcnt(6)
    v_pk_add_f32 v[124:125], v[124:125], v[20:21]
    v_pk_add_f32 v[126:127], v[126:127], v[22:23]
    s_add_u32 s39, s38, 41984
    buffer_store_dwordx4 v[124:127], v13, s[20:23], s39 offen
    s_waitcnt lgkmcnt(5)
    v_pk_add_f32 v[128:129], v[128:129], v[24:25]
    v_pk_add_f32 v[130:131], v[130:131], v[26:27]
    s_add_u32 s39, s38, 6144
    buffer_store_dwordx4 v[128:131], v13, s[20:23], s39 offen
    s_waitcnt lgkmcnt(4)
    v_pk_add_f32 v[132:133], v[132:133], v[28:29]
    v_pk_add_f32 v[134:135], v[134:135], v[30:31]
    s_add_u32 s39, s38, 43008
    buffer_store_dwordx4 v[132:135], v13, s[20:23], s39 offen
    s_waitcnt lgkmcnt(3)
    v_pk_add_f32 v[136:137], v[136:137], v[32:33]
    v_pk_add_f32 v[138:139], v[138:139], v[34:35]
    s_add_u32 s39, s38, 7168
    buffer_store_dwordx4 v[136:139], v13, s[20:23], s39 offen
    s_waitcnt lgkmcnt(2)
    v_pk_add_f32 v[140:141], v[140:141], v[36:37]
    v_pk_add_f32 v[142:143], v[142:143], v[38:39]
    s_add_u32 s39, s38, 44032
    buffer_store_dwordx4 v[140:143], v13, s[20:23], s39 offen
    s_waitcnt lgkmcnt(1)
    v_pk_add_f32 v[144:145], v[144:145], v[40:41]
    v_pk_add_f32 v[146:147], v[146:147], v[42:43]
    s_add_u32 s39, s38, 8192
    buffer_store_dwordx4 v[144:147], v13, s[20:23], s39 offen
    s_waitcnt lgkmcnt(0)
    v_pk_add_f32 v[148:149], v[148:149], v[44:45]
    v_pk_add_f32 v[150:151], v[150:151], v[46:47]
    s_add_u32 s39, s38, 45056
    buffer_store_dwordx4 v[148:151], v13, s[20:23], s39 offen
    s_branch fin_k4_down_kernel_14
keep0_k4_down_kernel_13:
    ds_read_b128 v[16:19], v6 offset:0
    ds_read_b128 v[20:23], v6 offset:1024
    ds_read_b128 v[24:27], v6 offset:2048
    ds_read_b128 v[28:31], v6 offset:3072
    ds_read_b128 v[32:35], v6 offset:4096
    ds_read_b128 v[36:39], v6 offset:5120
    ds_read_b128 v[40:43], v6 offset:6144
    ds_read_b128 v[44:47], v6 offset:7168
    ds_read_b128 v[48:51], v6 offset:8192
    ds_read_b128 v[52:55], v6 offset:9216
    s_waitcnt lgkmcnt(9)
    v_pk_add_f32 v[80:81], v[80:81], v[16:17]
    v_pk_add_f32 v[82:83], v[82:83], v[18:19]
    s_add_u32 s39, s38, 0
    buffer_store_dwordx4 v[80:83], v13, s[20:23], s39 offen
    s_waitcnt lgkmcnt(8)
    v_pk_add_f32 v[84:85], v[84:85], v[20:21]
    v_pk_add_f32 v[86:87], v[86:87], v[22:23]
    s_add_u32 s39, s38, 36864
    buffer_store_dwordx4 v[84:87], v13, s[20:23], s39 offen
    s_waitcnt lgkmcnt(7)
    v_pk_add_f32 v[88:89], v[88:89], v[24:25]
    v_pk_add_f32 v[90:91], v[90:91], v[26:27]
    s_add_u32 s39, s38, 1024
    buffer_store_dwordx4 v[88:91], v13, s[20:23], s39 offen
    s_waitcnt lgkmcnt(6)
    v_pk_add_f32 v[92:93], v[92:93], v[28:29]
    v_pk_add_f32 v[94:95], v[94:95], v[30:31]
    s_add_u32 s39, s38, 37888
    buffer_store_dwordx4 v[92:95], v13, s[20:23], s39 offen
    s_waitcnt lgkmcnt(5)
    v_pk_add_f32 v[96:97], v[96:97], v[32:33]
    v_pk_add_f32 v[98:99], v[98:99], v[34:35]
    s_add_u32 s39, s38, 2048
    buffer_store_dwordx4 v[96:99], v13, s[20:23], s39 offen
    s_waitcnt lgkmcnt(4)
    v_pk_add_f32 v[100:101], v[100:101], v[36:37]
    v_pk_add_f32 v[102:103], v[102:103], v[38:39]
    s_add_u32 s39, s38, 38912
    buffer_store_dwordx4 v[100:103], v13, s[20:23], s39 offen
    s_waitcnt lgkmcnt(3)
    v_pk_add_f32 v[104:105], v[104:105], v[40:41]
    v_pk_add_f32 v[106:107], v[106:107], v[42:43]
    s_add_u32 s39, s38, 3072
    buffer_store_dwordx4 v[104:107], v13, s[20:23], s39 offen
    s_waitcnt lgkmcnt(2)
    v_pk_add_f32 v[108:109], v[108:109], v[44:45]
    v_pk_add_f32 v[110:111], v[110:111], v[46:47]
    s_add_u32 s39, s38, 39936
    buffer_store_dwordx4 v[108:111], v13, s[20:23], s39 offen
    s_waitcnt lgkmcnt(1)
    v_pk_add_f32 v[112:113], v[112:113], v[48:49]
    v_pk_add_f32 v[114:115], v[114:115], v[50:51]
    s_add_u32 s39, s38, 4096
    buffer_store_dwordx4 v[112:115], v13, s[20:23], s39 offen
    s_waitcnt lgkmcnt(0)
    v_pk_add_f32 v[116:117], v[116:117], v[52:53]
    v_pk_add_f32 v[118:119], v[118:119], v[54:55]
    s_add_u32 s39, s38, 40960
    buffer_store_dwordx4 v[116:119], v13, s[20:23], s39 offen
fin_k4_down_kernel_14:
end_k4_down_kernel_1:
    s_endpgm
.globl k5_reduce_kernel
.p2align 8
.type k5_reduce_kernel,@function
k5_reduce_kernel:
    s_load_dwordx2 s[4:5], s[0:1], 80
    s_load_dwordx2 s[8:9], s[0:1], 96
    s_waitcnt lgkmcnt(0)
    s_mov_b32 s12, s4
    s_and_b32 s13, s5, 0xffff
    s_mov_b32 s14, 2359296
    s_mov_b32 s15, 0x00020000
    s_mov_b32 s20, s8
    s_and_b32 s21, s9, 0xffff
    s_mov_b32 s22, 268435456
    s_mov_b32 s23, 0x00020000
    s_cmp_ge_u32 s2, 192
    s_cbranch_scc1 end_k5_reduce_kernel_1
    v_lshrrev_b32 v1, 6, v0
    v_and_b32 v2, 63, v0
    v_readfirstlane_b32 s26, v1
    v_and_b32 v4, 15, v2
    v_lshrrev_b32 v5, 4, v2
    s_lshl_b32 s24, s2, 2
    s_add_u32 s24, s24, s26
    s_mul_i32 s25, s24, 10923
    s_lshr_b32 s25, s25, 16
    s_mul_i32 s27, s25, 6
    s_sub_u32 s27, s24, s27
    v_lshlrev_b32 v13, 4, v2
    s_mul_i32 s28, s24, 6144
    s_add_u32 s28, s28, 32505856
    buffer_load_dwordx4 v[16:19], v13, s[20:23], s28 offen offset:0
    buffer_load_dwordx4 v[20:23], v13, s[20:23], s28 offen offset:1024
    buffer_load_dwordx4 v[24:27], v13, s[20:23], s28 offen offset:2048
    buffer_load_dwordx4 v[28:31], v13, s[20:23], s28 offen offset:3072
    s_add_u32 s29, s28, 4096
    buffer_load_dwordx4 v[32:35], v13, s[20:23], s29 offen offset:0
    buffer_load_dwordx4 v[36:39], v13, s[20:23], s29 offen offset:1024
    s_add_u32 s28, s28, 4718592
    buffer_load_dwordx4 v[40:43], v13, s[20:23], s28 offen offset:0
    buffer_load_dwordx4 v[44:47], v13, s[20:23], s28 offen offset:1024
    buffer_load_dwordx4 v[48:51], v13, s[20:23], s28 offen offset:2048
    buffer_load_dwordx4 v[52:55], v13, s[20:23], s28 offen offset:3072
    s_add_u32 s29, s28, 4096
    buffer_load_dwordx4 v[56:59], v13, s[20:23], s29 offen offset:0
    buffer_load_dwordx4 v[60:63], v13, s[20:23], s29 offen offset:1024
    s_add_u32 s28, s28, 4718592
    buffer_load_dwordx4 v[64:67], v13, s[20:23], s28 offen offset:0
    buffer_load_dwordx4 v[68:71], v13, s[20:23], s28 offen offset:1024
    buffer_load_dwordx4 v[72:75], v13, s[20:23], s28 offen offset:2048
    buffer_load_dwordx4 v[76:79], v13, s[20:23], s28 offen offset:3072
    s_add_u32 s29, s28, 4096
    buffer_load_dwordx4 v[80:83], v13, s[20:23], s29 offen offset:0
    buffer_load_dwordx4 v[84:87], v13, s[20:23], s29 offen offset:1024
    s_add_u32 s28, s28, 4718592
    buffer_load_dwordx4 v[88:91], v13, s[20:23], s28 offen offset:0
    buffer_load_dwordx4 v[92:95], v13, s[20:23], s28 offen offset:1024
    buffer_load_dwordx4 v[96:99], v13, s[20:23], s28 offen offset:2048
    buffer_load_dwordx4 v[100:103], v13, s[20:23], s28 offen offset:3072
    s_add_u32 s29, s28, 4096
    buffer_load_dwordx4 v[104:107], v13, s[20:23], s29 offen offset:0
    buffer_load_dwordx4 v[108:111], v13, s[20:23], s29 offen offset:1024
    s_lshl_b32 s38, s25, 4
    v_add_u32 v3, s38, v4
    v_mul_u32_u24 v3, 1152, v3
    v_lshlrev_b32 v6, 3, v5
    v_add_u32 v3, v3, v6
    s_mul_i32 s39, s27, 192
    v_add_u32 v3, s39, v3
    v_lshlrev_b32 v6, 4, v5
    s_mul_i32 s39, s27, 384
    s_add_u32 s39, s39, 11520
    s_mov_b32 s40, 8912896
    buffer_load_dwordx4 v[112:115], v6, s[20:23], s39 offen offset:0
    buffer_load_dwordx2 v[136:137], v3, s[20:23], s40 offen offset:0
    buffer_load_dwordx4 v[116:119], v6, s[20:23], s39 offen offset:64
    buffer_load_dwordx2 v[138:139], v3, s[20:23], s40 offen offset:32
    buffer_load_dwordx4 v[120:123], v6, s[20:23], s39 offen offset:128
    buffer_load_dwordx2 v[140:141], v3, s[20:23], s40 offen offset:64
    buffer_load_dwordx4 v[124:127], v6, s[20:23], s39 offen offset:192
    buffer_load_dwordx2 v[142:143], v3, s[20:23], s40 offen offset:96
    buffer_load_dwordx4 v[128:131], v6, s[20:23], s39 offen offset:256
    buffer_load_dwordx2 v[144:145], v3, s[20:23], s40 offen offset:128
    buffer_load_dwordx4 v[132:135], v6, s[20:23], s39 offen offset:320
    buffer_load_dwordx2 v[146:147], v3, s[20:23], s40 offen offset:160
    s_waitcnt vmcnt(12)
    v_pk_add_f32 v[16:17], v[16:17], v[40:41]
    v_pk_add_f32 v[18:19], v[18:19], v[42:43]
    v_pk_add_f32 v[20:21], v[20:21], v[44:45]
    v_pk_add_f32 v[22:23], v[22:23], v[46:47]
    v_pk_add_f32 v[24:25], v[24:25], v[48:49]
    v_pk_add_f32 v[26:27], v[26:27], v[50:51]
    v_pk_add_f32 v[28:29], v[28:29], v[52:53]
    v_pk_add_f32 v[30:31], v[30:31], v[54:55]
    v_pk_add_f32 v[32:33], v[32:33], v[56:57]
    v_pk_add_f32 v[34:35], v[34:35], v[58:59]
    v_pk_add_f32 v[36:37], v[36:37], v[60:61]
    v_pk_add_f32 v[38:39], v[38:39], v[62:63]
    v_pk_add_f32 v[16:17], v[16:17], v[64:65]
    v_pk_add_f32 v[18:19], v[18:19], v[66:67]
    v_pk_add_f32 v[20:21], v[20:21], v[68:69]
    v_pk_add_f32 v[22:23], v[22:23], v[70:71]
    v_pk_add_f32 v[24:25], v[24:25], v[72:73]
    v_pk_add_f32 v[26:27], v[26:27], v[74:75]
    v_pk_add_f32 v[28:29], v[28:29], v[76:77]
    v_pk_add_f32 v[30:31], v[30:31], v[78:79]
    v_pk_add_f32 v[32:33], v[32:33], v[80:81]
    v_pk_add_f32 v[34:35], v[34:35], v[82:83]
    v_pk_add_f32 v[36:37], v[36:37], v[84:85]
    v_pk_add_f32 v[38:39], v[38:39], v[86:87]
    v_pk_add_f32 v[16:17], v[16:17], v[88:89]
    v_pk_add_f32 v[18:19], v[18:19], v[90:91]
    v_pk_add_f32 v[20:21], v[20:21], v[92:93]
    v_pk_add_f32 v[22:23], v[22:23], v[94:95]
    v_pk_add_f32 v[24:25], v[24:25], v[96:97]
    v_pk_add_f32 v[26:27], v[26:27], v[98:99]
    v_pk_add_f32 v[28:29], v[28:29], v[100:101]
    v_pk_add_f32 v[30:31], v[30:31], v[102:103]
    v_pk_add_f32 v[32:33], v[32:33], v[104:105]
    v_pk_add_f32 v[34:35], v[34:35], v[106:107]
    v_pk_add_f32 v[36:37], v[36:37], v[108:109]
    v_pk_add_f32 v[38:39], v[38:39], v[110:111]
    s_waitcnt vmcnt(0)
    v_cvt_pk_bf16_f32 v148, v16, v17
    v_lshlrev_b32 v16, 16, v148
    v_and_b32 v17, 0xffff0000, v148
    v_cvt_pk_bf16_f32 v148, v18, v19
    v_lshlrev_b32 v18, 16, v148
    v_and_b32 v19, 0xffff0000, v148
    v_mul_f32 v16, v16, v112
    v_mul_f32 v17, v17, v113
    v_mul_f32 v18, v18, v114
    v_mul_f32 v19, v19, v115
    v_cvt_pk_bf16_f32 v148, v16, v17
    v_lshlrev_b32 v16, 16, v148
    v_and_b32 v17, 0xffff0000, v148
    v_cvt_pk_bf16_f32 v148, v18, v19
    v_lshlrev_b32 v18, 16, v148
    v_and_b32 v19, 0xffff0000, v148
    v_lshlrev_b32 v148, 16, v136
    v_and_b32 v149, 0xffff0000, v136
    v_lshlrev_b32 v150, 16, v137
    v_and_b32 v151, 0xffff0000, v137
    v_add_f32 v16, v16, v148
    v_add_f32 v17, v17, v149
    v_add_f32 v18, v18, v150
    v_add_f32 v19, v19, v151
    v_cvt_pk_bf16_f32 v136, v16, v17
    v_cvt_pk_bf16_f32 v137, v18, v19
    buffer_store_dwordx2 v[136:137], v3, s[12:15], 0 offen offset:0
    v_cvt_pk_bf16_f32 v148, v20, v21
    v_lshlrev_b32 v20, 16, v148
    v_and_b32 v21, 0xffff0000, v148
    v_cvt_pk_bf16_f32 v148, v22, v23
    v_lshlrev_b32 v22, 16, v148
    v_and_b32 v23, 0xffff0000, v148
    v_mul_f32 v20, v20, v116
    v_mul_f32 v21, v21, v117
    v_mul_f32 v22, v22, v118
    v_mul_f32 v23, v23, v119
    v_cvt_pk_bf16_f32 v148, v20, v21
    v_lshlrev_b32 v20, 16, v148
    v_and_b32 v21, 0xffff0000, v148
    v_cvt_pk_bf16_f32 v148, v22, v23
    v_lshlrev_b32 v22, 16, v148
    v_and_b32 v23, 0xffff0000, v148
    v_lshlrev_b32 v148, 16, v138
    v_and_b32 v149, 0xffff0000, v138
    v_lshlrev_b32 v150, 16, v139
    v_and_b32 v151, 0xffff0000, v139
    v_add_f32 v20, v20, v148
    v_add_f32 v21, v21, v149
    v_add_f32 v22, v22, v150
    v_add_f32 v23, v23, v151
    v_cvt_pk_bf16_f32 v138, v20, v21
    v_cvt_pk_bf16_f32 v139, v22, v23
    buffer_store_dwordx2 v[138:139], v3, s[12:15], 0 offen offset:32
    v_cvt_pk_bf16_f32 v148, v24, v25
    v_lshlrev_b32 v24, 16, v148
    v_and_b32 v25, 0xffff0000, v148
    v_cvt_pk_bf16_f32 v148, v26, v27
    v_lshlrev_b32 v26, 16, v148
    v_and_b32 v27, 0xffff0000, v148
    v_mul_f32 v24, v24, v120
    v_mul_f32 v25, v25, v121
    v_mul_f32 v26, v26, v122
    v_mul_f32 v27, v27, v123
    v_cvt_pk_bf16_f32 v148, v24, v25
    v_lshlrev_b32 v24, 16, v148
    v_and_b32 v25, 0xffff0000, v148
    v_cvt_pk_bf16_f32 v148, v26, v27
    v_lshlrev_b32 v26, 16, v148
    v_and_b32 v27, 0xffff0000, v148
    v_lshlrev_b32 v148, 16, v140
    v_and_b32 v149, 0xffff0000, v140
    v_lshlrev_b32 v150, 16, v141
    v_and_b32 v151, 0xffff0000, v141
    v_add_f32 v24, v24, v148
    v_add_f32 v25, v25, v149
    v_add_f32 v26, v26, v150
    v_add_f32 v27, v27, v151
    v_cvt_pk_bf16_f32 v140, v24, v25
    v_cvt_pk_bf16_f32 v141, v26, v27
    buffer_store_dwordx2 v[140:141], v3, s[12:15], 0 offen offset:64
    v_cvt_pk_bf16_f32 v148, v28, v29
    v_lshlrev_b32 v28, 16, v148
    v_and_b32 v29, 0xffff0000, v148
    v_cvt_pk_bf16_f32 v148, v30, v31
    v_lshlrev_b32 v30, 16, v148
    v_and_b32 v31, 0xffff0000, v148
    v_mul_f32 v28, v28, v124
    v_mul_f32 v29, v29, v125
    v_mul_f32 v30, v30, v126
    v_mul_f32 v31, v31, v127
    v_cvt_pk_bf16_f32 v148, v28, v29
    v_lshlrev_b32 v28, 16, v148
    v_and_b32 v29, 0xffff0000, v148
    v_cvt_pk_bf16_f32 v148, v30, v31
    v_lshlrev_b32 v30, 16, v148
    v_and_b32 v31, 0xffff0000, v148
    v_lshlrev_b32 v148, 16, v142
    v_and_b32 v149, 0xffff0000, v142
    v_lshlrev_b32 v150, 16, v143
    v_and_b32 v151, 0xffff0000, v143
    v_add_f32 v28, v28, v148
    v_add_f32 v29, v29, v149
    v_add_f32 v30, v30, v150
    v_add_f32 v31, v31, v151
    v_cvt_pk_bf16_f32 v142, v28, v29
    v_cvt_pk_bf16_f32 v143, v30, v31
    buffer_store_dwordx2 v[142:143], v3, s[12:15], 0 offen offset:96
    v_cvt_pk_bf16_f32 v148, v32, v33
    v_lshlrev_b32 v32, 16, v148
    v_and_b32 v33, 0xffff0000, v148
    v_cvt_pk_bf16_f32 v148, v34, v35
    v_lshlrev_b32 v34, 16, v148
    v_and_b32 v35, 0xffff0000, v148
    v_mul_f32 v32, v32, v128
    v_mul_f32 v33, v33, v129
    v_mul_f32 v34, v34, v130
    v_mul_f32 v35, v35, v131
    v_cvt_pk_bf16_f32 v148, v32, v33
    v_lshlrev_b32 v32, 16, v148
    v_and_b32 v33, 0xffff0000, v148
    v_cvt_pk_bf16_f32 v148, v34, v35
    v_lshlrev_b32 v34, 16, v148
    v_and_b32 v35, 0xffff0000, v148
    v_lshlrev_b32 v148, 16, v144
    v_and_b32 v149, 0xffff0000, v144
    v_lshlrev_b32 v150, 16, v145
    v_and_b32 v151, 0xffff0000, v145
    v_add_f32 v32, v32, v148
    v_add_f32 v33, v33, v149
    v_add_f32 v34, v34, v150
    v_add_f32 v35, v35, v151
    v_cvt_pk_bf16_f32 v144, v32, v33
    v_cvt_pk_bf16_f32 v145, v34, v35
    buffer_store_dwordx2 v[144:145], v3, s[12:15], 0 offen offset:128
    v_cvt_pk_bf16_f32 v148, v36, v37
    v_lshlrev_b32 v36, 16, v148
    v_and_b32 v37, 0xffff0000, v148
    v_cvt_pk_bf16_f32 v148, v38, v39
    v_lshlrev_b32 v38, 16, v148
    v_and_b32 v39, 0xffff0000, v148
    v_mul_f32 v36, v36, v132
    v_mul_f32 v37, v37, v133
    v_mul_f32 v38, v38, v134
    v_mul_f32 v39, v39, v135
    v_cvt_pk_bf16_f32 v148, v36, v37
    v_lshlrev_b32 v36, 16, v148
    v_and_b32 v37, 0xffff0000, v148
    v_cvt_pk_bf16_f32 v148, v38, v39
    v_lshlrev_b32 v38, 16, v148
    v_and_b32 v39, 0xffff0000, v148
    v_lshlrev_b32 v148, 16, v146
    v_and_b32 v149, 0xffff0000, v146
    v_lshlrev_b32 v150, 16, v147
    v_and_b32 v151, 0xffff0000, v147
    v_add_f32 v36, v36, v148
    v_add_f32 v37, v37, v149
    v_add_f32 v38, v38, v150
    v_add_f32 v39, v39, v151
    v_cvt_pk_bf16_f32 v146, v36, v37
    v_cvt_pk_bf16_f32 v147, v38, v39
    buffer_store_dwordx2 v[146:147], v3, s[12:15], 0 offen offset:160
end_k5_reduce_kernel_1:
    s_endpgm
.section .rodata,"a"
.p2align 6
.amdhsa_kernel k0_mod_kernel
  .amdhsa_next_free_vgpr 96
  .amdhsa_next_free_sgpr 48
  .amdhsa_accum_offset 96
  .amdhsa_group_segment_fixed_size 0
  .amdhsa_kernarg_size 104
  .amdhsa_user_sgpr_count 2
  .amdhsa_user_sgpr_kernarg_segment_ptr 1
  .amdhsa_system_sgpr_workgroup_id_x 1
  .amdhsa_float_denorm_mode_32 3
.end_amdhsa_kernel
.p2align 6
.amdhsa_kernel ln1_kernel
  .amdhsa_next_free_vgpr 208
  .amdhsa_next_free_sgpr 48
  .amdhsa_accum_offset 208
  .amdhsa_group_segment_fixed_size 0
  .amdhsa_kernarg_size 104
  .amdhsa_user_sgpr_count 2
  .amdhsa_user_sgpr_kernarg_segment_ptr 1
  .amdhsa_system_sgpr_workgroup_id_x 1
  .amdhsa_float_denorm_mode_32 3
.end_amdhsa_kernel
.p2align 6
.amdhsa_kernel k1_qkv_kernel
  .amdhsa_next_free_vgpr 200
  .amdhsa_next_free_sgpr 64
  .amdhsa_accum_offset 200
  .amdhsa_group_segment_fixed_size 0
  .amdhsa_kernarg_size 104
  .amdhsa_user_sgpr_count 2
  .amdhsa_user_sgpr_kernarg_segment_ptr 1
  .amdhsa_system_sgpr_workgroup_id_x 1
  .amdhsa_float_denorm_mode_32 3
.end_amdhsa_kernel
.p2align 6
.amdhsa_kernel k2_attn_kernel
  .amdhsa_next_free_vgpr 200
  .amdhsa_next_free_sgpr 64
  .amdhsa_accum_offset 200
  .amdhsa_group_segment_fixed_size 0
  .amdhsa_kernarg_size 104
  .amdhsa_user_sgpr_count 2
  .amdhsa_user_sgpr_kernarg_segment_ptr 1
  .amdhsa_system_sgpr_workgroup_id_x 1
  .amdhsa_float_denorm_mode_32 3
.end_amdhsa_kernel
.p2align 6
.amdhsa_kernel ln2_kernel
  .amdhsa_next_free_vgpr 208
  .amdhsa_next_free_sgpr 48
  .amdhsa_accum_offset 208
  .amdhsa_group_segment_fixed_size 0
  .amdhsa_kernarg_size 104
  .amdhsa_user_sgpr_count 2
  .amdhsa_user_sgpr_kernarg_segment_ptr 1
  .amdhsa_system_sgpr_workgroup_id_x 1
  .amdhsa_float_denorm_mode_32 3
.end_amdhsa_kernel
.p2align 6
.amdhsa_kernel k3_gateup_kernel
  .amdhsa_next_free_vgpr 244
  .amdhsa_next_free_sgpr 64
  .amdhsa_accum_offset 244
  .amdhsa_group_segment_fixed_size 0
  .amdhsa_kernarg_size 104
  .amdhsa_user_sgpr_count 2
  .amdhsa_user_sgpr_kernarg_segment_ptr 1
  .amdhsa_system_sgpr_workgroup_id_x 1
  .amdhsa_float_denorm_mode_32 3
.end_amdhsa_kernel
.p2align 6
.amdhsa_kernel k4_down_kernel
  .amdhsa_next_free_vgpr 168
  .amdhsa_next_free_sgpr 64
  .amdhsa_accum_offset 168
  .amdhsa_group_segment_fixed_size 0
  .amdhsa_kernarg_size 104
  .amdhsa_user_sgpr_count 2
  .amdhsa_user_sgpr_kernarg_segment_ptr 1
  .amdhsa_system_sgpr_workgroup_id_x 1
  .amdhsa_float_denorm_mode_32 3
.end_amdhsa_kernel
.p2align 6
.amdhsa_kernel k5_reduce_kernel
  .amdhsa_next_free_vgpr 160
  .amdhsa_next_free_sgpr 48
  .amdhsa_accum_offset 160
  .amdhsa_group_segment_fixed_size 0
  .amdhsa_kernarg_size 104
  .amdhsa_user_sgpr_count 2
  .amdhsa_user_sgpr_kernarg_segment_ptr 1
  .amdhsa_system_sgpr_workgroup_id_x 1
  .amdhsa_float_denorm_mode_32 3
.end_amdhsa_kernel
```
